```python
import torch

def _softmax(x, axis=-1):
    return torch.softmax(x, dim=axis)
def _gelu(x):
    return torch.nn.functional.gelu(x, approximate="tanh")
def _silu(x):
    return torch.nn.functional.silu(x)
def _sigmoid(x):
    return torch.sigmoid(x)
def _layernorm(x, axis=-1, eps=1e-5):
    m = x.mean(dim=axis, keepdim=True)
    v = x.var(dim=axis, keepdim=True, unbiased=False)
    return (x - m) / torch.sqrt(v + eps)
def _scatter_add(tgt, idx, src, axis=0):
    return tgt.clone().index_add_(axis, idx, src)
def _segment_sum(src, seg, n):
    out = torch.zeros((n,) + src.shape[1:], dtype=src.dtype)
    return out.index_add_(0, seg, src)
def _pad(x, pw):
    flat = tuple(v for pair in reversed(pw) for v in pair)
    return torch.nn.functional.pad(x, flat)

kernel_name = 'standalone__modern_conv_block_slak__vision'

def setup_inputs():

    _w = (lambda a: (lambda t: t.to(torch.bfloat16) if t.is_floating_point() else t)(torch.as_tensor(a)))
    H = W = 384
    C = 96
    K = 3
    return {
        "x": _w((lambda *s: torch.randn(*s, dtype=torch.bfloat16) * 0.05)(1, H, W, C)),
        "dw": _w((lambda *s: torch.randn(*s, dtype=torch.bfloat16) * 0.05)(K, K, C)),
        "w1": _w((lambda *s: torch.randn(*s, dtype=torch.bfloat16) * 0.05)(C, 4 * C)),
        "w2": _w((lambda *s: torch.randn(*s, dtype=torch.bfloat16) * 0.05)(4 * C, C)),
        "grn_g": _w((lambda *s: torch.randn(*s, dtype=torch.bfloat16) * 0.05)(4 * C)),
        "grn_b": _w((lambda *s: torch.randn(*s, dtype=torch.bfloat16) * 0.05)(4 * C)),
    }

def reference(x, dw, w1, w2, grn_g, grn_b):
    B, H, W, C = x.shape
    K = dw.shape[0]
    pad = K // 2
    xp = _pad(x, ((0,0),(pad,pad),(pad,pad),(0,0)))
    out = torch.zeros_like(x)
    for i in range(K):
        for j in range(K):
            out = out + xp[:, i:i+H, j:j+W, :] * dw[i, j][None, None, None, :]
    h = _layernorm(out, axis=-1)
    h = _gelu(h @ w1)
    gx = torch.sqrt((h * h).sum(axis=(1, 2), keepdims=True) + 1e-6)
    nx = gx / (gx.mean(axis=-1, keepdims=True) + 1e-6)
    h = grn_g[None, None, None, :] * (h * nx) + grn_b[None, None, None, :] + h
    return x + h @ w2
```

```asm
; @launch grid=(256,1,1) block=(512,1,1) lds=163840
.amdgcn_target "amdgcn-amd-amdhsa--gfx950"
.text
.globl standalone__modern_conv_block_slak__vision_kernel
.p2align 8
.type standalone__modern_conv_block_slak__vision_kernel,@function
standalone__modern_conv_block_slak__vision_kernel:
    s_cmp_ge_u32 s2, 256
    s_cbranch_scc1 L_end
    s_load_dwordx16 s[16:31], s[0:1], 0
    s_load_dwordx2 s[32:33], s[0:1], 64
    v_and_b32 v1, 63, v0
    v_lshrrev_b32_e64 v10, 6, v0
    s_nop 0
    v_readfirstlane_b32 s3, v10
    s_nop 0
    s_cmp_lg_u32 s3, 7
    s_cbranch_scc1 L_skip1
    s_getpc_b64 s[12:13]
L_pf1:
    s_lshr_b32 s9, s2, 3
    s_lshl_b32 s9, s9, 11
    v_lshl_add_u32 v14, v1, 7, s9
    v_min_u32 v14, L_end-L_pf1, v14
    s_mov_b64 exec, 0xffff
    global_load_dword v36, v14, s[12:13]
    s_mov_b64 exec, -1
L_skip1:
    v_and_b32 v12, 15, v0
    v_lshlrev_b32_e64 v12, 2, v12
    v_add_u32 v12, 163536, v12
    v_mov_b32_e64 v13, 0
    ds_write_b32 v12, v13
    s_and_b32 s9, s2, 7
    s_lshl_b32 s9, s9, 5
    s_lshr_b32 s10, s2, 3
    s_add_u32 s4, s9, s10
    s_mul_i32 s9, s4, 3
    s_lshr_b32 s5, s9, 6
    s_mul_i32 s9, s4, 18
    s_mul_i32 s10, s5, 384
    s_sub_u32 s6, s9, s10
    s_mul_i32 s9, s6, 73728
    s_mul_i32 s10, s5, 6144
    s_add_u32 s9, s9, s10
    s_sub_u32 s7, s9, 73920
    s_sub_u32 s8, 385, s6
    s_mul_i32 s9, s3, 896
    s_add_u32 s11, s9, 73728
    s_lshr_b32 s69, s3, 2
    s_and_b32 s62, s3, 3
    s_cmp_lg_u32 s69, 0
    s_cbranch_scc1 L_rstart
    s_mul_i32 s9, s3, 56
    v_add_u32_e64 v10, s9, v1
    v_mul_u32_u24 v12, 5042, v10
    v_lshrrev_b32 v12, 16, v12
    v_mul_u32_u24 v13, 13, v12
    v_sub_u32_e64 v13, v10, v13
    v_mul_u32_u24 v9, 192, v12
    v_lshl_add_u32 v9, v13, 4, v9
    v_cmp_lt_u32 vcc, 33, v12
    v_cmp_eq_u32 s[56:57], 12, v13
    v_mov_b32 v14, 0x40000000
    s_or_b64 vcc, vcc, s[56:57]
    v_cndmask_b32 v9, v9, v14, vcc
    s_add_u32 s12, s3, 4
    s_mul_i32 s9, s12, 56
    v_add_u32_e64 v10, s9, v1
    v_mul_u32_u24 v12, 5042, v10
    v_lshrrev_b32 v12, 16, v12
    v_mul_u32_u24 v13, 13, v12
    v_sub_u32_e64 v13, v10, v13
    v_mul_u32_u24 v251, 192, v12
    v_lshl_add_u32 v251, v13, 4, v251
    v_cmp_lt_u32 vcc, 33, v12
    v_cmp_eq_u32 s[56:57], 12, v13
    v_mov_b32 v14, 0x40000000
    s_or_b64 vcc, vcc, s[56:57]
    v_cndmask_b32 v251, v251, v14, vcc
    v_min_u32 v16, 215, v0
    v_lshlrev_b32 v17, 3, v16
    s_waitcnt lgkmcnt(0)
    s_mov_b32 s36, s16
    s_mov_b32 s37, s17
    s_mov_b32 s38, 28311552
    s_mov_b32 s39, 0x00020000
    global_load_dwordx2 v[18:19], v17, s[18:19]
    s_mov_b32 exec_hi, 0x00ffffff
    s_add_u32 s9, s7, 0
    s_sub_u32 s10, s9, 28305408
    s_cmp_le_u32 s8, 0
    s_cselect_b32 s9, s10, s9
    s_add_u32 m0, s11, 0
    v_add_u32_e64 v10, s9, v9
    buffer_load_dwordx4 v10, s[36:39], 0 offen  lds
    s_add_u32 m0, m0, 3584
    v_add_u32_e64 v10, s9, v251
    buffer_load_dwordx4 v10, s[36:39], 0 offen  lds
    s_add_u32 s9, s7, 73728
    s_sub_u32 s10, s9, 28305408
    s_cmp_le_u32 s8, 1
    s_cselect_b32 s9, s10, s9
    s_add_u32 m0, s11, 7168
    v_add_u32_e64 v10, s9, v9
    buffer_load_dwordx4 v10, s[36:39], 0 offen  lds
    s_add_u32 m0, m0, 3584
    v_add_u32_e64 v10, s9, v251
    buffer_load_dwordx4 v10, s[36:39], 0 offen  lds
    s_add_u32 s9, s7, 147456
    s_sub_u32 s10, s9, 28305408
    s_cmp_le_u32 s8, 2
    s_cselect_b32 s9, s10, s9
    s_add_u32 m0, s11, 14336
    v_add_u32_e64 v10, s9, v9
    buffer_load_dwordx4 v10, s[36:39], 0 offen  lds
    s_add_u32 m0, m0, 3584
    v_add_u32_e64 v10, s9, v251
    buffer_load_dwordx4 v10, s[36:39], 0 offen  lds
    s_add_u32 s9, s7, 221184
    s_sub_u32 s10, s9, 28305408
    s_cmp_le_u32 s8, 3
    s_cselect_b32 s9, s10, s9
    s_add_u32 m0, s11, 21504
    v_add_u32_e64 v10, s9, v9
    buffer_load_dwordx4 v10, s[36:39], 0 offen  lds
    s_add_u32 m0, m0, 3584
    v_add_u32_e64 v10, s9, v251
    buffer_load_dwordx4 v10, s[36:39], 0 offen  lds
    s_mov_b32 exec_hi, -1
    s_barrier
    v_min_u32 v12, 243, v0
    v_mul_u32_u24 v22, 400, v12
    v_add_u32 v22, 145792, v22
    v_lshlrev_b32 v14, 4, v12
    v_cmp_gt_u32 vcc, 36, v12
    v_add_u32 v14, 159232, v14
    v_mul_u32_u24 v20, 2731, v16
    v_cndmask_b32 v22, v14, v22, vcc
    v_lshrrev_b32 v20, 16, v20
    v_mul_u32_u24 v21, 24, v20
    v_sub_u32 v21, v16, v21
    v_lshrrev_b32_e64 v21, 1, v21
    v_mul_u32_u24 v21, 1200, v21
    v_mul_u32_u24 v17, 11, v20
    v_lshrrev_b32 v17, 5, v17
    v_mul_u32_u24 v17, 1072, v17
    v_mul_u32_u24 v20, 400, v20
    v_sub_u32 v20, v20, v17
    v_add_u32 v20, v20, v21
    v_and_b32_e64 v16, 1, v16
    v_mul_u32_u24 v16, 72, v16
    v_add3_u32 v20, v20, v16, 0
    v_add_u32 v20, 145408, v20
    v_xor_b32 v21, 8, v20
    v_mov_b32 v28, 0
    v_mov_b32 v29, 0
    v_mov_b32 v30, 0
    v_mov_b32_e64 v31, 0
    s_and_b32 s9, s2, 7
    s_lshl_b32 s9, s9, 12
    s_add_u32 s64, s32, s9
    s_addc_u32 s65, s33, 0
    s_lshl_b32 s9, s3, 12
    s_add_u32 s66, s32, s9
    s_addc_u32 s67, s33, 0
    s_lshr_b32 s9, s2, 3
    s_xor_b32 s10, s3, 4
    s_or_b32 s68, s9, s10
    s_mov_b32 s44, s22
    s_mov_b32 s45, s23
    s_mov_b32 s46, 73728
    s_mov_b32 s47, 0x00020000
    s_mov_b32 s48, s28
    s_mov_b32 s49, s29
    s_mov_b32 s50, 28311552
    s_mov_b32 s51, 0x00020000
    s_mov_b32 s34, 0x409d30fc
    s_mov_b32 s35, 0x409d30fc
    v_bfe_u32 v12, v1, 2, 1
    v_lshrrev_b32 v13, 4, v1
    v_sub_u32 v13, v13, v12
    v_and_b32 v13, 3, v13
    v_lshrrev_b32 v12, 1, v1
    v_and_b32 v12, 4, v12
    v_and_b32 v14, 3, v1
    v_cmp_eq_u32 vcc, 3, v13
    v_or_b32 v12, v12, v14
    v_lshlrev_b32 v13, 7, v13
    v_cndmask_b32 v12, v12, v28, vcc
    v_lshl_add_u32 v2, v12, 4, v13
    v_add_u32 v2, 145408, v2
    v_lshrrev_b32_e64 v12, 5, v1
    v_bfe_u32 v13, v1, 2, 2
    v_lshl_add_u32 v12, v12, 2, v13
    v_bfe_u32 v13, v1, 3, 1
    v_lshlrev_b32_e64 v13, 6, v13
    v_lshl_add_u32 v12, v12, 7, v13
    v_bfe_u32 v13, v1, 4, 1
    v_lshl_add_u32 v12, v13, 5, v12
    v_lshl_add_u32 v248, v14, 3, v12
    v_xor_b32 v249, 64, v248
    v_lshlrev_b32 v6, 4, v1
    v_add_u32 v7, 36864, v6
    v_and_b32 v13, 31, v1
    v_lshlrev_b32 v8, 3, v13
    v_add_u32 v8, 160064, v8
    v_lshrrev_b32 v12, 5, v1
    v_lshlrev_b32 v12, 1, v12
    v_bfe_u32 v14, v1, 1, 2
    v_xor_b32 v12, v12, v14
    v_lshlrev_b32 v13, 6, v13
    v_lshl_add_u32 v0, v12, 4, v13
    ds_write_b128 v22, v[28:31]
    ds_write_b64 v21, v[28:29] offset:0
    ds_write_b64 v21, v[28:29] offset:16
    ds_write_b64 v21, v[28:29] offset:32
    ds_write_b64 v21, v[28:29] offset:48
    v_mov_b32 v41, 0
    v_mov_b32 v43, 0
    v_mov_b32 v44, 0
    v_mov_b32 v46, 0
    s_mov_b32 s12, 0
    s_lshr_b32 s13, s62, 1
    s_lshl_b32 s12, s12, 1
    s_add_u32 s9, s6, s12
    s_cmp_ge_u32 s9, 384
    s_cselect_b32 s10, 384, 0
    s_cselect_b32 s15, 1, 0
    s_sub_u32 s9, s9, s10
    s_add_u32 s15, s15, s5
    s_lshl_b32 s15, s15, 1
    s_add_u32 s15, s15, s13
    s_mul_i32 s54, s9, 73728
    s_mul_i32 s10, s15, 3072
    s_add_u32 s54, s54, s10
    s_cmp_eq_u32 s9, 0
    s_cselect_b32 s58, 0xffff, 0
    s_cmp_eq_u32 s9, 382
    s_cselect_b32 s59, 0xffff0000, 0
    s_cmp_eq_u32 s15, 0
    s_cselect_b32 s10, 0x00010001, 0
    s_or_b32 s56, s58, s10
    s_or_b32 s57, s59, s10
    s_cmp_eq_u32 s15, 23
    s_cselect_b32 s10, 0x80008000, 0
    s_or_b32 s60, s58, s10
    s_or_b32 s61, s59, s10
    s_mul_i32 s10, s13, 3328
    s_add_u32 s10, s10, 73728
    v_lshrrev_b32 v10, 4, v1
    v_add_u32 v10, s12, v10
    v_subrev_u32 v12, 10, v10
    v_min_u32_e64 v10, v10, v12
    v_mul_u32_u24 v10, 7168, v10
    v_and_b32_e64 v12, 15, v1
    v_mul_u32_u24 v12, 208, v12
    v_add3_u32 v10, v10, v12, s10
    v_mov_b32 v13, 159808
    v_add_u32 v4, 208, v10
    v_add_u32 v5, 416, v10
    v_cndmask_b32 v3, v10, v13, s[56:57]
    v_cndmask_b32 v4, v4, v13, s[58:59]
    v_cndmask_b32 v5, v5, v13, s[60:61]
    s_and_b32 s9, s62, 1
    s_mul_i32 s10, s9, 36864
    v_add_u32 v248, s10, v248
    v_add_u32_e64 v249, s10, v249
    s_mul_i32 s10, s9, 1536
    v_add_u32_e64 v250, s10, v8
    s_mov_b32 s40, s32
    s_mov_b32 s41, s33
    s_mov_b32 s42, 13631488
    s_mov_b32 s43, 0x00020000
    s_mul_i32 s9, s4, 49152
    s_mul_i32 s10, s62, 12288
    s_add_u32 s9, s9, s10
    s_add_u32 s63, s9, 1048576
    s_waitcnt vmcnt(8)
    v_and_b32 v40, 0xffff, v18
    v_and_b32 v42, 0xffff0000, v18
    v_and_b32 v45, 0xffff, v19
    v_and_b32 v47, 0xffff0000, v19
    ds_write_b64 v20, v[40:41] offset:0
    ds_write_b64 v20, v[42:43] offset:16
    ds_write_b64 v20, v[44:45] offset:32
    ds_write_b64 v20, v[46:47] offset:48
    s_waitcnt vmcnt(0) lgkmcnt(0)
    v_mov_b32 v14, 163536
    v_mov_b32_e64 v15, 1
    s_mov_b64 exec, 1
    ds_add_u32 v14, v15 offset:0
    s_mov_b64 exec, -1
    v_mov_b32 v14, 163536
    s_mov_b32 s10, 0
L_aw2:
    ds_read_b32 v15, v14 offset:0
    s_add_u32 s10, s10, 1
    s_waitcnt lgkmcnt(0)
    v_readfirstlane_b32 s9, v15
    s_lshr_b32 s55, s10, 22
    s_lshl_b32 s55, s55, 3
    s_or_b32 s9, s9, s55
    s_cmp_lt_u32 s9, 4
    s_cbranch_scc1 L_aw2
    s_setprio 3
    s_nop 0
    ds_read_b128 v[92:95], v2 offset:0
    ds_read_b128 v[96:99], v3 offset:0
    ds_read_b128 v[100:103], v2 offset:400
    ds_read_b128 v[104:107], v4 offset:0
    ds_read_b128 v[108:111], v2 offset:800
    ds_read_b128 v[112:115], v5 offset:0
    ds_read_b128 v[116:119], v2 offset:1200
    ds_read_b128 v[120:123], v3 offset:16
    ds_read_b128 v[124:127], v2 offset:1600
    ds_read_b128 v[128:131], v4 offset:16
    s_waitcnt lgkmcnt(8)
    v_mfma_f32_16x16x32_bf16 v[188:191], v[92:95], v[96:99], 0
    ds_read_b128 v[92:95], v2 offset:2000
    ds_read_b128 v[96:99], v5 offset:16
    s_waitcnt lgkmcnt(8)
    v_mfma_f32_16x16x32_bf16 v[188:191], v[100:103], v[104:107], v[188:191]
    ds_read_b128 v[100:103], v2 offset:2400
    ds_read_b128 v[104:107], v3 offset:32
    s_waitcnt lgkmcnt(8)
    v_mfma_f32_16x16x32_bf16 v[188:191], v[108:111], v[112:115], v[188:191]
    ds_read_b128 v[108:111], v2 offset:2800
    ds_read_b128 v[112:115], v4 offset:32
    s_waitcnt lgkmcnt(8)
    v_mfma_f32_16x16x32_bf16 v[192:195], v[116:119], v[120:123], 0
    ds_read_b128 v[116:119], v2 offset:3200
    ds_read_b128 v[120:123], v5 offset:32
    s_waitcnt lgkmcnt(8)
    v_mfma_f32_16x16x32_bf16 v[192:195], v[124:127], v[128:131], v[192:195]
    ds_read_b128 v[124:127], v2 offset:3600
    ds_read_b128 v[128:131], v3 offset:48
    s_waitcnt lgkmcnt(8)
    v_mfma_f32_16x16x32_bf16 v[192:195], v[92:95], v[96:99], v[192:195]
    ds_read_b128 v[92:95], v2 offset:4000
    ds_read_b128 v[96:99], v4 offset:48
    s_waitcnt lgkmcnt(8)
    v_mfma_f32_16x16x32_bf16 v[196:199], v[100:103], v[104:107], 0
    ds_read_b128 v[100:103], v2 offset:4400
    ds_read_b128 v[104:107], v5 offset:48
    s_waitcnt lgkmcnt(8)
    v_mfma_f32_16x16x32_bf16 v[196:199], v[108:111], v[112:115], v[196:199]
    ds_read_b128 v[108:111], v2 offset:4800
    ds_read_b128 v[112:115], v3 offset:64
    s_waitcnt lgkmcnt(8)
    v_mfma_f32_16x16x32_bf16 v[196:199], v[116:119], v[120:123], v[196:199]
    ds_read_b128 v[116:119], v2 offset:5200
    ds_read_b128 v[120:123], v4 offset:64
    s_waitcnt lgkmcnt(8)
    v_mfma_f32_16x16x32_bf16 v[200:203], v[124:127], v[128:131], 0
    ds_read_b128 v[124:127], v2 offset:5600
    ds_read_b128 v[128:131], v5 offset:64
    s_waitcnt lgkmcnt(8)
    v_mfma_f32_16x16x32_bf16 v[200:203], v[92:95], v[96:99], v[200:203]
    ds_read_b128 v[92:95], v2 offset:6000
    ds_read_b128 v[96:99], v3 offset:80
    s_waitcnt lgkmcnt(8)
    v_mfma_f32_16x16x32_bf16 v[200:203], v[100:103], v[104:107], v[200:203]
    ds_read_b128 v[100:103], v2 offset:6400
    ds_read_b128 v[104:107], v4 offset:80
    s_waitcnt lgkmcnt(8)
    v_mfma_f32_16x16x32_bf16 v[204:207], v[108:111], v[112:115], 0
    ds_read_b128 v[108:111], v2 offset:6800
    ds_read_b128 v[112:115], v5 offset:80
    s_waitcnt lgkmcnt(8)
    v_mfma_f32_16x16x32_bf16 v[204:207], v[116:119], v[120:123], v[204:207]
    ds_read_b128 v[116:119], v2 offset:7200
    ds_read_b128 v[120:123], v3 offset:96
    s_waitcnt lgkmcnt(8)
    v_mfma_f32_16x16x32_bf16 v[204:207], v[124:127], v[128:131], v[204:207]
    ds_read_b128 v[124:127], v2 offset:7600
    ds_read_b128 v[128:131], v4 offset:96
    s_waitcnt lgkmcnt(8)
    v_mfma_f32_16x16x32_bf16 v[208:211], v[92:95], v[96:99], 0
    ds_read_b128 v[92:95], v2 offset:8000
    ds_read_b128 v[96:99], v5 offset:96
    s_waitcnt lgkmcnt(8)
    v_mfma_f32_16x16x32_bf16 v[208:211], v[100:103], v[104:107], v[208:211]
    ds_read_b128 v[100:103], v2 offset:8400
    ds_read_b128 v[104:107], v3 offset:112
    s_waitcnt lgkmcnt(8)
    v_mfma_f32_16x16x32_bf16 v[208:211], v[108:111], v[112:115], v[208:211]
    ds_read_b128 v[108:111], v2 offset:8800
    ds_read_b128 v[112:115], v4 offset:112
    s_waitcnt lgkmcnt(8)
    v_mfma_f32_16x16x32_bf16 v[212:215], v[116:119], v[120:123], 0
    ds_read_b128 v[116:119], v2 offset:9200
    ds_read_b128 v[120:123], v5 offset:112
    s_waitcnt lgkmcnt(8)
    v_mfma_f32_16x16x32_bf16 v[212:215], v[124:127], v[128:131], v[212:215]
    ds_read_b128 v[124:127], v2 offset:9600
    ds_read_b128 v[128:131], v3 offset:128
    s_waitcnt lgkmcnt(8)
    v_mfma_f32_16x16x32_bf16 v[212:215], v[92:95], v[96:99], v[212:215]
    ds_read_b128 v[92:95], v2 offset:10000
    ds_read_b128 v[96:99], v4 offset:128
    s_waitcnt lgkmcnt(8)
    v_mfma_f32_16x16x32_bf16 v[216:219], v[100:103], v[104:107], 0
    ds_read_b128 v[100:103], v2 offset:10400
    ds_read_b128 v[104:107], v5 offset:128
    s_waitcnt lgkmcnt(8)
    v_mfma_f32_16x16x32_bf16 v[216:219], v[108:111], v[112:115], v[216:219]
    ds_read_b128 v[108:111], v2 offset:10800
    ds_read_b128 v[112:115], v3 offset:144
    s_waitcnt lgkmcnt(8)
    v_mfma_f32_16x16x32_bf16 v[216:219], v[116:119], v[120:123], v[216:219]
    ds_read_b128 v[116:119], v2 offset:11200
    ds_read_b128 v[120:123], v4 offset:144
    s_waitcnt lgkmcnt(8)
    v_mfma_f32_16x16x32_bf16 v[220:223], v[124:127], v[128:131], 0
    ds_read_b128 v[124:127], v2 offset:11600
    ds_read_b128 v[128:131], v5 offset:144
    s_waitcnt lgkmcnt(8)
    v_mfma_f32_16x16x32_bf16 v[220:223], v[92:95], v[96:99], v[220:223]
    ds_read_b128 v[92:95], v2 offset:12000
    ds_read_b128 v[96:99], v3 offset:160
    s_waitcnt lgkmcnt(8)
    v_mfma_f32_16x16x32_bf16 v[220:223], v[100:103], v[104:107], v[220:223]
    ds_read_b128 v[100:103], v2 offset:12400
    ds_read_b128 v[104:107], v4 offset:160
    s_waitcnt lgkmcnt(8)
    v_mfma_f32_16x16x32_bf16 v[224:227], v[108:111], v[112:115], 0
    ds_read_b128 v[108:111], v2 offset:12800
    ds_read_b128 v[112:115], v5 offset:160
    s_waitcnt lgkmcnt(8)
    v_mfma_f32_16x16x32_bf16 v[224:227], v[116:119], v[120:123], v[224:227]
    ds_read_b128 v[116:119], v2 offset:13200
    ds_read_b128 v[120:123], v3 offset:176
    s_waitcnt lgkmcnt(8)
    v_mfma_f32_16x16x32_bf16 v[224:227], v[124:127], v[128:131], v[224:227]
    ds_read_b128 v[124:127], v2 offset:13600
    ds_read_b128 v[128:131], v4 offset:176
    s_waitcnt lgkmcnt(8)
    v_mfma_f32_16x16x32_bf16 v[228:231], v[92:95], v[96:99], 0
    ds_read_b128 v[92:95], v2 offset:14000
    ds_read_b128 v[96:99], v5 offset:176
    s_waitcnt lgkmcnt(8)
    v_mfma_f32_16x16x32_bf16 v[228:231], v[100:103], v[104:107], v[228:231]
    s_waitcnt lgkmcnt(6)
    v_mfma_f32_16x16x32_bf16 v[228:231], v[108:111], v[112:115], v[228:231]
    s_waitcnt lgkmcnt(4)
    v_mfma_f32_16x16x32_bf16 v[232:235], v[116:119], v[120:123], 0
    s_waitcnt lgkmcnt(2)
    v_mfma_f32_16x16x32_bf16 v[232:235], v[124:127], v[128:131], v[232:235]
    s_waitcnt lgkmcnt(0)
    v_mfma_f32_16x16x32_bf16 v[232:235], v[92:95], v[96:99], v[232:235]
    v_mov_b32 v14, 163536
    v_mov_b32 v15, 1
    s_mov_b64 exec, 1
    ds_add_u32 v14, v15 offset:8
    s_mov_b64 exec, -1
    s_lshr_b32 s12, s62, 1
    s_add_u32 s12, s12, 3
    s_lshl_b32 s13, s69, 1
    s_sub_u32 s12, s12, s13
    s_and_b32 s13, s62, 1
    s_lshl_b32 s12, s12, 1
    s_add_u32 s9, s6, s12
    s_cmp_ge_u32 s9, 384
    s_cselect_b32 s10, 384, 0
    s_cselect_b32 s15, 1, 0
    s_sub_u32 s9, s9, s10
    s_add_u32 s15, s15, s5
    s_lshl_b32 s15, s15, 1
    s_add_u32 s15, s15, s13
    s_mul_i32 s52, s9, 73728
    s_mul_i32 s10, s15, 3072
    s_add_u32 s52, s52, s10
    s_cmp_eq_u32 s9, 0
    s_cselect_b32 s58, 0xffff, 0
    s_cmp_eq_u32 s9, 382
    s_cselect_b32 s59, 0xffff0000, 0
    s_cmp_eq_u32 s15, 0
    s_cselect_b32 s10, 0x00010001, 0
    s_or_b32 s56, s58, s10
    s_or_b32 s57, s59, s10
    s_cmp_eq_u32 s15, 23
    s_cselect_b32 s10, 0x80008000, 0
    s_or_b32 s60, s58, s10
    s_or_b32 s61, s59, s10
    s_mul_i32 s10, s13, 3328
    s_add_u32 s10, s10, 73728
    v_lshrrev_b32 v10, 4, v1
    v_add_u32 v10, s12, v10
    v_subrev_u32 v12, 10, v10
    v_min_u32_e64 v10, v10, v12
    v_mul_u32_u24 v10, 7168, v10
    v_and_b32_e64 v12, 15, v1
    v_mul_u32_u24 v12, 208, v12
    v_add3_u32 v10, v10, v12, s10
    v_mov_b32 v13, 159808
    v_add_u32 v4, 208, v10
    v_add_u32 v5, 416, v10
    v_cndmask_b32 v3, v10, v13, s[56:57]
    v_cndmask_b32 v4, v4, v13, s[58:59]
    v_cndmask_b32 v5, v5, v13, s[60:61]
    v_pk_add_f32 v[16:17], v[188:189], v[190:191]
    v_pk_mul_f32 v[20:21], v[188:189], v[188:189]
    v_pk_add_f32 v[18:19], v[192:193], v[194:195]
    v_pk_mul_f32 v[22:23], v[190:191], v[190:191]
    v_pk_fma_f32 v[20:21], v[192:193], v[192:193], v[20:21]
    v_pk_fma_f32 v[22:23], v[194:195], v[194:195], v[22:23]
    v_pk_add_f32 v[16:17], v[16:17], v[196:197]
    v_pk_fma_f32 v[20:21], v[196:197], v[196:197], v[20:21]
    v_pk_add_f32 v[18:19], v[18:19], v[198:199]
    v_pk_fma_f32 v[22:23], v[198:199], v[198:199], v[22:23]
    v_pk_add_f32 v[16:17], v[16:17], v[200:201]
    v_pk_fma_f32 v[20:21], v[200:201], v[200:201], v[20:21]
    v_pk_add_f32 v[18:19], v[18:19], v[202:203]
    v_pk_fma_f32 v[22:23], v[202:203], v[202:203], v[22:23]
    v_pk_add_f32 v[16:17], v[16:17], v[204:205]
    v_pk_fma_f32 v[20:21], v[204:205], v[204:205], v[20:21]
    v_pk_add_f32 v[18:19], v[18:19], v[206:207]
    v_pk_fma_f32 v[22:23], v[206:207], v[206:207], v[22:23]
    v_pk_add_f32 v[16:17], v[16:17], v[208:209]
    v_pk_fma_f32 v[20:21], v[208:209], v[208:209], v[20:21]
    v_pk_add_f32 v[18:19], v[18:19], v[210:211]
    v_pk_fma_f32 v[22:23], v[210:211], v[210:211], v[22:23]
    v_pk_add_f32 v[16:17], v[16:17], v[212:213]
    v_pk_fma_f32 v[20:21], v[212:213], v[212:213], v[20:21]
    v_pk_add_f32 v[18:19], v[18:19], v[214:215]
    v_pk_fma_f32 v[22:23], v[214:215], v[214:215], v[22:23]
    v_pk_add_f32 v[16:17], v[16:17], v[216:217]
    v_pk_fma_f32 v[20:21], v[216:217], v[216:217], v[20:21]
    v_pk_add_f32 v[18:19], v[18:19], v[218:219]
    v_pk_fma_f32 v[22:23], v[218:219], v[218:219], v[22:23]
    v_pk_add_f32 v[16:17], v[16:17], v[220:221]
    v_pk_fma_f32 v[20:21], v[220:221], v[220:221], v[20:21]
    v_pk_add_f32 v[18:19], v[18:19], v[222:223]
    v_pk_fma_f32 v[22:23], v[222:223], v[222:223], v[22:23]
    v_pk_add_f32 v[16:17], v[16:17], v[224:225]
    v_pk_fma_f32 v[20:21], v[224:225], v[224:225], v[20:21]
    v_pk_add_f32 v[18:19], v[18:19], v[226:227]
    v_pk_fma_f32 v[22:23], v[226:227], v[226:227], v[22:23]
    v_pk_add_f32 v[16:17], v[16:17], v[228:229]
    v_pk_fma_f32 v[20:21], v[228:229], v[228:229], v[20:21]
    v_pk_add_f32 v[18:19], v[18:19], v[230:231]
    v_pk_fma_f32 v[22:23], v[230:231], v[230:231], v[22:23]
    v_pk_add_f32 v[16:17], v[16:17], v[232:233]
    v_pk_fma_f32 v[20:21], v[232:233], v[232:233], v[20:21]
    v_pk_add_f32 v[18:19], v[18:19], v[234:235]
    v_pk_fma_f32 v[22:23], v[234:235], v[234:235], v[22:23]
    v_pk_add_f32 v[16:17], v[16:17], v[18:19]
    v_pk_add_f32 v[20:21], v[20:21], v[22:23]
    v_add_f32 v16, v16, v17
    v_add_f32 v20, v20, v21
    v_mov_b32 v17, v16
    v_mov_b32 v21, v20
    s_nop 0
    v_permlane32_swap_b32 v16, v17
    v_permlane32_swap_b32 v20, v21
    v_add_f32 v16, v16, v17
    v_add_f32_e64 v20, v20, v21
    v_mul_f32 v16, 0x3c2aaaab, v16
    v_mul_f32 v20, 0x3c2aaaab, v20
    v_fma_f32 v20, -v16, v16, v20
    v_max_f32_e64 v20, 0, v20
    v_add_f32 v20, 0x3727c5ac, v20
    v_rsq_f32 v20, v20
    s_nop 0
    v_mul_f32 v18, 0xbeeff558, v20
    v_mul_f32 v19, -v16, v18
    v_pk_fma_f32 v[188:189], v[188:189], v[18:19], v[18:19] op_sel:[0,0,1] op_sel_hi:[1,0,1]
    v_pk_fma_f32 v[190:191], v[190:191], v[18:19], v[18:19] op_sel:[0,0,1] op_sel_hi:[1,0,1]
    v_pk_fma_f32 v[192:193], v[192:193], v[18:19], v[18:19] op_sel:[0,0,1] op_sel_hi:[1,0,1]
    v_pk_fma_f32 v[194:195], v[194:195], v[18:19], v[18:19] op_sel:[0,0,1] op_sel_hi:[1,0,1]
    v_pk_fma_f32 v[196:197], v[196:197], v[18:19], v[18:19] op_sel:[0,0,1] op_sel_hi:[1,0,1]
    v_pk_fma_f32 v[198:199], v[198:199], v[18:19], v[18:19] op_sel:[0,0,1] op_sel_hi:[1,0,1]
    v_pk_fma_f32 v[200:201], v[200:201], v[18:19], v[18:19] op_sel:[0,0,1] op_sel_hi:[1,0,1]
    v_pk_fma_f32 v[202:203], v[202:203], v[18:19], v[18:19] op_sel:[0,0,1] op_sel_hi:[1,0,1]
    v_pk_fma_f32 v[204:205], v[204:205], v[18:19], v[18:19] op_sel:[0,0,1] op_sel_hi:[1,0,1]
    v_pk_fma_f32 v[206:207], v[206:207], v[18:19], v[18:19] op_sel:[0,0,1] op_sel_hi:[1,0,1]
    v_pk_fma_f32 v[208:209], v[208:209], v[18:19], v[18:19] op_sel:[0,0,1] op_sel_hi:[1,0,1]
    v_pk_fma_f32 v[210:211], v[210:211], v[18:19], v[18:19] op_sel:[0,0,1] op_sel_hi:[1,0,1]
    v_pk_fma_f32 v[212:213], v[212:213], v[18:19], v[18:19] op_sel:[0,0,1] op_sel_hi:[1,0,1]
    v_pk_fma_f32 v[214:215], v[214:215], v[18:19], v[18:19] op_sel:[0,0,1] op_sel_hi:[1,0,1]
    v_pk_fma_f32 v[216:217], v[216:217], v[18:19], v[18:19] op_sel:[0,0,1] op_sel_hi:[1,0,1]
    v_pk_fma_f32 v[218:219], v[218:219], v[18:19], v[18:19] op_sel:[0,0,1] op_sel_hi:[1,0,1]
    v_pk_fma_f32 v[220:221], v[220:221], v[18:19], v[18:19] op_sel:[0,0,1] op_sel_hi:[1,0,1]
    v_pk_fma_f32 v[222:223], v[222:223], v[18:19], v[18:19] op_sel:[0,0,1] op_sel_hi:[1,0,1]
    v_pk_fma_f32 v[224:225], v[224:225], v[18:19], v[18:19] op_sel:[0,0,1] op_sel_hi:[1,0,1]
    v_pk_fma_f32 v[226:227], v[226:227], v[18:19], v[18:19] op_sel:[0,0,1] op_sel_hi:[1,0,1]
    v_pk_fma_f32 v[228:229], v[228:229], v[18:19], v[18:19] op_sel:[0,0,1] op_sel_hi:[1,0,1]
    v_pk_fma_f32 v[230:231], v[230:231], v[18:19], v[18:19] op_sel:[0,0,1] op_sel_hi:[1,0,1]
    v_pk_fma_f32 v[232:233], v[232:233], v[18:19], v[18:19] op_sel:[0,0,1] op_sel_hi:[1,0,1]
    v_pk_fma_f32 v[234:235], v[234:235], v[18:19], v[18:19] op_sel:[0,0,1] op_sel_hi:[1,0,1]
    v_mov_b32 v14, 163536
    s_mov_b32 s10, 0
L_aw3:
    ds_read_b32 v15, v14 offset:4
    s_add_u32 s10, s10, 1
    s_waitcnt lgkmcnt(0)
    v_readfirstlane_b32 s9, v15
    s_lshr_b32 s55, s10, 22
    s_lshl_b32 s55, s55, 3
    s_or_b32 s9, s9, s55
    s_cmp_lt_u32 s9, 4
    s_cbranch_scc1 L_aw3
    s_nop 0
    ds_read_b64_tr_b16 v[24:25], v248 offset:0
    ds_read_b64_tr_b16 v[26:27], v248 offset:6144
    ds_read_b64_tr_b16 v[28:29], v248 offset:1024
    ds_read_b64_tr_b16 v[30:31], v248 offset:7168
    ds_read_b64_tr_b16 v[32:33], v248 offset:2048
    ds_read_b64_tr_b16 v[34:35], v248 offset:8192
    ds_read_b64_tr_b16 v[252:253], v248 offset:3072
    ds_read_b64_tr_b16 v[254:255], v248 offset:9216
    v_cvt_pk_bf16_f32 v68, v188, v189
    v_cvt_pk_bf16_f32 v69, v190, v191
    v_cvt_pk_bf16_f32 v70, v192, v193
    v_cvt_pk_bf16_f32 v71, v194, v195
    v_cvt_pk_bf16_f32 v72, v196, v197
    v_cvt_pk_bf16_f32 v73, v198, v199
    v_cvt_pk_bf16_f32 v74, v200, v201
    v_cvt_pk_bf16_f32 v75, v202, v203
    s_waitcnt lgkmcnt(6)
    s_nop 0
    v_mfma_f32_32x32x16_bf16 v[36:51], v[68:71], v[24:27], 0
    ds_read_b64_tr_b16 v[24:25], v248 offset:4096
    ds_read_b64_tr_b16 v[26:27], v248 offset:10240
    v_cvt_pk_bf16_f32 v76, v204, v205
    v_cvt_pk_bf16_f32 v77, v206, v207
    v_cvt_pk_bf16_f32 v78, v208, v209
    v_cvt_pk_bf16_f32 v79, v210, v211
    s_waitcnt lgkmcnt(6)
    s_nop 0
    v_mfma_f32_32x32x16_bf16 v[36:51], v[72:75], v[28:31], v[36:51]
    ds_read_b64_tr_b16 v[28:29], v248 offset:5120
    ds_read_b64_tr_b16 v[30:31], v248 offset:11264
    v_cvt_pk_bf16_f32 v80, v212, v213
    v_cvt_pk_bf16_f32 v81, v214, v215
    v_cvt_pk_bf16_f32 v82, v216, v217
    v_cvt_pk_bf16_f32 v83, v218, v219
    s_waitcnt lgkmcnt(6)
    s_nop 0
    v_mfma_f32_32x32x16_bf16 v[36:51], v[76:79], v[32:35], v[36:51]
    ds_read_b64_tr_b16 v[32:33], v249 offset:0
    ds_read_b64_tr_b16 v[34:35], v249 offset:6144
    v_cvt_pk_bf16_f32 v84, v220, v221
    v_cvt_pk_bf16_f32 v85, v222, v223
    v_cvt_pk_bf16_f32 v86, v224, v225
    v_cvt_pk_bf16_f32 v87, v226, v227
    s_waitcnt lgkmcnt(6)
    s_nop 0
    v_mfma_f32_32x32x16_bf16 v[36:51], v[80:83], v[252:255], v[36:51]
    ds_read_b64_tr_b16 v[252:253], v249 offset:1024
    ds_read_b64_tr_b16 v[254:255], v249 offset:7168
    v_cvt_pk_bf16_f32 v88, v228, v229
    v_cvt_pk_bf16_f32 v89, v230, v231
    v_cvt_pk_bf16_f32 v90, v232, v233
    v_cvt_pk_bf16_f32 v91, v234, v235
    s_waitcnt lgkmcnt(6)
    v_mfma_f32_32x32x16_bf16 v[36:51], v[84:87], v[24:27], v[36:51]
    ds_read_b64_tr_b16 v[24:25], v249 offset:2048
    ds_read_b64_tr_b16 v[26:27], v249 offset:8192
    s_waitcnt lgkmcnt(6)
    v_mfma_f32_32x32x16_bf16 v[36:51], v[88:91], v[28:31], v[36:51]
    ds_read_b64_tr_b16 v[28:29], v249 offset:3072
    ds_read_b64_tr_b16 v[30:31], v249 offset:9216
    s_setprio 2
    s_nop 8
    v_pk_fma_f32 v[16:17], v[36:37], v[36:37], s[34:35]
    v_pk_fma_f32 v[18:19], v[38:39], v[38:39], s[34:35]
    v_pk_fma_f32 v[20:21], v[40:41], v[40:41], s[34:35]
    v_pk_fma_f32 v[22:23], v[42:43], v[42:43], s[34:35]
    v_pk_mul_f32 v[16:17], v[16:17], v[36:37]
    v_pk_mul_f32 v[18:19], v[18:19], v[38:39]
    v_pk_mul_f32 v[20:21], v[20:21], v[40:41]
    v_pk_mul_f32 v[22:23], v[22:23], v[42:43]
    s_waitcnt lgkmcnt(0)
    v_mfma_f32_32x32x16_bf16 v[52:67], v[68:71], v[32:35], 0
    v_exp_f32 v16, v16
    v_exp_f32 v17, v17
    v_exp_f32 v18, v18
    v_mfma_f32_32x32x16_bf16 v[52:67], v[72:75], v[252:255], v[52:67]
    v_exp_f32 v19, v19
    v_exp_f32 v20, v20
    v_exp_f32 v21, v21
    v_exp_f32 v22, v22
    v_exp_f32_e64 v23, v23
    v_pk_add_f32 v[16:17], v[16:17], 1.0 op_sel_hi:[1,0]
    v_pk_add_f32 v[18:19], v[18:19], 1.0 op_sel_hi:[1,0]
    v_pk_add_f32 v[20:21], v[20:21], 1.0 op_sel_hi:[1,0]
    v_pk_add_f32 v[22:23], v[22:23], 1.0 op_sel_hi:[1,0]
    ds_read_b64_tr_b16 v[32:33], v249 offset:4096
    ds_read_b64_tr_b16 v[34:35], v249 offset:10240
    ds_read_b64_tr_b16 v[252:253], v249 offset:5120
    ds_read_b64_tr_b16 v[254:255], v249 offset:11264
    v_mfma_f32_32x32x16_bf16 v[52:67], v[76:79], v[24:27], v[52:67]
    v_rcp_f32 v16, v16
    v_rcp_f32 v17, v17
    v_rcp_f32_e64 v18, v18
    v_mfma_f32_32x32x16_bf16 v[52:67], v[80:83], v[28:31], v[52:67]
    v_rcp_f32 v19, v19
    v_rcp_f32 v20, v20
    v_rcp_f32 v21, v21
    v_rcp_f32 v22, v22
    v_rcp_f32_e64 v23, v23
    v_pk_mul_f32 v[16:17], v[16:17], v[36:37]
    v_pk_mul_f32 v[18:19], v[18:19], v[38:39]
    v_pk_mul_f32 v[20:21], v[20:21], v[40:41]
    v_pk_mul_f32 v[22:23], v[22:23], v[42:43]
    v_cvt_pk_bf16_f32 v108, v16, v17
    v_cvt_pk_bf16_f32 v109, v18, v19
    v_cvt_pk_bf16_f32 v110, v20, v21
    v_cvt_pk_bf16_f32 v111, v22, v23
    v_dot2_f32_bf16 v11, v108, v108, 0
    v_dot2_f32_bf16 v11, v109, v109, v11
    v_dot2_f32_bf16 v11, v110, v110, v11
    v_dot2_f32_bf16 v11, v111, v111, v11
    v_pk_fma_f32 v[16:17], v[44:45], v[44:45], s[34:35]
    v_pk_fma_f32 v[18:19], v[46:47], v[46:47], s[34:35]
    v_pk_fma_f32 v[20:21], v[48:49], v[48:49], s[34:35]
    v_pk_fma_f32 v[22:23], v[50:51], v[50:51], s[34:35]
    v_pk_mul_f32 v[16:17], v[16:17], v[44:45]
    v_pk_mul_f32 v[18:19], v[18:19], v[46:47]
    v_pk_mul_f32 v[20:21], v[20:21], v[48:49]
    v_pk_mul_f32 v[22:23], v[22:23], v[50:51]
    s_waitcnt lgkmcnt(0)
    ds_read_b64_tr_b16 v[24:25], v248 offset:12288
    ds_read_b64_tr_b16 v[26:27], v248 offset:18432
    ds_read_b64_tr_b16 v[28:29], v248 offset:13312
    ds_read_b64_tr_b16 v[30:31], v248 offset:19456
    v_mfma_f32_32x32x16_bf16 v[52:67], v[84:87], v[32:35], v[52:67]
    v_exp_f32 v16, v16
    v_exp_f32 v17, v17
    v_exp_f32 v18, v18
    v_mfma_f32_32x32x16_bf16 v[52:67], v[88:91], v[252:255], v[52:67]
    v_exp_f32 v19, v19
    v_exp_f32 v20, v20
    v_exp_f32 v21, v21
    v_exp_f32 v22, v22
    v_exp_f32_e64 v23, v23
    v_pk_add_f32 v[16:17], v[16:17], 1.0 op_sel_hi:[1,0]
    v_pk_add_f32 v[18:19], v[18:19], 1.0 op_sel_hi:[1,0]
    v_pk_add_f32 v[20:21], v[20:21], 1.0 op_sel_hi:[1,0]
    v_pk_add_f32 v[22:23], v[22:23], 1.0 op_sel_hi:[1,0]
    ds_read_b64_tr_b16 v[32:33], v248 offset:14336
    ds_read_b64_tr_b16 v[34:35], v248 offset:20480
    ds_read_b64_tr_b16 v[252:253], v248 offset:15360
    ds_read_b64_tr_b16 v[254:255], v248 offset:21504
    v_rcp_f32 v16, v16
    v_rcp_f32 v17, v17
    v_rcp_f32 v18, v18
    v_rcp_f32 v19, v19
    v_rcp_f32 v20, v20
    v_rcp_f32 v21, v21
    v_rcp_f32 v22, v22
    v_rcp_f32 v23, v23
    v_pk_mul_f32 v[16:17], v[16:17], v[44:45]
    v_pk_mul_f32 v[18:19], v[18:19], v[46:47]
    v_pk_mul_f32 v[20:21], v[20:21], v[48:49]
    v_pk_mul_f32 v[22:23], v[22:23], v[50:51]
    v_cvt_pk_bf16_f32 v112, v16, v17
    v_cvt_pk_bf16_f32 v113, v18, v19
    v_cvt_pk_bf16_f32 v114, v20, v21
    v_cvt_pk_bf16_f32 v115, v22, v23
    v_dot2_f32_bf16 v11, v112, v112, v11
    v_dot2_f32_bf16 v11, v113, v113, v11
    v_dot2_f32_bf16 v11, v114, v114, v11
    v_dot2_f32_bf16 v11, v115, v115, v11
    v_pk_fma_f32 v[16:17], v[52:53], v[52:53], s[34:35]
    v_pk_fma_f32 v[18:19], v[54:55], v[54:55], s[34:35]
    v_pk_fma_f32 v[20:21], v[56:57], v[56:57], s[34:35]
    v_pk_fma_f32 v[22:23], v[58:59], v[58:59], s[34:35]
    v_pk_mul_f32 v[16:17], v[16:17], v[52:53]
    v_pk_mul_f32 v[18:19], v[18:19], v[54:55]
    v_pk_mul_f32 v[20:21], v[20:21], v[56:57]
    v_pk_mul_f32 v[22:23], v[22:23], v[58:59]
    v_cvt_f64_f32 v[12:13], v11
    s_waitcnt lgkmcnt(0)
    v_mfma_f32_32x32x16_bf16 v[36:51], v[68:71], v[24:27], 0
    v_exp_f32 v16, v16
    v_exp_f32 v17, v17
    v_exp_f32_e64 v18, v18
    v_mfma_f32_32x32x16_bf16 v[36:51], v[72:75], v[28:31], v[36:51]
    v_exp_f32 v19, v19
    v_exp_f32 v20, v20
    v_exp_f32 v21, v21
    v_exp_f32 v22, v22
    v_exp_f32_e64 v23, v23
    v_pk_add_f32 v[16:17], v[16:17], 1.0 op_sel_hi:[1,0]
    v_pk_add_f32 v[18:19], v[18:19], 1.0 op_sel_hi:[1,0]
    v_pk_add_f32 v[20:21], v[20:21], 1.0 op_sel_hi:[1,0]
    v_pk_add_f32 v[22:23], v[22:23], 1.0 op_sel_hi:[1,0]
    ds_read_b64_tr_b16 v[24:25], v248 offset:16384
    ds_read_b64_tr_b16 v[26:27], v248 offset:22528
    ds_read_b64_tr_b16 v[28:29], v248 offset:17408
    ds_read_b64_tr_b16 v[30:31], v248 offset:23552
    ds_add_f64 v250, v[12:13] offset:0
    v_mfma_f32_32x32x16_bf16 v[36:51], v[76:79], v[32:35], v[36:51]
    v_rcp_f32 v16, v16
    v_rcp_f32 v17, v17
    v_rcp_f32_e64 v18, v18
    v_mfma_f32_32x32x16_bf16 v[36:51], v[80:83], v[252:255], v[36:51]
    v_rcp_f32 v19, v19
    v_rcp_f32 v20, v20
    v_rcp_f32 v21, v21
    v_rcp_f32 v22, v22
    v_rcp_f32_e64 v23, v23
    v_pk_mul_f32 v[16:17], v[16:17], v[52:53]
    v_pk_mul_f32 v[18:19], v[18:19], v[54:55]
    v_pk_mul_f32 v[20:21], v[20:21], v[56:57]
    v_pk_mul_f32 v[22:23], v[22:23], v[58:59]
    v_cvt_pk_bf16_f32 v116, v16, v17
    v_cvt_pk_bf16_f32 v117, v18, v19
    v_cvt_pk_bf16_f32 v118, v20, v21
    v_cvt_pk_bf16_f32 v119, v22, v23
    v_dot2_f32_bf16 v11, v116, v116, 0
    v_dot2_f32_bf16 v11, v117, v117, v11
    v_dot2_f32_bf16 v11, v118, v118, v11
    v_dot2_f32_bf16 v11, v119, v119, v11
    v_pk_fma_f32 v[16:17], v[60:61], v[60:61], s[34:35]
    v_pk_fma_f32 v[18:19], v[62:63], v[62:63], s[34:35]
    v_pk_fma_f32 v[20:21], v[64:65], v[64:65], s[34:35]
    v_pk_fma_f32 v[22:23], v[66:67], v[66:67], s[34:35]
    v_pk_mul_f32 v[16:17], v[16:17], v[60:61]
    v_pk_mul_f32 v[18:19], v[18:19], v[62:63]
    v_pk_mul_f32 v[20:21], v[20:21], v[64:65]
    v_pk_mul_f32 v[22:23], v[22:23], v[66:67]
    s_waitcnt lgkmcnt(1)
    ds_read_b64_tr_b16 v[32:33], v249 offset:12288
    ds_read_b64_tr_b16 v[34:35], v249 offset:18432
    ds_read_b64_tr_b16 v[252:253], v249 offset:13312
    ds_read_b64_tr_b16 v[254:255], v249 offset:19456
    v_mfma_f32_32x32x16_bf16 v[36:51], v[84:87], v[24:27], v[36:51]
    v_exp_f32 v16, v16
    v_exp_f32 v17, v17
    v_exp_f32 v18, v18
    v_mfma_f32_32x32x16_bf16 v[36:51], v[88:91], v[28:31], v[36:51]
    v_exp_f32 v19, v19
    v_exp_f32 v20, v20
    v_exp_f32 v21, v21
    v_exp_f32 v22, v22
    v_exp_f32_e64 v23, v23
    v_pk_add_f32 v[16:17], v[16:17], 1.0 op_sel_hi:[1,0]
    v_pk_add_f32 v[18:19], v[18:19], 1.0 op_sel_hi:[1,0]
    v_pk_add_f32 v[20:21], v[20:21], 1.0 op_sel_hi:[1,0]
    v_pk_add_f32 v[22:23], v[22:23], 1.0 op_sel_hi:[1,0]
    ds_read_b64_tr_b16 v[24:25], v249 offset:14336
    ds_read_b64_tr_b16 v[26:27], v249 offset:20480
    ds_read_b64_tr_b16 v[28:29], v249 offset:15360
    ds_read_b64_tr_b16 v[30:31], v249 offset:21504
    v_rcp_f32 v16, v16
    v_rcp_f32 v17, v17
    v_rcp_f32 v18, v18
    v_rcp_f32 v19, v19
    v_rcp_f32 v20, v20
    v_rcp_f32 v21, v21
    v_rcp_f32 v22, v22
    v_rcp_f32 v23, v23
    v_pk_mul_f32 v[16:17], v[16:17], v[60:61]
    v_pk_mul_f32 v[18:19], v[18:19], v[62:63]
    v_pk_mul_f32 v[20:21], v[20:21], v[64:65]
    v_pk_mul_f32 v[22:23], v[22:23], v[66:67]
    v_cvt_pk_bf16_f32 v120, v16, v17
    v_cvt_pk_bf16_f32 v121, v18, v19
    v_cvt_pk_bf16_f32 v122, v20, v21
    v_cvt_pk_bf16_f32 v123, v22, v23
    v_dot2_f32_bf16 v11, v120, v120, v11
    v_dot2_f32_bf16 v11, v121, v121, v11
    v_dot2_f32_bf16 v11, v122, v122, v11
    v_dot2_f32_bf16 v11, v123, v123, v11
    v_mov_b32 v14, 163536
    v_mov_b32 v15, 1
    s_mov_b64 exec, 1
    ds_add_u32 v14, v15 offset:16
    s_mov_b64 exec, -1
    s_nop 0
    v_pk_fma_f32 v[16:17], v[36:37], v[36:37], s[34:35]
    v_pk_fma_f32 v[18:19], v[38:39], v[38:39], s[34:35]
    v_pk_fma_f32 v[20:21], v[40:41], v[40:41], s[34:35]
    v_pk_fma_f32 v[22:23], v[42:43], v[42:43], s[34:35]
    v_pk_mul_f32 v[16:17], v[16:17], v[36:37]
    v_pk_mul_f32 v[18:19], v[18:19], v[38:39]
    v_pk_mul_f32 v[20:21], v[20:21], v[40:41]
    v_pk_mul_f32 v[22:23], v[22:23], v[42:43]
    v_cvt_f64_f32 v[12:13], v11
    s_waitcnt lgkmcnt(1)
    v_mfma_f32_32x32x16_bf16 v[52:67], v[68:71], v[32:35], 0
    v_exp_f32 v16, v16
    v_exp_f32 v17, v17
    v_exp_f32_e64 v18, v18
    v_mfma_f32_32x32x16_bf16 v[52:67], v[72:75], v[252:255], v[52:67]
    v_exp_f32 v19, v19
    v_exp_f32 v20, v20
    v_exp_f32 v21, v21
    v_exp_f32 v22, v22
    v_exp_f32_e64 v23, v23
    v_pk_add_f32 v[16:17], v[16:17], 1.0 op_sel_hi:[1,0]
    v_pk_add_f32 v[18:19], v[18:19], 1.0 op_sel_hi:[1,0]
    v_pk_add_f32 v[20:21], v[20:21], 1.0 op_sel_hi:[1,0]
    v_pk_add_f32 v[22:23], v[22:23], 1.0 op_sel_hi:[1,0]
    ds_read_b64_tr_b16 v[32:33], v249 offset:16384
    ds_read_b64_tr_b16 v[34:35], v249 offset:22528
    ds_read_b64_tr_b16 v[252:253], v249 offset:17408
    ds_read_b64_tr_b16 v[254:255], v249 offset:23552
    ds_add_f64 v250, v[12:13] offset:256
    v_mfma_f32_32x32x16_bf16 v[52:67], v[76:79], v[24:27], v[52:67]
    v_rcp_f32 v16, v16
    v_rcp_f32 v17, v17
    v_rcp_f32_e64 v18, v18
    v_mfma_f32_32x32x16_bf16 v[52:67], v[80:83], v[28:31], v[52:67]
    v_rcp_f32 v19, v19
    v_rcp_f32 v20, v20
    v_rcp_f32 v21, v21
    v_rcp_f32 v22, v22
    v_rcp_f32_e64 v23, v23
    v_pk_mul_f32 v[16:17], v[16:17], v[36:37]
    v_pk_mul_f32 v[18:19], v[18:19], v[38:39]
    v_pk_mul_f32 v[20:21], v[20:21], v[40:41]
    v_pk_mul_f32 v[22:23], v[22:23], v[42:43]
    v_cvt_pk_bf16_f32 v156, v16, v17
    v_cvt_pk_bf16_f32 v157, v18, v19
    v_cvt_pk_bf16_f32 v158, v20, v21
    v_cvt_pk_bf16_f32 v159, v22, v23
    v_dot2_f32_bf16 v11, v156, v156, 0
    v_dot2_f32_bf16 v11, v157, v157, v11
    v_dot2_f32_bf16 v11, v158, v158, v11
    v_dot2_f32_bf16 v11, v159, v159, v11
    v_pk_fma_f32 v[16:17], v[44:45], v[44:45], s[34:35]
    v_pk_fma_f32 v[18:19], v[46:47], v[46:47], s[34:35]
    v_pk_fma_f32 v[20:21], v[48:49], v[48:49], s[34:35]
    v_pk_fma_f32 v[22:23], v[50:51], v[50:51], s[34:35]
    v_pk_mul_f32 v[16:17], v[16:17], v[44:45]
    v_pk_mul_f32 v[18:19], v[18:19], v[46:47]
    v_pk_mul_f32 v[20:21], v[20:21], v[48:49]
    v_pk_mul_f32 v[22:23], v[22:23], v[50:51]
    s_waitcnt lgkmcnt(1)
    ds_read_b64_tr_b16 v[24:25], v248 offset:24576
    ds_read_b64_tr_b16 v[26:27], v248 offset:30720
    ds_read_b64_tr_b16 v[28:29], v248 offset:25600
    ds_read_b64_tr_b16 v[30:31], v248 offset:31744
    v_mfma_f32_32x32x16_bf16 v[52:67], v[84:87], v[32:35], v[52:67]
    v_exp_f32 v16, v16
    v_exp_f32 v17, v17
    v_exp_f32 v18, v18
    v_mfma_f32_32x32x16_bf16 v[52:67], v[88:91], v[252:255], v[52:67]
    v_exp_f32 v19, v19
    v_exp_f32 v20, v20
    v_exp_f32 v21, v21
    v_exp_f32 v22, v22
    v_exp_f32_e64 v23, v23
    v_pk_add_f32 v[16:17], v[16:17], 1.0 op_sel_hi:[1,0]
    v_pk_add_f32 v[18:19], v[18:19], 1.0 op_sel_hi:[1,0]
    v_pk_add_f32 v[20:21], v[20:21], 1.0 op_sel_hi:[1,0]
    v_pk_add_f32 v[22:23], v[22:23], 1.0 op_sel_hi:[1,0]
    ds_read_b64_tr_b16 v[32:33], v248 offset:26624
    ds_read_b64_tr_b16 v[34:35], v248 offset:32768
    ds_read_b64_tr_b16 v[252:253], v248 offset:27648
    ds_read_b64_tr_b16 v[254:255], v248 offset:33792
    v_rcp_f32 v16, v16
    v_rcp_f32 v17, v17
    v_rcp_f32 v18, v18
    v_rcp_f32 v19, v19
    v_rcp_f32 v20, v20
    v_rcp_f32 v21, v21
    v_rcp_f32 v22, v22
    v_rcp_f32 v23, v23
    v_pk_mul_f32 v[16:17], v[16:17], v[44:45]
    v_pk_mul_f32 v[18:19], v[18:19], v[46:47]
    v_pk_mul_f32 v[20:21], v[20:21], v[48:49]
    v_pk_mul_f32 v[22:23], v[22:23], v[50:51]
    v_cvt_pk_bf16_f32 v160, v16, v17
    v_cvt_pk_bf16_f32 v161, v18, v19
    v_cvt_pk_bf16_f32 v162, v20, v21
    v_cvt_pk_bf16_f32 v163, v22, v23
    v_dot2_f32_bf16 v11, v160, v160, v11
    v_dot2_f32_bf16 v11, v161, v161, v11
    v_dot2_f32_bf16 v11, v162, v162, v11
    v_dot2_f32_bf16 v11, v163, v163, v11
    v_mov_b32 v14, 163536
    s_mov_b32 s10, 0
L_aw4:
    ds_read_b32 v15, v14 offset:32
    s_add_u32 s10, s10, 1
    s_waitcnt lgkmcnt(0)
    v_readfirstlane_b32 s9, v15
    s_lshr_b32 s55, s10, 22
    s_lshl_b32 s55, s55, 3
    s_or_b32 s9, s9, s55
    s_cmp_lt_u32 s9, 4
    s_cbranch_scc1 L_aw4
    s_nop 0
    v_pk_fma_f32 v[16:17], v[52:53], v[52:53], s[34:35]
    v_pk_fma_f32 v[18:19], v[54:55], v[54:55], s[34:35]
    v_pk_fma_f32 v[20:21], v[56:57], v[56:57], s[34:35]
    v_pk_fma_f32 v[22:23], v[58:59], v[58:59], s[34:35]
    v_pk_mul_f32 v[16:17], v[16:17], v[52:53]
    v_pk_mul_f32 v[18:19], v[18:19], v[54:55]
    v_pk_mul_f32 v[20:21], v[20:21], v[56:57]
    v_pk_mul_f32 v[22:23], v[22:23], v[58:59]
    v_cvt_f64_f32_e64 v[12:13], v11
    ds_read_b128 v[92:95], v2 offset:0
    ds_read_b128 v[96:99], v3 offset:0
    ds_read_b128 v[100:103], v2 offset:400
    ds_read_b128 v[104:107], v4 offset:0
    ds_read_b128 v[140:143], v2 offset:800
    ds_read_b128 v[144:147], v5 offset:0
    v_mfma_f32_32x32x16_bf16 v[36:51], v[68:71], v[24:27], 0
    v_exp_f32 v16, v16
    v_exp_f32 v17, v17
    v_exp_f32_e64 v18, v18
    v_mfma_f32_32x32x16_bf16 v[36:51], v[72:75], v[28:31], v[36:51]
    v_exp_f32 v19, v19
    v_exp_f32 v20, v20
    v_exp_f32 v21, v21
    v_exp_f32 v22, v22
    v_exp_f32_e64 v23, v23
    v_pk_add_f32 v[16:17], v[16:17], 1.0 op_sel_hi:[1,0]
    v_pk_add_f32 v[18:19], v[18:19], 1.0 op_sel_hi:[1,0]
    v_pk_add_f32 v[20:21], v[20:21], 1.0 op_sel_hi:[1,0]
    v_pk_add_f32 v[22:23], v[22:23], 1.0 op_sel_hi:[1,0]
    ds_read_b64_tr_b16 v[24:25], v248 offset:28672
    ds_read_b64_tr_b16 v[26:27], v248 offset:34816
    ds_read_b64_tr_b16 v[28:29], v248 offset:29696
    ds_read_b64_tr_b16 v[30:31], v248 offset:35840
    ds_add_f64 v250, v[12:13] offset:512
    ds_read_b128 v[148:151], v2 offset:1200
    ds_read_b128 v[152:155], v3 offset:16
    ds_read_b128 v[172:175], v2 offset:1600
    ds_read_b128 v[176:179], v4 offset:16
    s_waitcnt lgkmcnt(14)
    ds_read_b128 v[180:183], v2 offset:2000
    s_waitcnt lgkmcnt(14)
    ds_read_b128 v[184:187], v5 offset:16
    v_mfma_f32_32x32x16_bf16 v[36:51], v[76:79], v[32:35], v[36:51]
    v_rcp_f32 v16, v16
    v_rcp_f32 v17, v17
    v_rcp_f32_e64 v18, v18
    v_mfma_f32_32x32x16_bf16 v[36:51], v[80:83], v[252:255], v[36:51]
    v_rcp_f32 v19, v19
    v_rcp_f32 v20, v20
    v_rcp_f32 v21, v21
    v_rcp_f32 v22, v22
    v_rcp_f32_e64 v23, v23
    v_pk_mul_f32 v[16:17], v[16:17], v[52:53]
    v_pk_mul_f32 v[18:19], v[18:19], v[54:55]
    v_pk_mul_f32 v[20:21], v[20:21], v[56:57]
    v_pk_mul_f32 v[22:23], v[22:23], v[58:59]
    v_cvt_pk_bf16_f32 v164, v16, v17
    v_cvt_pk_bf16_f32 v165, v18, v19
    v_cvt_pk_bf16_f32 v166, v20, v21
    v_cvt_pk_bf16_f32 v167, v22, v23
    v_dot2_f32_bf16 v11, v164, v164, 0
    v_dot2_f32_bf16 v11, v165, v165, v11
    v_dot2_f32_bf16 v11, v166, v166, v11
    v_dot2_f32_bf16 v11, v167, v167, v11
    v_pk_fma_f32 v[16:17], v[60:61], v[60:61], s[34:35]
    v_pk_fma_f32 v[18:19], v[62:63], v[62:63], s[34:35]
    v_pk_fma_f32 v[20:21], v[64:65], v[64:65], s[34:35]
    v_pk_fma_f32 v[22:23], v[66:67], v[66:67], s[34:35]
    v_pk_mul_f32 v[16:17], v[16:17], v[60:61]
    v_pk_mul_f32 v[18:19], v[18:19], v[62:63]
    v_pk_mul_f32 v[20:21], v[20:21], v[64:65]
    v_pk_mul_f32 v[22:23], v[22:23], v[66:67]
    s_waitcnt lgkmcnt(7)
    s_waitcnt lgkmcnt(0)
    ds_read_b64_tr_b16 v[32:33], v249 offset:24576
    ds_read_b64_tr_b16 v[34:35], v249 offset:30720
    ds_read_b64_tr_b16 v[252:253], v249 offset:25600
    ds_read_b64_tr_b16 v[254:255], v249 offset:31744
    v_mfma_f32_32x32x16_bf16 v[36:51], v[84:87], v[24:27], v[36:51]
    v_exp_f32 v16, v16
    v_exp_f32 v17, v17
    v_exp_f32_e64 v18, v18
    v_mfma_f32_32x32x16_bf16 v[36:51], v[88:91], v[28:31], v[36:51]
    v_exp_f32 v19, v19
    v_exp_f32 v20, v20
    v_exp_f32 v21, v21
    v_exp_f32 v22, v22
    v_exp_f32_e64 v23, v23
    v_pk_add_f32 v[16:17], v[16:17], 1.0 op_sel_hi:[1,0]
    v_pk_add_f32 v[18:19], v[18:19], 1.0 op_sel_hi:[1,0]
    v_pk_add_f32 v[20:21], v[20:21], 1.0 op_sel_hi:[1,0]
    v_pk_add_f32 v[22:23], v[22:23], 1.0 op_sel_hi:[1,0]
    ds_read_b64_tr_b16 v[24:25], v249 offset:26624
    ds_read_b64_tr_b16 v[26:27], v249 offset:32768
    ds_read_b64_tr_b16 v[28:29], v249 offset:27648
    ds_read_b64_tr_b16 v[30:31], v249 offset:33792
    v_mfma_f32_16x16x32_bf16 v[188:191], v[92:95], v[96:99], 0
    v_rcp_f32_e64 v16, v16
    v_mfma_f32_16x16x32_bf16 v[188:191], v[100:103], v[104:107], v[188:191]
    v_rcp_f32_e64 v17, v17
    v_mfma_f32_16x16x32_bf16 v[188:191], v[140:143], v[144:147], v[188:191]
    v_rcp_f32_e64 v18, v18
    v_mfma_f32_16x16x32_bf16 v[192:195], v[148:151], v[152:155], 0
    v_rcp_f32_e64 v19, v19
    v_mfma_f32_16x16x32_bf16 v[192:195], v[172:175], v[176:179], v[192:195]
    v_rcp_f32_e64 v20, v20
    v_mfma_f32_16x16x32_bf16 v[192:195], v[180:183], v[184:187], v[192:195]
    v_rcp_f32 v21, v21
    v_rcp_f32 v22, v22
    v_rcp_f32_e64 v23, v23
    v_pk_mul_f32 v[16:17], v[16:17], v[60:61]
    v_pk_mul_f32 v[18:19], v[18:19], v[62:63]
    v_pk_mul_f32 v[20:21], v[20:21], v[64:65]
    v_pk_mul_f32 v[22:23], v[22:23], v[66:67]
    v_cvt_pk_bf16_f32 v168, v16, v17
    v_cvt_pk_bf16_f32 v169, v18, v19
    v_cvt_pk_bf16_f32 v170, v20, v21
    v_cvt_pk_bf16_f32 v171, v22, v23
    v_dot2_f32_bf16 v11, v168, v168, v11
    v_dot2_f32_bf16 v11, v169, v169, v11
    v_dot2_f32_bf16 v11, v170, v170, v11
    v_dot2_f32_bf16 v11, v171, v171, v11
    v_mov_b32 v14, 163536
    v_mov_b32 v15, 1
    s_mov_b64 exec, 1
    ds_add_u32 v14, v15 offset:20
    s_mov_b64 exec, -1
    v_mov_b32 v14, 163536
    s_mov_b32 s10, 0
L_aw5:
    ds_read_b32 v15, v14 offset:28
    s_add_u32 s10, s10, 1
    s_waitcnt lgkmcnt(0)
    v_readfirstlane_b32 s9, v15
    s_lshr_b32 s55, s10, 22
    s_lshl_b32 s55, s55, 3
    s_or_b32 s9, s9, s55
    s_cmp_lt_u32 s9, 4
    s_cbranch_scc1 L_aw5
    v_pk_fma_f32 v[16:17], v[36:37], v[36:37], s[34:35]
    v_pk_fma_f32 v[18:19], v[38:39], v[38:39], s[34:35]
    v_pk_fma_f32 v[20:21], v[40:41], v[40:41], s[34:35]
    v_pk_fma_f32 v[22:23], v[42:43], v[42:43], s[34:35]
    v_pk_mul_f32 v[16:17], v[16:17], v[36:37]
    v_pk_mul_f32 v[18:19], v[18:19], v[38:39]
    v_pk_mul_f32 v[20:21], v[20:21], v[40:41]
    v_pk_mul_f32 v[22:23], v[22:23], v[42:43]
    v_cvt_f64_f32_e64 v[12:13], v11
    ds_read_b128 v[92:95], v2 offset:2400
    ds_read_b128 v[96:99], v3 offset:32
    ds_read_b128 v[100:103], v2 offset:2800
    ds_read_b128 v[104:107], v4 offset:32
    ds_read_b128 v[140:143], v2 offset:3200
    ds_read_b128 v[144:147], v5 offset:32
    v_mfma_f32_32x32x16_bf16 v[52:67], v[68:71], v[32:35], 0
    v_exp_f32 v16, v16
    v_exp_f32 v17, v17
    v_exp_f32_e64 v18, v18
    v_mfma_f32_32x32x16_bf16 v[52:67], v[72:75], v[252:255], v[52:67]
    v_exp_f32 v19, v19
    v_exp_f32 v20, v20
    v_exp_f32 v21, v21
    v_exp_f32 v22, v22
    v_exp_f32_e64 v23, v23
    v_pk_add_f32 v[16:17], v[16:17], 1.0 op_sel_hi:[1,0]
    v_pk_add_f32 v[18:19], v[18:19], 1.0 op_sel_hi:[1,0]
    v_pk_add_f32 v[20:21], v[20:21], 1.0 op_sel_hi:[1,0]
    v_pk_add_f32 v[22:23], v[22:23], 1.0 op_sel_hi:[1,0]
    ds_read_b64_tr_b16 v[32:33], v249 offset:28672
    ds_read_b64_tr_b16 v[34:35], v249 offset:34816
    ds_read_b64_tr_b16 v[252:253], v249 offset:29696
    ds_read_b64_tr_b16 v[254:255], v249 offset:35840
    ds_add_f64 v250, v[12:13] offset:768
    ds_read_b128 v[148:151], v2 offset:3600
    ds_read_b128 v[152:155], v3 offset:48
    ds_read_b128 v[172:175], v2 offset:4000
    ds_read_b128 v[176:179], v4 offset:48
    s_waitcnt lgkmcnt(14)
    ds_read_b128 v[180:183], v2 offset:4400
    s_waitcnt lgkmcnt(14)
    ds_read_b128 v[184:187], v5 offset:48
    v_mfma_f32_32x32x16_bf16 v[52:67], v[76:79], v[24:27], v[52:67]
    v_rcp_f32 v16, v16
    v_rcp_f32 v17, v17
    v_rcp_f32_e64 v18, v18
    v_mfma_f32_32x32x16_bf16 v[52:67], v[80:83], v[28:31], v[52:67]
    v_rcp_f32 v19, v19
    v_rcp_f32 v20, v20
    v_rcp_f32 v21, v21
    v_rcp_f32 v22, v22
    v_rcp_f32_e64 v23, v23
    v_pk_mul_f32 v[16:17], v[16:17], v[36:37]
    v_pk_mul_f32 v[18:19], v[18:19], v[38:39]
    v_pk_mul_f32 v[20:21], v[20:21], v[40:41]
    v_pk_mul_f32 v[22:23], v[22:23], v[42:43]
    v_cvt_pk_bf16_f32 v124, v16, v17
    v_cvt_pk_bf16_f32 v125, v18, v19
    v_cvt_pk_bf16_f32 v126, v20, v21
    v_cvt_pk_bf16_f32 v127, v22, v23
    v_dot2_f32_bf16 v11, v124, v124, 0
    v_dot2_f32_bf16 v11, v125, v125, v11
    v_dot2_f32_bf16 v11, v126, v126, v11
    v_dot2_f32_bf16 v11, v127, v127, v11
    v_pk_fma_f32 v[16:17], v[44:45], v[44:45], s[34:35]
    v_pk_fma_f32 v[18:19], v[46:47], v[46:47], s[34:35]
    v_pk_fma_f32 v[20:21], v[48:49], v[48:49], s[34:35]
    v_pk_fma_f32 v[22:23], v[50:51], v[50:51], s[34:35]
    v_pk_mul_f32 v[16:17], v[16:17], v[44:45]
    v_pk_mul_f32 v[18:19], v[18:19], v[46:47]
    v_pk_mul_f32 v[20:21], v[20:21], v[48:49]
    v_pk_mul_f32 v[22:23], v[22:23], v[50:51]
    s_waitcnt lgkmcnt(7)
    s_waitcnt lgkmcnt(0)
    ds_read_b128 v[24:27], v6 offset:0
    ds_read_b128 v[28:31], v6 offset:1024
    v_mfma_f32_32x32x16_bf16 v[52:67], v[84:87], v[32:35], v[52:67]
    v_exp_f32 v16, v16
    v_exp_f32 v17, v17
    v_exp_f32_e64 v18, v18
    v_mfma_f32_32x32x16_bf16 v[52:67], v[88:91], v[252:255], v[52:67]
    v_exp_f32 v19, v19
    v_exp_f32 v20, v20
    v_exp_f32 v21, v21
    v_exp_f32 v22, v22
    v_exp_f32_e64 v23, v23
    v_pk_add_f32 v[16:17], v[16:17], 1.0 op_sel_hi:[1,0]
    v_pk_add_f32 v[18:19], v[18:19], 1.0 op_sel_hi:[1,0]
    v_pk_add_f32 v[20:21], v[20:21], 1.0 op_sel_hi:[1,0]
    v_pk_add_f32 v[22:23], v[22:23], 1.0 op_sel_hi:[1,0]
    ds_read_b128 v[32:35], v6 offset:2048
    ds_read_b128 v[252:255], v6 offset:3072
    v_mfma_f32_16x16x32_bf16 v[196:199], v[92:95], v[96:99], 0
    v_rcp_f32_e64 v16, v16
    v_mfma_f32_16x16x32_bf16 v[196:199], v[100:103], v[104:107], v[196:199]
    v_rcp_f32_e64 v17, v17
    v_mfma_f32_16x16x32_bf16 v[196:199], v[140:143], v[144:147], v[196:199]
    v_rcp_f32_e64 v18, v18
    v_mfma_f32_16x16x32_bf16 v[200:203], v[148:151], v[152:155], 0
    v_rcp_f32_e64 v19, v19
    v_mfma_f32_16x16x32_bf16 v[200:203], v[172:175], v[176:179], v[200:203]
    v_rcp_f32_e64 v20, v20
    v_mfma_f32_16x16x32_bf16 v[200:203], v[180:183], v[184:187], v[200:203]
    v_rcp_f32 v21, v21
    v_rcp_f32 v22, v22
    v_rcp_f32_e64 v23, v23
    v_pk_mul_f32 v[16:17], v[16:17], v[44:45]
    v_pk_mul_f32 v[18:19], v[18:19], v[46:47]
    v_pk_mul_f32 v[20:21], v[20:21], v[48:49]
    v_pk_mul_f32 v[22:23], v[22:23], v[50:51]
    v_cvt_pk_bf16_f32 v128, v16, v17
    v_cvt_pk_bf16_f32 v129, v18, v19
    v_cvt_pk_bf16_f32 v130, v20, v21
    v_cvt_pk_bf16_f32 v131, v22, v23
    v_dot2_f32_bf16 v11, v128, v128, v11
    v_dot2_f32_bf16 v11, v129, v129, v11
    v_dot2_f32_bf16 v11, v130, v130, v11
    v_dot2_f32_bf16 v11, v131, v131, v11
    s_setprio 3
    s_nop 0
    ds_read_b128 v[92:95], v2 offset:4800
    ds_read_b128 v[96:99], v3 offset:64
    ds_read_b128 v[100:103], v2 offset:5200
    ds_read_b128 v[104:107], v4 offset:64
    ds_read_b128 v[140:143], v2 offset:5600
    ds_read_b128 v[144:147], v5 offset:64
    ds_read_b128 v[148:151], v2 offset:6000
    ds_read_b128 v[152:155], v3 offset:80
    ds_read_b128 v[172:175], v2 offset:6400
    ds_read_b128 v[176:179], v4 offset:80
    ds_read_b128 v[180:183], v2 offset:6800
    s_waitcnt lgkmcnt(14)
    ds_read_b128 v[184:187], v5 offset:80
    s_waitcnt lgkmcnt(0)
    v_mfma_f32_16x16x32_bf16 v[204:207], v[92:95], v[96:99], 0
    ds_read_b128 v[92:95], v2 offset:7200
    ds_read_b128 v[96:99], v3 offset:96
    v_mfma_f32_16x16x32_bf16 v[204:207], v[100:103], v[104:107], v[204:207]
    ds_read_b128 v[100:103], v2 offset:7600
    ds_read_b128 v[104:107], v4 offset:96
    v_mfma_f32_16x16x32_bf16 v[204:207], v[140:143], v[144:147], v[204:207]
    ds_read_b128 v[140:143], v2 offset:8000
    ds_read_b128 v[144:147], v5 offset:96
    v_mfma_f32_16x16x32_bf16 v[208:211], v[148:151], v[152:155], 0
    ds_read_b128 v[148:151], v2 offset:8400
    ds_read_b128 v[152:155], v3 offset:112
    v_mfma_f32_16x16x32_bf16 v[208:211], v[172:175], v[176:179], v[208:211]
    ds_read_b128 v[172:175], v2 offset:8800
    ds_read_b128 v[176:179], v4 offset:112
    v_mfma_f32_16x16x32_bf16 v[208:211], v[180:183], v[184:187], v[208:211]
    ds_read_b128 v[180:183], v2 offset:9200
    ds_read_b128 v[184:187], v5 offset:112
    s_waitcnt lgkmcnt(0)
    s_nop 0
    v_mfma_f32_16x16x32_bf16 v[212:215], v[92:95], v[96:99], 0
    ds_read_b128 v[92:95], v2 offset:9600
    ds_read_b128 v[96:99], v3 offset:128
    v_mfma_f32_16x16x32_bf16 v[212:215], v[100:103], v[104:107], v[212:215]
    ds_read_b128 v[100:103], v2 offset:10000
    ds_read_b128 v[104:107], v4 offset:128
    v_mfma_f32_16x16x32_bf16 v[212:215], v[140:143], v[144:147], v[212:215]
    ds_read_b128 v[140:143], v2 offset:10400
    ds_read_b128 v[144:147], v5 offset:128
    v_mfma_f32_16x16x32_bf16 v[216:219], v[148:151], v[152:155], 0
    ds_read_b128 v[148:151], v2 offset:10800
    ds_read_b128 v[152:155], v3 offset:144
    v_mfma_f32_16x16x32_bf16 v[216:219], v[172:175], v[176:179], v[216:219]
    ds_read_b128 v[172:175], v2 offset:11200
    ds_read_b128 v[176:179], v4 offset:144
    v_mfma_f32_16x16x32_bf16 v[216:219], v[180:183], v[184:187], v[216:219]
    ds_read_b128 v[180:183], v2 offset:11600
    ds_read_b128 v[184:187], v5 offset:144
    s_waitcnt lgkmcnt(0)
    s_nop 0
    v_mfma_f32_16x16x32_bf16 v[220:223], v[92:95], v[96:99], 0
    ds_read_b128 v[92:95], v2 offset:12000
    ds_read_b128 v[96:99], v3 offset:160
    v_mfma_f32_16x16x32_bf16 v[220:223], v[100:103], v[104:107], v[220:223]
    ds_read_b128 v[100:103], v2 offset:12400
    ds_read_b128 v[104:107], v4 offset:160
    v_mfma_f32_16x16x32_bf16 v[220:223], v[140:143], v[144:147], v[220:223]
    ds_read_b128 v[140:143], v2 offset:12800
    ds_read_b128 v[144:147], v5 offset:160
    v_mfma_f32_16x16x32_bf16 v[224:227], v[148:151], v[152:155], 0
    ds_read_b128 v[148:151], v2 offset:13200
    ds_read_b128 v[152:155], v3 offset:176
    v_mfma_f32_16x16x32_bf16 v[224:227], v[172:175], v[176:179], v[224:227]
    ds_read_b128 v[172:175], v2 offset:13600
    ds_read_b128 v[176:179], v4 offset:176
    v_mfma_f32_16x16x32_bf16 v[224:227], v[180:183], v[184:187], v[224:227]
    ds_read_b128 v[180:183], v2 offset:14000
    ds_read_b128 v[184:187], v5 offset:176
    s_waitcnt lgkmcnt(0)
    s_nop 0
    v_mfma_f32_16x16x32_bf16 v[228:231], v[92:95], v[96:99], 0
    v_mfma_f32_16x16x32_bf16 v[228:231], v[100:103], v[104:107], v[228:231]
    v_mfma_f32_16x16x32_bf16 v[228:231], v[140:143], v[144:147], v[228:231]
    v_mfma_f32_16x16x32_bf16 v[232:235], v[148:151], v[152:155], 0
    v_mfma_f32_16x16x32_bf16 v[232:235], v[172:175], v[176:179], v[232:235]
    v_mfma_f32_16x16x32_bf16 v[232:235], v[180:183], v[184:187], v[232:235]
    v_mov_b32 v14, 163536
    v_mov_b32 v15, 1
    s_mov_b64 exec, 1
    ds_add_u32 v14, v15 offset:24
    s_mov_b64 exec, -1
    s_lshr_b32 s12, s62, 1
    s_add_u32 s12, s12, 7
    s_lshl_b32 s13, s69, 1
    s_sub_u32 s12, s12, s13
    s_and_b32 s13, s62, 1
    s_lshl_b32 s12, s12, 1
    s_add_u32 s9, s6, s12
    s_cmp_ge_u32 s9, 384
    s_cselect_b32 s10, 384, 0
    s_cselect_b32 s15, 1, 0
    s_sub_u32 s9, s9, s10
    s_add_u32 s15, s15, s5
    s_lshl_b32 s15, s15, 1
    s_add_u32 s15, s15, s13
    s_mul_i32 s53, s9, 73728
    s_mul_i32 s10, s15, 3072
    s_add_u32 s53, s53, s10
    s_cmp_eq_u32 s9, 0
    s_cselect_b32 s58, 0xffff, 0
    s_cmp_eq_u32 s9, 382
    s_cselect_b32 s59, 0xffff0000, 0
    s_cmp_eq_u32 s15, 0
    s_cselect_b32 s10, 0x00010001, 0
    s_or_b32 s56, s58, s10
    s_or_b32 s57, s59, s10
    s_cmp_eq_u32 s15, 23
    s_cselect_b32 s10, 0x80008000, 0
    s_or_b32 s60, s58, s10
    s_or_b32 s61, s59, s10
    s_mul_i32 s10, s13, 3328
    s_add_u32 s10, s10, 73728
    v_lshrrev_b32 v10, 4, v1
    v_add_u32 v10, s12, v10
    v_subrev_u32 v12, 10, v10
    v_min_u32_e64 v10, v10, v12
    v_mul_u32_u24 v10, 7168, v10
    v_and_b32_e64 v12, 15, v1
    v_mul_u32_u24 v12, 208, v12
    v_add3_u32 v10, v10, v12, s10
    v_mov_b32 v13, 159808
    v_add_u32 v4, 208, v10
    v_add_u32 v5, 416, v10
    v_cndmask_b32 v3, v10, v13, s[56:57]
    v_cndmask_b32 v4, v4, v13, s[58:59]
    v_cndmask_b32 v5, v5, v13, s[60:61]
    v_pk_add_f32 v[16:17], v[188:189], v[190:191]
    v_pk_mul_f32 v[20:21], v[188:189], v[188:189]
    v_pk_add_f32 v[18:19], v[192:193], v[194:195]
    v_pk_mul_f32 v[22:23], v[190:191], v[190:191]
    v_pk_fma_f32 v[20:21], v[192:193], v[192:193], v[20:21]
    v_pk_fma_f32 v[22:23], v[194:195], v[194:195], v[22:23]
    v_pk_add_f32 v[16:17], v[16:17], v[196:197]
    v_pk_fma_f32 v[20:21], v[196:197], v[196:197], v[20:21]
    v_pk_add_f32 v[18:19], v[18:19], v[198:199]
    v_pk_fma_f32 v[22:23], v[198:199], v[198:199], v[22:23]
    v_pk_add_f32 v[16:17], v[16:17], v[200:201]
    v_pk_fma_f32 v[20:21], v[200:201], v[200:201], v[20:21]
    v_pk_add_f32 v[18:19], v[18:19], v[202:203]
    v_pk_fma_f32 v[22:23], v[202:203], v[202:203], v[22:23]
    v_pk_add_f32 v[16:17], v[16:17], v[204:205]
    v_pk_fma_f32 v[20:21], v[204:205], v[204:205], v[20:21]
    v_pk_add_f32 v[18:19], v[18:19], v[206:207]
    v_pk_fma_f32 v[22:23], v[206:207], v[206:207], v[22:23]
    v_pk_add_f32 v[16:17], v[16:17], v[208:209]
    v_pk_fma_f32 v[20:21], v[208:209], v[208:209], v[20:21]
    v_pk_add_f32 v[18:19], v[18:19], v[210:211]
    v_pk_fma_f32 v[22:23], v[210:211], v[210:211], v[22:23]
    v_pk_add_f32 v[16:17], v[16:17], v[212:213]
    v_pk_fma_f32 v[20:21], v[212:213], v[212:213], v[20:21]
    v_pk_add_f32 v[18:19], v[18:19], v[214:215]
    v_pk_fma_f32 v[22:23], v[214:215], v[214:215], v[22:23]
    v_pk_add_f32 v[16:17], v[16:17], v[216:217]
    v_pk_fma_f32 v[20:21], v[216:217], v[216:217], v[20:21]
    v_pk_add_f32 v[18:19], v[18:19], v[218:219]
    v_pk_fma_f32 v[22:23], v[218:219], v[218:219], v[22:23]
    v_pk_add_f32 v[16:17], v[16:17], v[220:221]
    v_pk_fma_f32 v[20:21], v[220:221], v[220:221], v[20:21]
    v_pk_add_f32 v[18:19], v[18:19], v[222:223]
    v_pk_fma_f32 v[22:23], v[222:223], v[222:223], v[22:23]
    v_pk_add_f32 v[16:17], v[16:17], v[224:225]
    v_pk_fma_f32 v[20:21], v[224:225], v[224:225], v[20:21]
    v_pk_add_f32 v[18:19], v[18:19], v[226:227]
    v_pk_fma_f32 v[22:23], v[226:227], v[226:227], v[22:23]
    v_pk_add_f32 v[16:17], v[16:17], v[228:229]
    v_pk_fma_f32 v[20:21], v[228:229], v[228:229], v[20:21]
    v_pk_add_f32 v[18:19], v[18:19], v[230:231]
    v_pk_fma_f32 v[22:23], v[230:231], v[230:231], v[22:23]
    v_pk_add_f32 v[16:17], v[16:17], v[232:233]
    v_pk_fma_f32 v[20:21], v[232:233], v[232:233], v[20:21]
    v_pk_add_f32 v[18:19], v[18:19], v[234:235]
    v_pk_fma_f32 v[22:23], v[234:235], v[234:235], v[22:23]
    v_pk_add_f32 v[16:17], v[16:17], v[18:19]
    v_pk_add_f32 v[20:21], v[20:21], v[22:23]
    v_add_f32 v16, v16, v17
    v_add_f32 v20, v20, v21
    v_mov_b32 v17, v16
    v_mov_b32 v21, v20
    s_nop 0
    v_permlane32_swap_b32 v16, v17
    v_permlane32_swap_b32 v20, v21
    v_add_f32 v16, v16, v17
    v_add_f32_e64 v20, v20, v21
    v_mul_f32 v16, 0x3c2aaaab, v16
    v_mul_f32 v20, 0x3c2aaaab, v20
    v_fma_f32 v20, -v16, v16, v20
    v_max_f32_e64 v20, 0, v20
    v_add_f32 v20, 0x3727c5ac, v20
    v_rsq_f32 v20, v20
    s_nop 0
    v_mul_f32 v18, 0xbeeff558, v20
    v_mul_f32 v19, -v16, v18
    v_pk_fma_f32 v[188:189], v[188:189], v[18:19], v[18:19] op_sel:[0,0,1] op_sel_hi:[1,0,1]
    v_pk_fma_f32 v[190:191], v[190:191], v[18:19], v[18:19] op_sel:[0,0,1] op_sel_hi:[1,0,1]
    v_pk_fma_f32 v[192:193], v[192:193], v[18:19], v[18:19] op_sel:[0,0,1] op_sel_hi:[1,0,1]
    v_pk_fma_f32 v[194:195], v[194:195], v[18:19], v[18:19] op_sel:[0,0,1] op_sel_hi:[1,0,1]
    v_pk_fma_f32 v[196:197], v[196:197], v[18:19], v[18:19] op_sel:[0,0,1] op_sel_hi:[1,0,1]
    v_pk_fma_f32 v[198:199], v[198:199], v[18:19], v[18:19] op_sel:[0,0,1] op_sel_hi:[1,0,1]
    v_pk_fma_f32 v[200:201], v[200:201], v[18:19], v[18:19] op_sel:[0,0,1] op_sel_hi:[1,0,1]
    v_pk_fma_f32 v[202:203], v[202:203], v[18:19], v[18:19] op_sel:[0,0,1] op_sel_hi:[1,0,1]
    v_pk_fma_f32 v[204:205], v[204:205], v[18:19], v[18:19] op_sel:[0,0,1] op_sel_hi:[1,0,1]
    v_pk_fma_f32 v[206:207], v[206:207], v[18:19], v[18:19] op_sel:[0,0,1] op_sel_hi:[1,0,1]
    v_pk_fma_f32 v[208:209], v[208:209], v[18:19], v[18:19] op_sel:[0,0,1] op_sel_hi:[1,0,1]
    v_pk_fma_f32 v[210:211], v[210:211], v[18:19], v[18:19] op_sel:[0,0,1] op_sel_hi:[1,0,1]
    v_pk_fma_f32 v[212:213], v[212:213], v[18:19], v[18:19] op_sel:[0,0,1] op_sel_hi:[1,0,1]
    v_pk_fma_f32 v[214:215], v[214:215], v[18:19], v[18:19] op_sel:[0,0,1] op_sel_hi:[1,0,1]
    v_pk_fma_f32 v[216:217], v[216:217], v[18:19], v[18:19] op_sel:[0,0,1] op_sel_hi:[1,0,1]
    v_pk_fma_f32 v[218:219], v[218:219], v[18:19], v[18:19] op_sel:[0,0,1] op_sel_hi:[1,0,1]
    v_pk_fma_f32 v[220:221], v[220:221], v[18:19], v[18:19] op_sel:[0,0,1] op_sel_hi:[1,0,1]
    v_pk_fma_f32 v[222:223], v[222:223], v[18:19], v[18:19] op_sel:[0,0,1] op_sel_hi:[1,0,1]
    v_pk_fma_f32 v[224:225], v[224:225], v[18:19], v[18:19] op_sel:[0,0,1] op_sel_hi:[1,0,1]
    v_pk_fma_f32 v[226:227], v[226:227], v[18:19], v[18:19] op_sel:[0,0,1] op_sel_hi:[1,0,1]
    v_pk_fma_f32 v[228:229], v[228:229], v[18:19], v[18:19] op_sel:[0,0,1] op_sel_hi:[1,0,1]
    v_pk_fma_f32 v[230:231], v[230:231], v[18:19], v[18:19] op_sel:[0,0,1] op_sel_hi:[1,0,1]
    v_pk_fma_f32 v[232:233], v[232:233], v[18:19], v[18:19] op_sel:[0,0,1] op_sel_hi:[1,0,1]
    v_pk_fma_f32 v[234:235], v[234:235], v[18:19], v[18:19] op_sel:[0,0,1] op_sel_hi:[1,0,1]
    v_cvt_pk_bf16_f32 v68, v188, v189
    v_cvt_pk_bf16_f32 v69, v190, v191
    v_cvt_pk_bf16_f32 v70, v192, v193
    v_cvt_pk_bf16_f32 v71, v194, v195
    v_cvt_pk_bf16_f32 v72, v196, v197
    v_cvt_pk_bf16_f32 v73, v198, v199
    v_cvt_pk_bf16_f32 v74, v200, v201
    v_cvt_pk_bf16_f32 v75, v202, v203
    v_cvt_pk_bf16_f32 v76, v204, v205
    v_cvt_pk_bf16_f32 v77, v206, v207
    v_cvt_pk_bf16_f32 v78, v208, v209
    v_cvt_pk_bf16_f32 v79, v210, v211
    v_cvt_pk_bf16_f32 v80, v212, v213
    v_cvt_pk_bf16_f32 v81, v214, v215
    v_cvt_pk_bf16_f32 v82, v216, v217
    v_cvt_pk_bf16_f32 v83, v218, v219
    v_cvt_pk_bf16_f32 v84, v220, v221
    v_cvt_pk_bf16_f32 v85, v222, v223
    v_cvt_pk_bf16_f32 v86, v224, v225
    v_cvt_pk_bf16_f32 v87, v226, v227
    v_cvt_pk_bf16_f32 v88, v228, v229
    v_cvt_pk_bf16_f32 v89, v230, v231
    v_cvt_pk_bf16_f32 v90, v232, v233
    v_cvt_pk_bf16_f32 v91, v234, v235
    s_setprio 2
    s_nop 0
    v_pk_fma_f32 v[16:17], v[52:53], v[52:53], s[34:35]
    v_pk_fma_f32 v[18:19], v[54:55], v[54:55], s[34:35]
    v_pk_fma_f32 v[20:21], v[56:57], v[56:57], s[34:35]
    v_pk_fma_f32 v[22:23], v[58:59], v[58:59], s[34:35]
    v_pk_mul_f32 v[16:17], v[16:17], v[52:53]
    v_pk_mul_f32 v[18:19], v[18:19], v[54:55]
    v_pk_mul_f32 v[20:21], v[20:21], v[56:57]
    v_pk_mul_f32 v[22:23], v[22:23], v[58:59]
    v_cvt_f64_f32_e64 v[12:13], v11
    v_mfma_f32_32x32x16_bf16 v[36:51], v[68:71], v[24:27], 0
    v_exp_f32 v16, v16
    v_exp_f32 v17, v17
    v_exp_f32_e64 v18, v18
    v_mfma_f32_32x32x16_bf16 v[36:51], v[72:75], v[28:31], v[36:51]
    v_exp_f32 v19, v19
    v_exp_f32 v20, v20
    v_exp_f32 v21, v21
    v_exp_f32 v22, v22
    v_exp_f32_e64 v23, v23
    v_pk_add_f32 v[16:17], v[16:17], 1.0 op_sel_hi:[1,0]
    v_pk_add_f32 v[18:19], v[18:19], 1.0 op_sel_hi:[1,0]
    v_pk_add_f32 v[20:21], v[20:21], 1.0 op_sel_hi:[1,0]
    v_pk_add_f32 v[22:23], v[22:23], 1.0 op_sel_hi:[1,0]
    ds_read_b128 v[24:27], v6 offset:4096
    ds_read_b128 v[28:31], v6 offset:5120
    ds_add_f64 v250, v[12:13] offset:1024
    v_mfma_f32_32x32x16_bf16 v[36:51], v[76:79], v[32:35], v[36:51]
    v_rcp_f32 v16, v16
    v_rcp_f32 v17, v17
    v_rcp_f32_e64 v18, v18
    v_mfma_f32_32x32x16_bf16 v[36:51], v[80:83], v[252:255], v[36:51]
    v_rcp_f32 v19, v19
    v_rcp_f32 v20, v20
    v_rcp_f32 v21, v21
    v_rcp_f32 v22, v22
    v_rcp_f32_e64 v23, v23
    v_pk_mul_f32 v[16:17], v[16:17], v[52:53]
    v_pk_mul_f32 v[18:19], v[18:19], v[54:55]
    v_pk_mul_f32 v[20:21], v[20:21], v[56:57]
    v_pk_mul_f32 v[22:23], v[22:23], v[58:59]
    v_cvt_pk_bf16_f32 v132, v16, v17
    v_cvt_pk_bf16_f32 v133, v18, v19
    v_cvt_pk_bf16_f32 v134, v20, v21
    v_cvt_pk_bf16_f32 v135, v22, v23
    v_dot2_f32_bf16 v11, v132, v132, 0
    v_dot2_f32_bf16 v11, v133, v133, v11
    v_dot2_f32_bf16 v11, v134, v134, v11
    v_dot2_f32_bf16 v11, v135, v135, v11
    v_pk_fma_f32 v[16:17], v[60:61], v[60:61], s[34:35]
    v_pk_fma_f32 v[18:19], v[62:63], v[62:63], s[34:35]
    v_pk_fma_f32 v[20:21], v[64:65], v[64:65], s[34:35]
    v_pk_fma_f32 v[22:23], v[66:67], v[66:67], s[34:35]
    v_pk_mul_f32 v[16:17], v[16:17], v[60:61]
    v_pk_mul_f32 v[18:19], v[18:19], v[62:63]
    v_pk_mul_f32 v[20:21], v[20:21], v[64:65]
    v_pk_mul_f32 v[22:23], v[22:23], v[66:67]
    s_waitcnt lgkmcnt(1)
    ds_read_b128 v[32:35], v6 offset:6144
    ds_read_b128 v[252:255], v6 offset:7168
    v_mfma_f32_32x32x16_bf16 v[36:51], v[84:87], v[24:27], v[36:51]
    v_exp_f32 v16, v16
    v_exp_f32 v17, v17
    v_exp_f32 v18, v18
    v_mfma_f32_32x32x16_bf16 v[36:51], v[88:91], v[28:31], v[36:51]
    v_exp_f32 v19, v19
    v_exp_f32 v20, v20
    v_exp_f32 v21, v21
    v_exp_f32 v22, v22
    v_exp_f32_e64 v23, v23
    v_pk_add_f32 v[16:17], v[16:17], 1.0 op_sel_hi:[1,0]
    v_pk_add_f32 v[18:19], v[18:19], 1.0 op_sel_hi:[1,0]
    v_pk_add_f32 v[20:21], v[20:21], 1.0 op_sel_hi:[1,0]
    v_pk_add_f32 v[22:23], v[22:23], 1.0 op_sel_hi:[1,0]
    ds_read_b128 v[24:27], v6 offset:8192
    ds_read_b128 v[28:31], v6 offset:9216
    v_rcp_f32 v16, v16
    v_rcp_f32 v17, v17
    v_rcp_f32 v18, v18
    v_rcp_f32 v19, v19
    v_rcp_f32 v20, v20
    v_rcp_f32 v21, v21
    v_rcp_f32 v22, v22
    v_rcp_f32 v23, v23
    v_pk_mul_f32 v[16:17], v[16:17], v[60:61]
    v_pk_mul_f32 v[18:19], v[18:19], v[62:63]
    v_pk_mul_f32 v[20:21], v[20:21], v[64:65]
    v_pk_mul_f32 v[22:23], v[22:23], v[66:67]
    v_cvt_pk_bf16_f32 v136, v16, v17
    v_cvt_pk_bf16_f32 v137, v18, v19
    v_cvt_pk_bf16_f32 v138, v20, v21
    v_cvt_pk_bf16_f32 v139, v22, v23
    v_dot2_f32_bf16 v11, v136, v136, v11
    v_dot2_f32_bf16 v11, v137, v137, v11
    v_dot2_f32_bf16 v11, v138, v138, v11
    v_dot2_f32_bf16 v11, v139, v139, v11
    s_nop 2
    v_cvt_f64_f32 v[12:13], v11
    ds_add_f64 v250, v[12:13] offset:1280
    v_mov_b32 v14, 163536
    s_mov_b32 s10, 0
L_aw6:
    ds_read_b32 v15, v14 offset:24
    s_add_u32 s10, s10, 1
    s_waitcnt lgkmcnt(0)
    v_readfirstlane_b32 s9, v15
    s_lshr_b32 s55, s10, 22
    s_lshl_b32 s55, s55, 3
    s_or_b32 s9, s9, s55
    s_cmp_lt_u32 s9, 4
    s_cbranch_scc1 L_aw6
    s_mov_b32 exec_hi, 0x00ffffff
    s_add_u32 s9, s7, 1179648
    s_sub_u32 s10, s9, 28305408
    s_cmp_le_u32 s8, 16
    s_cselect_b32 s9, s10, s9
    s_add_u32 m0, s11, 43008
    v_add_u32 v10, s9, v9
    buffer_load_dwordx4 v10, s[36:39], 0 offen  lds
    s_add_u32 m0, m0, 3584
    v_add_u32_e64 v10, s9, v251
    buffer_load_dwordx4 v10, s[36:39], 0 offen  lds
    s_add_u32 s9, s7, 1253376
    s_sub_u32 s10, s9, 28305408
    s_cmp_le_u32 s8, 17
    s_cselect_b32 s9, s10, s9
    s_add_u32 m0, s11, 50176
    v_add_u32_e64 v10, s9, v9
    buffer_load_dwordx4 v10, s[36:39], 0 offen  lds
    s_add_u32 m0, m0, 3584
    v_add_u32_e64 v10, s9, v251
    buffer_load_dwordx4 v10, s[36:39], 0 offen  lds
    s_add_u32 s9, s7, 1327104
    s_sub_u32 s10, s9, 28305408
    s_cmp_le_u32 s8, 18
    s_cselect_b32 s9, s10, s9
    s_add_u32 m0, s11, 57344
    v_add_u32_e64 v10, s9, v9
    buffer_load_dwordx4 v10, s[36:39], 0 offen  lds
    s_add_u32 m0, m0, 3584
    v_add_u32_e64 v10, s9, v251
    buffer_load_dwordx4 v10, s[36:39], 0 offen  lds
    s_add_u32 s9, s7, 1400832
    s_sub_u32 s10, s9, 28305408
    s_cmp_le_u32 s8, 19
    s_cselect_b32 s9, s10, s9
    s_add_u32 m0, s11, 64512
    v_add_u32_e64 v10, s9, v9
    buffer_load_dwordx4 v10, s[36:39], 0 offen  lds
    s_add_u32 m0, m0, 3584
    v_add_u32_e64 v10, s9, v251
    buffer_load_dwordx4 v10, s[36:39], 0 offen  lds
    s_mov_b32 exec_hi, -1
    s_waitcnt lgkmcnt(0)
    s_nop 7
    s_branch L_join1
L_rstart:
    v_lshrrev_b32_e64 v12, 3, v1
    v_mul_u32_u24 v252, 768, v12
    v_bfe_u32 v12, v1, 4, 1
    v_lshlrev_b32 v12, 2, v12
    v_and_b32 v13, 7, v1
    v_xor_b32_e64 v12, v12, v13
    v_lshl_add_u32 v252, v12, 4, v252
    s_and_b32 s12, s62, 1
    s_lshr_b32 s13, s62, 1
    s_mul_i32 s9, s12, 384
    s_mul_i32 s10, s13, 36864
    s_add_u32 s9, s9, s10
    v_add_u32 v252, s9, v252
    s_mul_i32 s14, s12, 36864
    s_mul_i32 s10, s13, 3072
    s_add_u32 s14, s14, s10
    s_waitcnt lgkmcnt(0)
    s_mov_b32 s40, s20
    s_mov_b32 s41, s21
    s_mov_b32 s42, 73728
    s_mov_b32 s43, 0x00020000
    s_lshr_b32 s9, s2, 3
    s_lshl_b32 s9, s9, 2
    s_add_u32 s9, s9, s62
    s_mul_i32 s9, s9, 576
    v_lshlrev_b32_e64 v12, 7, v1
    s_mov_b64 exec, 0x1f
    buffer_load_dword v37, v12, s[40:43], s9 offen
    s_mov_b64 exec, -1
    s_barrier
    v_mov_b32 v28, 0
    v_mov_b32 v29, 0
    v_mov_b32 v30, 0
    v_mov_b32 v31, 0
    s_and_b32 s9, s2, 7
    s_lshl_b32 s9, s9, 12
    s_add_u32 s64, s32, s9
    s_addc_u32 s65, s33, 0
    s_lshl_b32 s9, s3, 12
    s_add_u32 s66, s32, s9
    s_addc_u32 s67, s33, 0
    s_lshr_b32 s9, s2, 3
    s_xor_b32 s10, s3, 4
    s_or_b32 s68, s9, s10
    s_mov_b32 s44, s22
    s_mov_b32 s45, s23
    s_mov_b32 s46, 73728
    s_mov_b32 s47, 0x00020000
    s_mov_b32 s48, s28
    s_mov_b32 s49, s29
    s_mov_b32 s50, 28311552
    s_mov_b32 s51, 0x00020000
    s_mov_b32 s34, 0x409d30fc
    s_mov_b32 s35, 0x409d30fc
    v_bfe_u32 v12, v1, 2, 1
    v_lshrrev_b32 v13, 4, v1
    v_sub_u32 v13, v13, v12
    v_and_b32 v13, 3, v13
    v_lshrrev_b32 v12, 1, v1
    v_and_b32 v12, 4, v12
    v_and_b32 v14, 3, v1
    v_cmp_eq_u32 vcc, 3, v13
    v_or_b32 v12, v12, v14
    v_lshlrev_b32 v13, 7, v13
    v_cndmask_b32 v12, v12, v28, vcc
    v_lshl_add_u32 v2, v12, 4, v13
    v_add_u32 v2, 145408, v2
    v_lshrrev_b32_e64 v12, 5, v1
    v_bfe_u32 v13, v1, 2, 2
    v_lshl_add_u32 v12, v12, 2, v13
    v_bfe_u32 v13, v1, 3, 1
    v_lshlrev_b32_e64 v13, 6, v13
    v_lshl_add_u32 v12, v12, 7, v13
    v_bfe_u32 v13, v1, 4, 1
    v_lshl_add_u32 v12, v13, 5, v12
    v_lshl_add_u32 v248, v14, 3, v12
    v_xor_b32 v249, 64, v248
    v_lshlrev_b32 v6, 4, v1
    v_add_u32 v7, 36864, v6
    v_and_b32 v13, 31, v1
    v_lshlrev_b32 v8, 3, v13
    v_add_u32 v8, 160064, v8
    v_lshrrev_b32 v12, 5, v1
    v_lshlrev_b32 v12, 1, v12
    v_bfe_u32 v14, v1, 1, 2
    v_xor_b32 v12, v12, v14
    v_lshlrev_b32 v13, 6, v13
    v_lshl_add_u32 v0, v12, 4, v13
    s_mov_b32 s36, s16
    s_mov_b32 s37, s17
    s_mov_b32 s38, 28311552
    s_mov_b32 s39, 0x00020000
    s_mul_i32 s9, s3, 56
    v_add_u32 v10, s9, v1
    v_mul_u32_u24 v12, 5042, v10
    v_lshrrev_b32 v12, 16, v12
    v_mul_u32_u24 v13, 13, v12
    v_sub_u32_e64 v13, v10, v13
    v_mul_u32_u24 v9, 192, v12
    v_lshl_add_u32 v9, v13, 4, v9
    v_cmp_lt_u32 vcc, 33, v12
    v_cmp_eq_u32 s[56:57], 12, v13
    v_mov_b32 v14, 0x40000000
    s_or_b64 vcc, vcc, s[56:57]
    v_cndmask_b32 v9, v9, v14, vcc
    s_mul_i32 s9, s62, 56
    v_add_u32 v10, s9, v1
    v_mul_u32_u24 v12, 5042, v10
    v_lshrrev_b32 v12, 16, v12
    v_mul_u32_u24 v13, 13, v12
    v_sub_u32_e64 v13, v10, v13
    v_mul_u32_u24 v251, 192, v12
    v_lshl_add_u32 v251, v13, 4, v251
    v_cmp_lt_u32 vcc, 33, v12
    v_cmp_eq_u32 s[56:57], 12, v13
    v_mov_b32_e64 v14, 0x40000000
    s_or_b64 vcc, vcc, s[56:57]
    v_cndmask_b32 v251, v251, v14, vcc
    s_lshr_b32 s12, s62, 1
    s_add_u32 s12, s12, 3
    s_lshl_b32 s13, s69, 1
    s_sub_u32 s12, s12, s13
    s_and_b32 s13, s62, 1
    s_lshl_b32 s12, s12, 1
    s_add_u32 s9, s6, s12
    s_cmp_ge_u32 s9, 384
    s_cselect_b32 s10, 384, 0
    s_cselect_b32 s15, 1, 0
    s_sub_u32 s9, s9, s10
    s_add_u32 s15, s15, s5
    s_lshl_b32 s15, s15, 1
    s_add_u32 s15, s15, s13
    s_mul_i32 s52, s9, 73728
    s_mul_i32 s10, s15, 3072
    s_add_u32 s52, s52, s10
    s_cmp_eq_u32 s9, 0
    s_cselect_b32 s58, 0xffff, 0
    s_cmp_eq_u32 s9, 382
    s_cselect_b32 s59, 0xffff0000, 0
    s_cmp_eq_u32 s15, 0
    s_cselect_b32 s10, 0x00010001, 0
    s_or_b32 s56, s58, s10
    s_or_b32 s57, s59, s10
    s_cmp_eq_u32 s15, 23
    s_cselect_b32 s10, 0x80008000, 0
    s_or_b32 s60, s58, s10
    s_or_b32 s61, s59, s10
    s_mul_i32 s10, s13, 3328
    s_add_u32 s10, s10, 73728
    v_lshrrev_b32 v10, 4, v1
    v_add_u32 v10, s12, v10
    v_subrev_u32 v12, 10, v10
    v_min_u32_e64 v10, v10, v12
    v_mul_u32_u24 v10, 7168, v10
    v_and_b32_e64 v12, 15, v1
    v_mul_u32_u24 v12, 208, v12
    v_add3_u32 v10, v10, v12, s10
    v_mov_b32 v13, 159808
    v_add_u32 v4, 208, v10
    v_add_u32 v5, 416, v10
    v_cndmask_b32 v3, v10, v13, s[56:57]
    v_cndmask_b32 v4, v4, v13, s[58:59]
    v_cndmask_b32 v5, v5, v13, s[60:61]
    s_waitcnt vmcnt(0)
    s_add_u32 m0, s14, 0
    s_mov_b32 s9, 0
    s_nop 0
    buffer_load_dwordx4 v252, s[40:43], s9 offen lds
    s_add_u32 m0, s14, 6144
    s_mov_b32 s9, 6144
    buffer_load_dwordx4 v252, s[40:43], s9 offen lds
    s_add_u32 m0, s14, 1024
    s_mov_b32 s9, 12288
    buffer_load_dwordx4 v252, s[40:43], s9 offen lds
    s_add_u32 m0, s14, 7168
    s_mov_b32 s9, 18432
    buffer_load_dwordx4 v252, s[40:43], s9 offen lds
    s_add_u32 m0, s14, 2048
    s_mov_b32 s9, 24576
    buffer_load_dwordx4 v252, s[40:43], s9 offen lds
    s_add_u32 m0, s14, 8192
    s_mov_b32 s9, 30720
    buffer_load_dwordx4 v252, s[40:43], s9 offen lds
    s_add_u32 m0, s14, 12288
    s_mov_b32 s9, 128
    buffer_load_dwordx4 v252, s[40:43], s9 offen lds
    s_add_u32 m0, s14, 18432
    s_mov_b32 s9, 6272
    buffer_load_dwordx4 v252, s[40:43], s9 offen lds
    s_add_u32 m0, s14, 13312
    s_mov_b32 s9, 12416
    buffer_load_dwordx4 v252, s[40:43], s9 offen lds
    s_add_u32 m0, s14, 19456
    s_mov_b32 s9, 18560
    buffer_load_dwordx4 v252, s[40:43], s9 offen lds
    s_add_u32 m0, s14, 14336
    s_mov_b32 s9, 24704
    buffer_load_dwordx4 v252, s[40:43], s9 offen lds
    s_add_u32 m0, s14, 20480
    s_mov_b32 s9, 30848
    buffer_load_dwordx4 v252, s[40:43], s9 offen lds
    s_add_u32 m0, s14, 24576
    s_mov_b32 s9, 256
    buffer_load_dwordx4 v252, s[40:43], s9 offen lds
    s_add_u32 m0, s14, 30720
    s_mov_b32 s9, 6400
    buffer_load_dwordx4 v252, s[40:43], s9 offen lds
    s_add_u32 m0, s14, 25600
    s_mov_b32 s9, 12544
    buffer_load_dwordx4 v252, s[40:43], s9 offen lds
    s_add_u32 m0, s14, 31744
    s_mov_b32 s9, 18688
    buffer_load_dwordx4 v252, s[40:43], s9 offen lds
    s_add_u32 m0, s14, 26624
    s_mov_b32 s9, 24832
    buffer_load_dwordx4 v252, s[40:43], s9 offen lds
    s_add_u32 m0, s14, 32768
    s_mov_b32 s9, 30976
    buffer_load_dwordx4 v252, s[40:43], s9 offen lds
    s_mov_b32 exec_hi, 0x00ffffff
    s_add_u32 s9, s7, 294912
    s_sub_u32 s10, s9, 28305408
    s_cmp_le_u32 s8, 4
    s_cselect_b32 s9, s10, s9
    s_add_u32 m0, s11, 28672
    v_add_u32_e64 v10, s9, v9
    buffer_load_dwordx4 v10, s[36:39], 0 offen  lds
    s_sub_u32 m0, m0, 3584
    v_add_u32_e64 v10, s9, v251
    buffer_load_dwordx4 v10, s[36:39], 0 offen  lds
    s_add_u32 s9, s7, 368640
    s_sub_u32 s10, s9, 28305408
    s_cmp_le_u32 s8, 5
    s_cselect_b32 s9, s10, s9
    s_add_u32 m0, s11, 35840
    v_add_u32_e64 v10, s9, v9
    buffer_load_dwordx4 v10, s[36:39], 0 offen  lds
    s_sub_u32 m0, m0, 3584
    v_add_u32_e64 v10, s9, v251
    buffer_load_dwordx4 v10, s[36:39], 0 offen  lds
    s_add_u32 s9, s7, 442368
    s_sub_u32 s10, s9, 28305408
    s_cmp_le_u32 s8, 6
    s_cselect_b32 s9, s10, s9
    s_add_u32 m0, s11, 43008
    v_add_u32_e64 v10, s9, v9
    buffer_load_dwordx4 v10, s[36:39], 0 offen  lds
    s_sub_u32 m0, m0, 3584
    v_add_u32_e64 v10, s9, v251
    buffer_load_dwordx4 v10, s[36:39], 0 offen  lds
    s_add_u32 s9, s7, 516096
    s_sub_u32 s10, s9, 28305408
    s_cmp_le_u32 s8, 7
    s_cselect_b32 s9, s10, s9
    s_add_u32 m0, s11, 50176
    v_add_u32_e64 v10, s9, v9
    buffer_load_dwordx4 v10, s[36:39], 0 offen  lds
    s_sub_u32 m0, m0, 3584
    v_add_u32_e64 v10, s9, v251
    buffer_load_dwordx4 v10, s[36:39], 0 offen  lds
    s_mov_b32 exec_hi, -1
    s_waitcnt vmcnt(8)
    v_mov_b32 v14, 163536
    v_mov_b32 v15, 1
    s_mov_b64 exec, 1
    ds_add_u32 v14, v15 offset:4
    s_mov_b64 exec, -1
    v_add_u32 v16, s14, v248
    v_add_u32_e64 v17, s14, v249
    ds_read_b64_tr_b16 v[92:93], v16 offset:0
    ds_read_b64_tr_b16 v[94:95], v16 offset:6144
    ds_read_b64_tr_b16 v[96:97], v17 offset:0
    ds_read_b64_tr_b16 v[98:99], v17 offset:6144
    ds_read_b64_tr_b16 v[100:101], v16 offset:1024
    ds_read_b64_tr_b16 v[102:103], v16 offset:7168
    ds_read_b64_tr_b16 v[104:105], v17 offset:1024
    ds_read_b64_tr_b16 v[106:107], v17 offset:7168
    ds_read_b64_tr_b16 v[140:141], v16 offset:2048
    ds_read_b64_tr_b16 v[142:143], v16 offset:8192
    ds_read_b64_tr_b16 v[144:145], v17 offset:2048
    ds_read_b64_tr_b16 v[146:147], v17 offset:8192
    ds_read_b64_tr_b16 v[108:109], v16 offset:12288
    ds_read_b64_tr_b16 v[110:111], v16 offset:18432
    s_waitcnt lgkmcnt(14)
    ds_read_b64_tr_b16 v[112:113], v17 offset:12288
    s_waitcnt lgkmcnt(14)
    ds_read_b64_tr_b16 v[114:115], v17 offset:18432
    s_waitcnt lgkmcnt(14)
    ds_read_b64_tr_b16 v[116:117], v16 offset:13312
    s_waitcnt lgkmcnt(14)
    ds_read_b64_tr_b16 v[118:119], v16 offset:19456
    s_waitcnt lgkmcnt(14)
    ds_read_b64_tr_b16 v[120:121], v17 offset:13312
    s_waitcnt lgkmcnt(14)
    ds_read_b64_tr_b16 v[122:123], v17 offset:19456
    s_waitcnt lgkmcnt(14)
    ds_read_b64_tr_b16 v[156:157], v16 offset:14336
    s_waitcnt lgkmcnt(14)
    ds_read_b64_tr_b16 v[158:159], v16 offset:20480
    s_waitcnt lgkmcnt(14)
    ds_read_b64_tr_b16 v[160:161], v17 offset:14336
    s_waitcnt lgkmcnt(14)
    ds_read_b64_tr_b16 v[162:163], v17 offset:20480
    s_waitcnt lgkmcnt(14)
    ds_read_b64_tr_b16 v[164:165], v16 offset:24576
    s_waitcnt lgkmcnt(14)
    ds_read_b64_tr_b16 v[166:167], v16 offset:30720
    s_waitcnt lgkmcnt(14)
    ds_read_b64_tr_b16 v[168:169], v17 offset:24576
    s_waitcnt lgkmcnt(14)
    ds_read_b64_tr_b16 v[170:171], v17 offset:30720
    s_waitcnt lgkmcnt(14)
    ds_read_b64_tr_b16 v[124:125], v16 offset:25600
    s_waitcnt lgkmcnt(14)
    ds_read_b64_tr_b16 v[126:127], v16 offset:31744
    s_waitcnt lgkmcnt(14)
    ds_read_b64_tr_b16 v[128:129], v17 offset:25600
    s_waitcnt lgkmcnt(14)
    ds_read_b64_tr_b16 v[130:131], v17 offset:31744
    s_waitcnt lgkmcnt(14)
    ds_read_b64_tr_b16 v[132:133], v16 offset:26624
    s_waitcnt lgkmcnt(14)
    ds_read_b64_tr_b16 v[134:135], v16 offset:32768
    s_waitcnt lgkmcnt(14)
    ds_read_b64_tr_b16 v[136:137], v17 offset:26624
    s_waitcnt lgkmcnt(14)
    ds_read_b64_tr_b16 v[138:139], v17 offset:32768
    v_add_u32 v236, s14, v6
    s_setprio 3
    v_dot2_f32_bf16 v16, v92, v92, 0
    v_dot2_f32_bf16 v17, v96, v96, 0
    v_dot2_f32_bf16 v18, v108, v108, 0
    v_dot2_f32_bf16 v19, v112, v112, 0
    s_waitcnt lgkmcnt(11)
    v_dot2_f32_bf16 v20, v164, v164, 0
    s_waitcnt lgkmcnt(9)
    v_dot2_f32_bf16 v21, v168, v168, 0
    v_dot2_f32_bf16 v16, v93, v93, v16
    v_dot2_f32_bf16 v17, v97, v97, v17
    v_dot2_f32_bf16 v18, v109, v109, v18
    v_dot2_f32_bf16 v19, v113, v113, v19
    v_dot2_f32_bf16 v20, v165, v165, v20
    v_dot2_f32_bf16 v21, v169, v169, v21
    v_dot2_f32_bf16 v16, v94, v94, v16
    v_dot2_f32_bf16 v17, v98, v98, v17
    v_dot2_f32_bf16 v18, v110, v110, v18
    v_dot2_f32_bf16 v19, v114, v114, v19
    v_dot2_f32_bf16 v20, v166, v166, v20
    s_waitcnt lgkmcnt(8)
    s_nop 0
    v_dot2_f32_bf16 v21, v170, v170, v21
    v_dot2_f32_bf16 v16, v95, v95, v16
    v_dot2_f32_bf16 v17, v99, v99, v17
    v_dot2_f32_bf16 v18, v111, v111, v18
    v_dot2_f32_bf16 v19, v115, v115, v19
    v_dot2_f32_bf16 v20, v167, v167, v20
    v_dot2_f32_bf16 v21, v171, v171, v21
    v_dot2_f32_bf16 v16, v100, v100, v16
    v_dot2_f32_bf16 v17, v104, v104, v17
    v_dot2_f32_bf16 v18, v116, v116, v18
    v_dot2_f32_bf16 v19, v120, v120, v19
    s_waitcnt lgkmcnt(7)
    v_dot2_f32_bf16 v20, v124, v124, v20
    s_waitcnt lgkmcnt(5)
    v_dot2_f32_bf16 v21, v128, v128, v21
    v_dot2_f32_bf16 v16, v101, v101, v16
    v_dot2_f32_bf16 v17, v105, v105, v17
    v_dot2_f32_bf16 v18, v117, v117, v18
    v_dot2_f32_bf16 v19, v121, v121, v19
    v_dot2_f32_bf16 v20, v125, v125, v20
    v_dot2_f32_bf16 v21, v129, v129, v21
    v_dot2_f32_bf16 v16, v102, v102, v16
    v_dot2_f32_bf16 v17, v106, v106, v17
    v_dot2_f32_bf16 v18, v118, v118, v18
    v_dot2_f32_bf16 v19, v122, v122, v19
    v_dot2_f32_bf16 v20, v126, v126, v20
    s_waitcnt lgkmcnt(4)
    s_nop 0
    v_dot2_f32_bf16 v21, v130, v130, v21
    v_dot2_f32_bf16 v16, v103, v103, v16
    v_dot2_f32_bf16 v17, v107, v107, v17
    v_dot2_f32_bf16 v18, v119, v119, v18
    v_dot2_f32_bf16 v19, v123, v123, v19
    v_dot2_f32_bf16 v20, v127, v127, v20
    v_dot2_f32_bf16 v21, v131, v131, v21
    v_dot2_f32_bf16 v16, v140, v140, v16
    v_dot2_f32_bf16 v17, v144, v144, v17
    v_dot2_f32_bf16 v18, v156, v156, v18
    v_dot2_f32_bf16 v19, v160, v160, v19
    s_waitcnt lgkmcnt(3)
    v_dot2_f32_bf16 v20, v132, v132, v20
    s_waitcnt lgkmcnt(1)
    v_dot2_f32_bf16 v21, v136, v136, v21
    v_dot2_f32_bf16 v16, v141, v141, v16
    v_dot2_f32_bf16 v17, v145, v145, v17
    v_dot2_f32_bf16 v18, v157, v157, v18
    v_dot2_f32_bf16 v19, v161, v161, v19
    v_dot2_f32_bf16 v20, v133, v133, v20
    v_dot2_f32_bf16 v21, v137, v137, v21
    v_dot2_f32_bf16 v16, v142, v142, v16
    v_dot2_f32_bf16 v17, v146, v146, v17
    v_dot2_f32_bf16 v18, v158, v158, v18
    v_dot2_f32_bf16 v19, v162, v162, v19
    v_dot2_f32_bf16 v20, v134, v134, v20
    s_waitcnt lgkmcnt(0)
    s_nop 0
    v_dot2_f32_bf16 v21, v138, v138, v21
    v_dot2_f32_bf16 v16, v143, v143, v16
    v_dot2_f32_bf16 v17, v147, v147, v17
    v_dot2_f32_bf16 v18, v159, v159, v18
    v_dot2_f32_bf16 v19, v163, v163, v19
    v_dot2_f32_bf16 v20, v135, v135, v20
    v_dot2_f32_bf16 v21, v139, v139, v21
    v_permlane32_swap_b32 v16, v17
    v_permlane32_swap_b32 v18, v19
    s_nop 0
    v_permlane32_swap_b32 v20, v21
    v_add_f32 v16, v16, v17
    v_add_f32 v18, v18, v19
    v_add_f32_e64 v20, v20, v21
    v_max3_f32 v17, v16, v18, v20
    v_add_f32 v16, v16, v18
    v_add_f32_e64 v16, v16, v20
    s_nop 1
    v_add_f32_dpp v16, v16, v16 quad_perm:[1,0,3,2] row_mask:0xf bank_mask:0xf
    s_nop 1
    v_add_f32_dpp v16, v16, v16 quad_perm:[2,3,0,1] row_mask:0xf bank_mask:0xf
    s_nop 1
    v_add_f32_dpp v16, v16, v16 row_half_mirror row_mask:0xf bank_mask:0xf
    s_nop 1
    v_add_f32_dpp v16, v16, v16 row_mirror row_mask:0xf bank_mask:0xf
    s_nop 0
    v_readlane_b32 s9, v16, 0
    v_readlane_b32 s10, v16, 16
    v_readlane_b32 s12, v16, 32
    v_readlane_b32 s13, v16, 48
    v_mov_b32 v16, s9
    v_add_f32 v16, s10, v16
    v_add_f32 v16, s12, v16
    v_add_f32 v16, s13, v16
    v_max_f32_dpp v17, v17, v17 quad_perm:[1,0,3,2] row_mask:0xf bank_mask:0xf
    s_nop 1
    v_max_f32_dpp v17, v17, v17 quad_perm:[2,3,0,1] row_mask:0xf bank_mask:0xf
    s_nop 1
    v_max_f32_dpp v17, v17, v17 row_half_mirror row_mask:0xf bank_mask:0xf
    s_nop 1
    v_max_f32_dpp v17, v17, v17 row_mirror row_mask:0xf bank_mask:0xf
    s_nop 0
    v_readlane_b32 s9, v17, 0
    v_readlane_b32 s10, v17, 16
    v_readlane_b32 s12, v17, 32
    v_readlane_b32 s13, v17, 48
    v_mov_b32 v17, s9
    v_max_f32 v17, s10, v17
    v_max_f32 v17, s12, v17
    v_max_f32_e64 v17, s13, v17
    s_lshl_b32 s9, s62, 2
    s_add_u32 s9, s9, 163520
    v_mov_b32_e64 v18, s9
    ds_write_b32 v18, v16
    ds_write_b32 v18, v17 offset:96
    s_waitcnt vmcnt(0)
    v_mov_b32 v14, 163536
    v_mov_b32_e64 v15, 1
    s_mov_b64 exec, 1
    ds_add_u32 v14, v15 offset:12
    s_mov_b64 exec, -1
    v_mov_b32 v14, 163536
    s_mov_b32 s10, 0
L_aw7:
    ds_read_b32 v15, v14 offset:8
    s_add_u32 s10, s10, 1
    s_waitcnt lgkmcnt(0)
    v_readfirstlane_b32 s9, v15
    s_lshr_b32 s55, s10, 22
    s_lshl_b32 s55, s55, 3
    s_or_b32 s9, s9, s55
    s_cmp_lt_u32 s9, 4
    s_cbranch_scc1 L_aw7
    s_mov_b32 s10, 0
L_aw8:
    ds_read_b32 v15, v14 offset:12
    s_add_u32 s10, s10, 1
    s_waitcnt lgkmcnt(0)
    v_readfirstlane_b32 s9, v15
    s_lshr_b32 s55, s10, 22
    s_lshl_b32 s55, s55, 3
    s_or_b32 s9, s9, s55
    s_cmp_lt_u32 s9, 4
    s_cbranch_scc1 L_aw8
    s_mov_b32 exec_hi, 0x00ffffff
    s_add_u32 s9, s7, 589824
    s_sub_u32 s10, s9, 28305408
    s_cmp_le_u32 s8, 8
    s_cselect_b32 s9, s10, s9
    s_add_u32 m0, s11, 57344
    v_add_u32 v10, s9, v9
    buffer_load_dwordx4 v10, s[36:39], 0 offen  lds
    s_sub_u32 m0, m0, 3584
    v_add_u32_e64 v10, s9, v251
    buffer_load_dwordx4 v10, s[36:39], 0 offen  lds
    s_add_u32 s9, s7, 663552
    s_sub_u32 s10, s9, 28305408
    s_cmp_le_u32 s8, 9
    s_cselect_b32 s9, s10, s9
    s_add_u32 m0, s11, 64512
    v_add_u32_e64 v10, s9, v9
    buffer_load_dwordx4 v10, s[36:39], 0 offen  lds
    s_sub_u32 m0, m0, 3584
    v_add_u32_e64 v10, s9, v251
    buffer_load_dwordx4 v10, s[36:39], 0 offen  lds
    s_add_u32 s9, s7, 737280
    s_sub_u32 s10, s9, 28305408
    s_cmp_le_u32 s8, 10
    s_cselect_b32 s9, s10, s9
    s_add_u32 m0, s11, 0
    v_add_u32 v10, s9, v9
    buffer_load_dwordx4 v10, s[36:39], 0 offen  lds
    s_sub_u32 m0, m0, 3584
    v_add_u32_e64 v10, s9, v251
    buffer_load_dwordx4 v10, s[36:39], 0 offen  lds
    s_add_u32 s9, s7, 811008
    s_sub_u32 s10, s9, 28305408
    s_cmp_le_u32 s8, 11
    s_cselect_b32 s9, s10, s9
    s_add_u32 m0, s11, 7168
    v_add_u32_e64 v10, s9, v9
    buffer_load_dwordx4 v10, s[36:39], 0 offen  lds
    s_sub_u32 m0, m0, 3584
    v_add_u32_e64 v10, s9, v251
    buffer_load_dwordx4 v10, s[36:39], 0 offen  lds
    s_mov_b32 exec_hi, -1
    s_cmp_lg_u32 s68, 0
    s_cbranch_scc1 L_skip9
    v_lshlrev_b32 v12, 4, v1
    global_store_dwordx4 v12, v[28:31], s[64:65] offset:0 sc0 sc1
    global_store_dwordx4 v12, v[28:31], s[64:65] offset:1024 sc0 sc1
    global_store_dwordx4 v12, v[28:31], s[64:65] offset:2048 sc0 sc1
    global_store_dwordx4 v12, v[28:31], s[64:65] offset:3072 sc0 sc1
    s_nop 1
    s_nop 0
    v_add_u32 v12, 65536, v12
    global_store_dwordx4 v12, v[28:31], s[64:65] offset:0 sc0 sc1
    global_store_dwordx4 v12, v[28:31], s[64:65] offset:1024 sc0 sc1
    global_store_dwordx4 v12, v[28:31], s[64:65] offset:2048 sc0 sc1
    global_store_dwordx4 v12, v[28:31], s[64:65] offset:3072 sc0 sc1
L_skip9:
    ds_read_b128 v[20:23], v2 offset:0
    ds_read_b128 v[24:27], v3 offset:0
    ds_read_b128 v[28:31], v2 offset:400
    ds_read_b128 v[32:35], v4 offset:0
    ds_read_b128 v[36:39], v2 offset:800
    ds_read_b128 v[40:43], v5 offset:0
    ds_read_b128 v[44:47], v2 offset:1200
    ds_read_b128 v[48:51], v3 offset:16
    s_waitcnt lgkmcnt(0)
    s_nop 0
    v_mfma_f32_16x16x32_bf16 v[188:191], v[20:23], v[24:27], 0
    ds_read_b128 v[20:23], v2 offset:1600
    ds_read_b128 v[24:27], v4 offset:16
    v_mfma_f32_16x16x32_bf16 v[188:191], v[28:31], v[32:35], v[188:191]
    ds_read_b128 v[28:31], v2 offset:2000
    ds_read_b128 v[32:35], v5 offset:16
    v_mfma_f32_16x16x32_bf16 v[188:191], v[36:39], v[40:43], v[188:191]
    ds_read_b128 v[36:39], v2 offset:2400
    ds_read_b128 v[40:43], v3 offset:32
    v_mfma_f32_16x16x32_bf16 v[192:195], v[44:47], v[48:51], 0
    ds_read_b128 v[44:47], v2 offset:2800
    ds_read_b128 v[48:51], v4 offset:32
    s_waitcnt lgkmcnt(0)
    s_nop 0
    v_mfma_f32_16x16x32_bf16 v[192:195], v[20:23], v[24:27], v[192:195]
    ds_read_b128 v[20:23], v2 offset:3200
    ds_read_b128 v[24:27], v5 offset:32
    v_mfma_f32_16x16x32_bf16 v[192:195], v[28:31], v[32:35], v[192:195]
    ds_read_b128 v[28:31], v2 offset:3600
    ds_read_b128 v[32:35], v3 offset:48
    v_mfma_f32_16x16x32_bf16 v[196:199], v[36:39], v[40:43], 0
    ds_read_b128 v[36:39], v2 offset:4000
    ds_read_b128 v[40:43], v4 offset:48
    v_mfma_f32_16x16x32_bf16 v[196:199], v[44:47], v[48:51], v[196:199]
    ds_read_b128 v[44:47], v2 offset:4400
    ds_read_b128 v[48:51], v5 offset:48
    s_waitcnt lgkmcnt(0)
    s_nop 0
    v_mfma_f32_16x16x32_bf16 v[196:199], v[20:23], v[24:27], v[196:199]
    ds_read_b128 v[20:23], v2 offset:4800
    ds_read_b128 v[24:27], v3 offset:64
    v_mfma_f32_16x16x32_bf16 v[200:203], v[28:31], v[32:35], 0
    ds_read_b128 v[28:31], v2 offset:5200
    ds_read_b128 v[32:35], v4 offset:64
    v_mfma_f32_16x16x32_bf16 v[200:203], v[36:39], v[40:43], v[200:203]
    ds_read_b128 v[36:39], v2 offset:5600
    ds_read_b128 v[40:43], v5 offset:64
    v_mfma_f32_16x16x32_bf16 v[200:203], v[44:47], v[48:51], v[200:203]
    ds_read_b128 v[44:47], v2 offset:6000
    ds_read_b128 v[48:51], v3 offset:80
    s_waitcnt lgkmcnt(0)
    s_nop 0
    v_mfma_f32_16x16x32_bf16 v[204:207], v[20:23], v[24:27], 0
    ds_read_b128 v[20:23], v2 offset:6400
    ds_read_b128 v[24:27], v4 offset:80
    v_mfma_f32_16x16x32_bf16 v[204:207], v[28:31], v[32:35], v[204:207]
    ds_read_b128 v[28:31], v2 offset:6800
    ds_read_b128 v[32:35], v5 offset:80
    v_mfma_f32_16x16x32_bf16 v[204:207], v[36:39], v[40:43], v[204:207]
    ds_read_b128 v[36:39], v2 offset:7200
    ds_read_b128 v[40:43], v3 offset:96
    v_mfma_f32_16x16x32_bf16 v[208:211], v[44:47], v[48:51], 0
    ds_read_b128 v[44:47], v2 offset:7600
    ds_read_b128 v[48:51], v4 offset:96
    s_waitcnt lgkmcnt(0)
    s_nop 0
    v_mfma_f32_16x16x32_bf16 v[208:211], v[20:23], v[24:27], v[208:211]
    ds_read_b128 v[20:23], v2 offset:8000
    ds_read_b128 v[24:27], v5 offset:96
    v_mfma_f32_16x16x32_bf16 v[208:211], v[28:31], v[32:35], v[208:211]
    ds_read_b128 v[28:31], v2 offset:8400
    ds_read_b128 v[32:35], v3 offset:112
    v_mfma_f32_16x16x32_bf16 v[212:215], v[36:39], v[40:43], 0
    ds_read_b128 v[36:39], v2 offset:8800
    ds_read_b128 v[40:43], v4 offset:112
    v_mfma_f32_16x16x32_bf16 v[212:215], v[44:47], v[48:51], v[212:215]
    ds_read_b128 v[44:47], v2 offset:9200
    ds_read_b128 v[48:51], v5 offset:112
    s_waitcnt lgkmcnt(0)
    s_nop 0
    v_mfma_f32_16x16x32_bf16 v[212:215], v[20:23], v[24:27], v[212:215]
    ds_read_b128 v[20:23], v2 offset:9600
    ds_read_b128 v[24:27], v3 offset:128
    v_mfma_f32_16x16x32_bf16 v[216:219], v[28:31], v[32:35], 0
    ds_read_b128 v[28:31], v2 offset:10000
    ds_read_b128 v[32:35], v4 offset:128
    v_mfma_f32_16x16x32_bf16 v[216:219], v[36:39], v[40:43], v[216:219]
    ds_read_b128 v[36:39], v2 offset:10400
    ds_read_b128 v[40:43], v5 offset:128
    v_mfma_f32_16x16x32_bf16 v[216:219], v[44:47], v[48:51], v[216:219]
    ds_read_b128 v[44:47], v2 offset:10800
    ds_read_b128 v[48:51], v3 offset:144
    s_waitcnt lgkmcnt(0)
    s_nop 0
    v_mfma_f32_16x16x32_bf16 v[220:223], v[20:23], v[24:27], 0
    ds_read_b128 v[20:23], v2 offset:11200
    ds_read_b128 v[24:27], v4 offset:144
    v_mfma_f32_16x16x32_bf16 v[220:223], v[28:31], v[32:35], v[220:223]
    ds_read_b128 v[28:31], v2 offset:11600
    ds_read_b128 v[32:35], v5 offset:144
    v_mfma_f32_16x16x32_bf16 v[220:223], v[36:39], v[40:43], v[220:223]
    ds_read_b128 v[36:39], v2 offset:12000
    ds_read_b128 v[40:43], v3 offset:160
    v_mfma_f32_16x16x32_bf16 v[224:227], v[44:47], v[48:51], 0
    ds_read_b128 v[44:47], v2 offset:12400
    ds_read_b128 v[48:51], v4 offset:160
    s_waitcnt lgkmcnt(0)
    s_nop 0
    v_mfma_f32_16x16x32_bf16 v[224:227], v[20:23], v[24:27], v[224:227]
    ds_read_b128 v[20:23], v2 offset:12800
    ds_read_b128 v[24:27], v5 offset:160
    v_mfma_f32_16x16x32_bf16 v[224:227], v[28:31], v[32:35], v[224:227]
    ds_read_b128 v[28:31], v2 offset:13200
    ds_read_b128 v[32:35], v3 offset:176
    v_mfma_f32_16x16x32_bf16 v[228:231], v[36:39], v[40:43], 0
    ds_read_b128 v[36:39], v2 offset:13600
    ds_read_b128 v[40:43], v4 offset:176
    v_mfma_f32_16x16x32_bf16 v[228:231], v[44:47], v[48:51], v[228:231]
    ds_read_b128 v[44:47], v2 offset:14000
    ds_read_b128 v[48:51], v5 offset:176
    s_waitcnt lgkmcnt(0)
    v_mfma_f32_16x16x32_bf16 v[228:231], v[20:23], v[24:27], v[228:231]
    v_mfma_f32_16x16x32_bf16 v[232:235], v[28:31], v[32:35], 0
    v_mfma_f32_16x16x32_bf16 v[232:235], v[36:39], v[40:43], v[232:235]
    v_mfma_f32_16x16x32_bf16 v[232:235], v[44:47], v[48:51], v[232:235]
    v_mov_b32 v14, 163536
    s_mov_b32 s10, 0
L_aw10:
    ds_read_b32 v15, v14 offset:16
    s_add_u32 s10, s10, 1
    s_waitcnt lgkmcnt(0)
    v_readfirstlane_b32 s9, v15
    s_lshr_b32 s55, s10, 22
    s_lshl_b32 s55, s55, 3
    s_or_b32 s9, s9, s55
    s_cmp_lt_u32 s9, 4
    s_cbranch_scc1 L_aw10
    ds_write_b128 v236, v[92:95] offset:0
    ds_write_b128 v236, v[96:99] offset:6144
    ds_write_b128 v236, v[100:103] offset:1024
    ds_write_b128 v236, v[104:107] offset:7168
    ds_write_b128 v236, v[140:143] offset:2048
    ds_write_b128 v236, v[144:147] offset:8192
    s_lshr_b32 s12, s62, 1
    s_add_u32 s12, s12, 7
    s_lshl_b32 s13, s69, 1
    s_sub_u32 s12, s12, s13
    s_and_b32 s13, s62, 1
    s_lshl_b32 s12, s12, 1
    s_add_u32 s9, s6, s12
    s_cmp_ge_u32 s9, 384
    s_cselect_b32 s10, 384, 0
    s_cselect_b32 s15, 1, 0
    s_sub_u32 s9, s9, s10
    s_add_u32 s15, s15, s5
    s_lshl_b32 s15, s15, 1
    s_add_u32 s15, s15, s13
    s_mul_i32 s53, s9, 73728
    s_mul_i32 s10, s15, 3072
    s_add_u32 s53, s53, s10
    s_cmp_eq_u32 s9, 0
    s_cselect_b32 s58, 0xffff, 0
    s_cmp_eq_u32 s9, 382
    s_cselect_b32 s59, 0xffff0000, 0
    s_cmp_eq_u32 s15, 0
    s_cselect_b32 s10, 0x00010001, 0
    s_or_b32 s56, s58, s10
    s_or_b32 s57, s59, s10
    s_cmp_eq_u32 s15, 23
    s_cselect_b32 s10, 0x80008000, 0
    s_or_b32 s60, s58, s10
    s_or_b32 s61, s59, s10
    s_mul_i32 s10, s13, 3328
    s_add_u32 s10, s10, 73728
    v_lshrrev_b32 v10, 4, v1
    v_add_u32 v10, s12, v10
    v_subrev_u32 v12, 10, v10
    v_min_u32 v10, v10, v12
    v_mul_u32_u24 v10, 7168, v10
    v_and_b32_e64 v12, 15, v1
    v_mul_u32_u24 v12, 208, v12
    v_add3_u32 v10, v10, v12, s10
    v_mov_b32 v13, 159808
    v_add_u32 v4, 208, v10
    v_add_u32 v5, 416, v10
    v_cndmask_b32 v3, v10, v13, s[56:57]
    v_cndmask_b32 v4, v4, v13, s[58:59]
    v_cndmask_b32 v5, v5, v13, s[60:61]
    s_waitcnt vmcnt(0)
    v_mov_b32 v14, 163536
    v_mov_b32_e64 v15, 1
    s_mov_b64 exec, 1
    ds_add_u32 v14, v15 offset:32
    s_mov_b64 exec, -1
    s_nop 0
    v_pk_add_f32 v[16:17], v[188:189], v[190:191]
    v_pk_mul_f32 v[20:21], v[188:189], v[188:189]
    v_pk_add_f32 v[18:19], v[192:193], v[194:195]
    v_pk_mul_f32 v[22:23], v[190:191], v[190:191]
    v_pk_fma_f32 v[20:21], v[192:193], v[192:193], v[20:21]
    v_pk_fma_f32 v[22:23], v[194:195], v[194:195], v[22:23]
    v_pk_add_f32 v[16:17], v[16:17], v[196:197]
    v_pk_fma_f32 v[20:21], v[196:197], v[196:197], v[20:21]
    v_pk_add_f32 v[18:19], v[18:19], v[198:199]
    v_pk_fma_f32 v[22:23], v[198:199], v[198:199], v[22:23]
    v_pk_add_f32 v[16:17], v[16:17], v[200:201]
    v_pk_fma_f32 v[20:21], v[200:201], v[200:201], v[20:21]
    v_pk_add_f32 v[18:19], v[18:19], v[202:203]
    v_pk_fma_f32 v[22:23], v[202:203], v[202:203], v[22:23]
    v_pk_add_f32 v[16:17], v[16:17], v[204:205]
    v_pk_fma_f32 v[20:21], v[204:205], v[204:205], v[20:21]
    v_pk_add_f32 v[18:19], v[18:19], v[206:207]
    v_pk_fma_f32 v[22:23], v[206:207], v[206:207], v[22:23]
    v_pk_add_f32 v[16:17], v[16:17], v[208:209]
    v_pk_fma_f32 v[20:21], v[208:209], v[208:209], v[20:21]
    v_pk_add_f32 v[18:19], v[18:19], v[210:211]
    v_pk_fma_f32 v[22:23], v[210:211], v[210:211], v[22:23]
    v_pk_add_f32 v[16:17], v[16:17], v[212:213]
    v_pk_fma_f32 v[20:21], v[212:213], v[212:213], v[20:21]
    v_pk_add_f32 v[18:19], v[18:19], v[214:215]
    v_pk_fma_f32 v[22:23], v[214:215], v[214:215], v[22:23]
    v_pk_add_f32 v[16:17], v[16:17], v[216:217]
    v_pk_fma_f32 v[20:21], v[216:217], v[216:217], v[20:21]
    v_pk_add_f32 v[18:19], v[18:19], v[218:219]
    v_pk_fma_f32 v[22:23], v[218:219], v[218:219], v[22:23]
    v_pk_add_f32 v[16:17], v[16:17], v[220:221]
    v_pk_fma_f32 v[20:21], v[220:221], v[220:221], v[20:21]
    v_pk_add_f32 v[18:19], v[18:19], v[222:223]
    v_pk_fma_f32 v[22:23], v[222:223], v[222:223], v[22:23]
    v_pk_add_f32 v[16:17], v[16:17], v[224:225]
    v_pk_fma_f32 v[20:21], v[224:225], v[224:225], v[20:21]
    v_pk_add_f32 v[18:19], v[18:19], v[226:227]
    v_pk_fma_f32 v[22:23], v[226:227], v[226:227], v[22:23]
    v_pk_add_f32 v[16:17], v[16:17], v[228:229]
    v_pk_fma_f32 v[20:21], v[228:229], v[228:229], v[20:21]
    v_pk_add_f32 v[18:19], v[18:19], v[230:231]
    v_pk_fma_f32 v[22:23], v[230:231], v[230:231], v[22:23]
    v_pk_add_f32 v[16:17], v[16:17], v[232:233]
    v_pk_fma_f32 v[20:21], v[232:233], v[232:233], v[20:21]
    v_pk_add_f32 v[18:19], v[18:19], v[234:235]
    v_pk_fma_f32 v[22:23], v[234:235], v[234:235], v[22:23]
    v_pk_add_f32 v[16:17], v[16:17], v[18:19]
    v_pk_add_f32 v[20:21], v[20:21], v[22:23]
    v_add_f32 v16, v16, v17
    v_add_f32 v20, v20, v21
    v_mov_b32 v17, v16
    v_mov_b32 v21, v20
    s_nop 0
    v_permlane32_swap_b32 v16, v17
    v_permlane32_swap_b32 v20, v21
    v_add_f32 v16, v16, v17
    v_add_f32_e64 v20, v20, v21
    v_mul_f32 v16, 0x3c2aaaab, v16
    v_mul_f32 v20, 0x3c2aaaab, v20
    v_fma_f32 v20, -v16, v16, v20
    v_max_f32_e64 v20, 0, v20
    v_add_f32 v20, 0x3727c5ac, v20
    v_rsq_f32 v20, v20
    s_nop 0
    v_mul_f32 v18, 0xbeeff558, v20
    v_mul_f32 v19, -v16, v18
    v_pk_fma_f32 v[188:189], v[188:189], v[18:19], v[18:19] op_sel:[0,0,1] op_sel_hi:[1,0,1]
    v_pk_fma_f32 v[190:191], v[190:191], v[18:19], v[18:19] op_sel:[0,0,1] op_sel_hi:[1,0,1]
    v_pk_fma_f32 v[192:193], v[192:193], v[18:19], v[18:19] op_sel:[0,0,1] op_sel_hi:[1,0,1]
    v_pk_fma_f32 v[194:195], v[194:195], v[18:19], v[18:19] op_sel:[0,0,1] op_sel_hi:[1,0,1]
    v_pk_fma_f32 v[196:197], v[196:197], v[18:19], v[18:19] op_sel:[0,0,1] op_sel_hi:[1,0,1]
    v_pk_fma_f32 v[198:199], v[198:199], v[18:19], v[18:19] op_sel:[0,0,1] op_sel_hi:[1,0,1]
    v_pk_fma_f32 v[200:201], v[200:201], v[18:19], v[18:19] op_sel:[0,0,1] op_sel_hi:[1,0,1]
    v_pk_fma_f32 v[202:203], v[202:203], v[18:19], v[18:19] op_sel:[0,0,1] op_sel_hi:[1,0,1]
    v_pk_fma_f32 v[204:205], v[204:205], v[18:19], v[18:19] op_sel:[0,0,1] op_sel_hi:[1,0,1]
    v_pk_fma_f32 v[206:207], v[206:207], v[18:19], v[18:19] op_sel:[0,0,1] op_sel_hi:[1,0,1]
    v_pk_fma_f32 v[208:209], v[208:209], v[18:19], v[18:19] op_sel:[0,0,1] op_sel_hi:[1,0,1]
    v_pk_fma_f32 v[210:211], v[210:211], v[18:19], v[18:19] op_sel:[0,0,1] op_sel_hi:[1,0,1]
    v_pk_fma_f32 v[212:213], v[212:213], v[18:19], v[18:19] op_sel:[0,0,1] op_sel_hi:[1,0,1]
    v_pk_fma_f32 v[214:215], v[214:215], v[18:19], v[18:19] op_sel:[0,0,1] op_sel_hi:[1,0,1]
    v_pk_fma_f32 v[216:217], v[216:217], v[18:19], v[18:19] op_sel:[0,0,1] op_sel_hi:[1,0,1]
    v_pk_fma_f32 v[218:219], v[218:219], v[18:19], v[18:19] op_sel:[0,0,1] op_sel_hi:[1,0,1]
    v_pk_fma_f32 v[220:221], v[220:221], v[18:19], v[18:19] op_sel:[0,0,1] op_sel_hi:[1,0,1]
    v_pk_fma_f32 v[222:223], v[222:223], v[18:19], v[18:19] op_sel:[0,0,1] op_sel_hi:[1,0,1]
    v_pk_fma_f32 v[224:225], v[224:225], v[18:19], v[18:19] op_sel:[0,0,1] op_sel_hi:[1,0,1]
    v_pk_fma_f32 v[226:227], v[226:227], v[18:19], v[18:19] op_sel:[0,0,1] op_sel_hi:[1,0,1]
    v_pk_fma_f32 v[228:229], v[228:229], v[18:19], v[18:19] op_sel:[0,0,1] op_sel_hi:[1,0,1]
    v_pk_fma_f32 v[230:231], v[230:231], v[18:19], v[18:19] op_sel:[0,0,1] op_sel_hi:[1,0,1]
    v_pk_fma_f32 v[232:233], v[232:233], v[18:19], v[18:19] op_sel:[0,0,1] op_sel_hi:[1,0,1]
    v_pk_fma_f32 v[234:235], v[234:235], v[18:19], v[18:19] op_sel:[0,0,1] op_sel_hi:[1,0,1]
    s_waitcnt lgkmcnt(0)
    v_mov_b32 v14, 163536
    v_mov_b32_e64 v15, 1
    s_mov_b64 exec, 1
    ds_add_u32 v14, v15 offset:28
    s_mov_b64 exec, -1
    v_mov_b32 v14, 163536
    s_mov_b32 s10, 0
L_aw11:
    ds_read_b32 v15, v14 offset:28
    s_add_u32 s10, s10, 1
    s_waitcnt lgkmcnt(0)
    v_readfirstlane_b32 s9, v15
    s_lshr_b32 s55, s10, 22
    s_lshl_b32 s55, s55, 3
    s_or_b32 s9, s9, s55
    s_cmp_lt_u32 s9, 4
    s_cbranch_scc1 L_aw11
    s_mov_b32 exec_hi, 0x00ffffff
    s_add_u32 s9, s7, 884736
    s_sub_u32 s10, s9, 28305408
    s_cmp_le_u32 s8, 12
    s_cselect_b32 s9, s10, s9
    s_add_u32 m0, s11, 14336
    v_add_u32_e64 v10, s9, v9
    buffer_load_dwordx4 v10, s[36:39], 0 offen  lds
    s_sub_u32 m0, m0, 3584
    v_add_u32_e64 v10, s9, v251
    buffer_load_dwordx4 v10, s[36:39], 0 offen  lds
    s_add_u32 s9, s7, 958464
    s_sub_u32 s10, s9, 28305408
    s_cmp_le_u32 s8, 13
    s_cselect_b32 s9, s10, s9
    s_add_u32 m0, s11, 21504
    v_add_u32_e64 v10, s9, v9
    buffer_load_dwordx4 v10, s[36:39], 0 offen  lds
    s_sub_u32 m0, m0, 3584
    v_add_u32_e64 v10, s9, v251
    buffer_load_dwordx4 v10, s[36:39], 0 offen  lds
    s_add_u32 s9, s7, 1032192
    s_sub_u32 s10, s9, 28305408
    s_cmp_le_u32 s8, 14
    s_cselect_b32 s9, s10, s9
    s_add_u32 m0, s11, 28672
    v_add_u32_e64 v10, s9, v9
    buffer_load_dwordx4 v10, s[36:39], 0 offen  lds
    s_sub_u32 m0, m0, 3584
    v_add_u32_e64 v10, s9, v251
    buffer_load_dwordx4 v10, s[36:39], 0 offen  lds
    s_add_u32 s9, s7, 1105920
    s_sub_u32 s10, s9, 28305408
    s_cmp_le_u32 s8, 15
    s_cselect_b32 s9, s10, s9
    s_add_u32 m0, s11, 35840
    v_add_u32_e64 v10, s9, v9
    buffer_load_dwordx4 v10, s[36:39], 0 offen  lds
    s_sub_u32 m0, m0, 3584
    v_add_u32_e64 v10, s9, v251
    buffer_load_dwordx4 v10, s[36:39], 0 offen  lds
    s_mov_b32 exec_hi, -1
    s_nop 0
    ds_read_b128 v[24:27], v6 offset:0
    ds_read_b128 v[28:31], v6 offset:1024
    ds_read_b128 v[32:35], v6 offset:2048
    ds_read_b128 v[252:255], v6 offset:3072
    v_cvt_pk_bf16_f32 v68, v188, v189
    v_cvt_pk_bf16_f32 v69, v190, v191
    v_cvt_pk_bf16_f32 v70, v192, v193
    v_cvt_pk_bf16_f32 v71, v194, v195
    v_cvt_pk_bf16_f32 v72, v196, v197
    v_cvt_pk_bf16_f32 v73, v198, v199
    v_cvt_pk_bf16_f32 v74, v200, v201
    v_cvt_pk_bf16_f32 v75, v202, v203
    s_waitcnt lgkmcnt(3)
    s_nop 0
    v_mfma_f32_32x32x16_bf16 v[36:51], v[68:71], v[24:27], 0
    ds_read_b128 v[24:27], v6 offset:4096
    v_cvt_pk_bf16_f32 v76, v204, v205
    v_cvt_pk_bf16_f32 v77, v206, v207
    v_cvt_pk_bf16_f32 v78, v208, v209
    v_cvt_pk_bf16_f32 v79, v210, v211
    s_waitcnt lgkmcnt(3)
    s_nop 0
    v_mfma_f32_32x32x16_bf16 v[36:51], v[72:75], v[28:31], v[36:51]
    ds_read_b128 v[28:31], v6 offset:5120
    v_cvt_pk_bf16_f32 v80, v212, v213
    v_cvt_pk_bf16_f32 v81, v214, v215
    v_cvt_pk_bf16_f32 v82, v216, v217
    v_cvt_pk_bf16_f32 v83, v218, v219
    s_waitcnt lgkmcnt(3)
    s_nop 0
    v_mfma_f32_32x32x16_bf16 v[36:51], v[76:79], v[32:35], v[36:51]
    ds_read_b128 v[32:35], v6 offset:6144
    v_cvt_pk_bf16_f32 v84, v220, v221
    v_cvt_pk_bf16_f32 v85, v222, v223
    v_cvt_pk_bf16_f32 v86, v224, v225
    v_cvt_pk_bf16_f32 v87, v226, v227
    s_waitcnt lgkmcnt(3)
    s_nop 0
    v_mfma_f32_32x32x16_bf16 v[36:51], v[80:83], v[252:255], v[36:51]
    ds_read_b128 v[252:255], v6 offset:7168
    v_cvt_pk_bf16_f32 v88, v228, v229
    v_cvt_pk_bf16_f32 v89, v230, v231
    v_cvt_pk_bf16_f32 v90, v232, v233
    v_cvt_pk_bf16_f32 v91, v234, v235
    s_waitcnt lgkmcnt(3)
    v_mfma_f32_32x32x16_bf16 v[36:51], v[84:87], v[24:27], v[36:51]
    ds_read_b128 v[24:27], v6 offset:8192
    s_waitcnt lgkmcnt(3)
    v_mfma_f32_32x32x16_bf16 v[36:51], v[88:91], v[28:31], v[36:51]
    ds_read_b128 v[28:31], v6 offset:9216
    s_waitcnt lgkmcnt(0)
    s_nop 11
L_join1:
    v_mov_b32 v14, 163616
    ds_read_b128 v[16:19], v14
    s_waitcnt lgkmcnt(0)
    v_max_f32 v16, v16, v17
    v_max_f32 v18, v18, v19
    v_add_f32 v16, v16, v18
    v_cmp_gt_f32 vcc, 0x3f11ce1c, v16
    s_nop 4
    s_cbranch_vccz L_slow
    v_pk_fma_f32 v[16:17], v[36:37], v[36:37], s[34:35]
    v_pk_fma_f32 v[18:19], v[38:39], v[38:39], s[34:35]
    v_pk_fma_f32 v[20:21], v[40:41], v[40:41], s[34:35]
    v_pk_fma_f32 v[22:23], v[42:43], v[42:43], s[34:35]
    v_pk_mul_f32 v[16:17], v[16:17], v[36:37]
    v_pk_mul_f32 v[18:19], v[18:19], v[38:39]
    v_pk_mul_f32 v[20:21], v[20:21], v[40:41]
    v_pk_mul_f32 v[22:23], v[22:23], v[42:43]
    s_setprio 1
    v_mfma_f32_32x32x16_bf16 v[52:67], v[68:71], v[32:35], 0
    v_exp_f32 v16, v16
    v_exp_f32 v17, v17
    v_exp_f32 v18, v18
    v_mfma_f32_32x32x16_bf16 v[52:67], v[72:75], v[252:255], v[52:67]
    v_exp_f32 v19, v19
    v_exp_f32 v20, v20
    v_exp_f32 v21, v21
    v_exp_f32 v22, v22
    v_exp_f32_e64 v23, v23
    v_pk_add_f32 v[16:17], v[16:17], 1.0 op_sel_hi:[1,0]
    v_pk_add_f32 v[20:21], v[20:21], 1.0 op_sel_hi:[1,0]
    v_pk_fma_f32 v[36:37], v[36:37], v[18:19], v[36:37]
    v_pk_fma_f32 v[40:41], v[40:41], v[22:23], v[40:41]
    v_pk_fma_f32 v[18:19], v[16:17], v[18:19], v[16:17]
    v_pk_fma_f32 v[22:23], v[20:21], v[22:23], v[20:21]
    v_pk_mul_f32 v[38:39], v[38:39], v[16:17]
    v_pk_mul_f32 v[42:43], v[42:43], v[20:21]
    ds_read_b128 v[32:35], v6 offset:10240
    ds_read_b128 v[252:255], v6 offset:11264
    v_mfma_f32_32x32x16_bf16 v[52:67], v[76:79], v[24:27], v[52:67]
    v_rcp_f32 v18, v18
    v_rcp_f32 v19, v19
    v_rcp_f32 v22, v22
    v_rcp_f32 v23, v23
    v_pk_mul_f32 v[36:37], v[36:37], v[18:19]
    v_pk_mul_f32 v[38:39], v[38:39], v[18:19]
    v_pk_mul_f32 v[40:41], v[40:41], v[22:23]
    v_pk_mul_f32 v[42:43], v[42:43], v[22:23]
    v_pk_fma_f32 v[16:17], v[44:45], v[44:45], s[34:35]
    v_pk_fma_f32 v[18:19], v[46:47], v[46:47], s[34:35]
    v_pk_fma_f32 v[20:21], v[48:49], v[48:49], s[34:35]
    v_pk_fma_f32 v[22:23], v[50:51], v[50:51], s[34:35]
    v_pk_mul_f32 v[16:17], v[16:17], v[44:45]
    v_pk_mul_f32 v[18:19], v[18:19], v[46:47]
    v_pk_mul_f32 v[20:21], v[20:21], v[48:49]
    v_pk_mul_f32 v[22:23], v[22:23], v[50:51]
    s_waitcnt lgkmcnt(0)
    ds_read_b128 v[24:27], v7 offset:0
    v_mfma_f32_32x32x16_bf16 v[52:67], v[80:83], v[28:31], v[52:67]
    v_exp_f32 v16, v16
    v_exp_f32 v17, v17
    v_exp_f32 v18, v18
    v_mfma_f32_32x32x16_bf16 v[52:67], v[84:87], v[32:35], v[52:67]
    v_exp_f32 v19, v19
    v_exp_f32 v20, v20
    v_exp_f32 v21, v21
    v_exp_f32 v22, v22
    v_exp_f32_e64 v23, v23
    v_pk_add_f32 v[16:17], v[16:17], 1.0 op_sel_hi:[1,0]
    v_pk_add_f32 v[20:21], v[20:21], 1.0 op_sel_hi:[1,0]
    v_pk_fma_f32 v[44:45], v[44:45], v[18:19], v[44:45]
    v_pk_fma_f32 v[48:49], v[48:49], v[22:23], v[48:49]
    v_pk_fma_f32 v[18:19], v[16:17], v[18:19], v[16:17]
    v_pk_fma_f32 v[22:23], v[20:21], v[22:23], v[20:21]
    v_pk_mul_f32 v[46:47], v[46:47], v[16:17]
    v_pk_mul_f32 v[50:51], v[50:51], v[20:21]
    ds_read_b128 v[28:31], v7 offset:1024
    ds_read_b128 v[32:35], v7 offset:2048
    v_mfma_f32_32x32x16_bf16 v[52:67], v[88:91], v[252:255], v[52:67]
    v_rcp_f32 v18, v18
    v_rcp_f32 v19, v19
    v_rcp_f32 v22, v22
    v_rcp_f32 v23, v23
    v_cvt_pk_bf16_f32 v92, v36, v37
    v_cvt_pk_bf16_f32 v93, v38, v39
    v_cvt_pk_bf16_f32 v94, v40, v41
    v_cvt_pk_bf16_f32 v95, v42, v43
    v_pk_mul_f32 v[44:45], v[44:45], v[18:19]
    v_pk_mul_f32 v[46:47], v[46:47], v[18:19]
    v_pk_mul_f32 v[48:49], v[48:49], v[22:23]
    v_pk_mul_f32 v[50:51], v[50:51], v[22:23]
    v_cvt_pk_bf16_f32 v96, v44, v45
    v_cvt_pk_bf16_f32 v97, v46, v47
    v_cvt_pk_bf16_f32 v98, v48, v49
    v_cvt_pk_bf16_f32 v99, v50, v51
    v_dot2_f32_bf16 v11, v92, v92, 0
    v_dot2_f32_bf16 v11, v93, v93, v11
    v_dot2_f32_bf16 v11, v94, v94, v11
    v_dot2_f32_bf16 v11, v95, v95, v11
    v_dot2_f32_bf16 v11, v96, v96, v11
    v_dot2_f32_bf16 v11, v97, v97, v11
    v_dot2_f32_bf16 v11, v98, v98, v11
    v_dot2_f32_bf16 v11, v99, v99, v11
    ds_read_b128 v[252:255], v7 offset:3072
    s_cmp_lg_u32 s69, 1
    s_cbranch_scc1 L_skip12
    v_mov_b32 v14, 163536
    s_mov_b32 s10, 0
L_aw13:
    ds_read_b32 v15, v14 offset:20
    s_add_u32 s10, s10, 1
    s_waitcnt lgkmcnt(0)
    v_readfirstlane_b32 s9, v15
    s_lshr_b32 s55, s10, 22
    s_lshl_b32 s55, s55, 3
    s_or_b32 s9, s9, s55
    s_cmp_lt_u32 s9, 4
    s_cbranch_scc1 L_aw13
    s_nop 0
    ds_write_b128 v236, v[108:111] offset:12288
    ds_write_b128 v236, v[112:115] offset:18432
    ds_write_b128 v236, v[116:119] offset:13312
    ds_write_b128 v236, v[120:123] offset:19456
    ds_write_b128 v236, v[156:159] offset:14336
    ds_write_b128 v236, v[160:163] offset:20480
L_skip12:
    s_cmp_lg_u32 s69, 0
    s_cbranch_scc1 L_skip14
    s_add_u32 s9, s63, 0
    s_nop 1
    buffer_store_dwordx4 v[108:111], v6, s[40:43], s9 offen sc1 nt
    s_add_u32 s9, s63, 1024
    buffer_store_dwordx4 v[112:115], v6, s[40:43], s9 offen sc1 nt
    s_add_u32 s9, s63, 2048
    buffer_store_dwordx4 v[116:119], v6, s[40:43], s9 offen sc1 nt
L_skip14:
    v_pk_fma_f32 v[16:17], v[52:53], v[52:53], s[34:35]
    v_pk_fma_f32 v[18:19], v[54:55], v[54:55], s[34:35]
    v_pk_fma_f32 v[20:21], v[56:57], v[56:57], s[34:35]
    v_pk_fma_f32 v[22:23], v[58:59], v[58:59], s[34:35]
    v_pk_mul_f32 v[16:17], v[16:17], v[52:53]
    v_pk_mul_f32 v[18:19], v[18:19], v[54:55]
    v_pk_mul_f32 v[20:21], v[20:21], v[56:57]
    v_pk_mul_f32 v[22:23], v[22:23], v[58:59]
    v_cvt_f64_f32 v[12:13], v11
    s_waitcnt lgkmcnt(1)
    v_mfma_f32_32x32x16_bf16 v[36:51], v[68:71], v[24:27], 0
    v_exp_f32 v16, v16
    v_exp_f32 v17, v17
    v_exp_f32_e64 v18, v18
    v_mfma_f32_32x32x16_bf16 v[36:51], v[72:75], v[28:31], v[36:51]
    v_exp_f32 v19, v19
    v_exp_f32 v20, v20
    v_exp_f32 v21, v21
    v_exp_f32 v22, v22
    v_exp_f32_e64 v23, v23
    v_pk_add_f32 v[16:17], v[16:17], 1.0 op_sel_hi:[1,0]
    v_pk_add_f32 v[20:21], v[20:21], 1.0 op_sel_hi:[1,0]
    v_pk_fma_f32 v[52:53], v[52:53], v[18:19], v[52:53]
    v_pk_fma_f32 v[56:57], v[56:57], v[22:23], v[56:57]
    v_pk_fma_f32 v[18:19], v[16:17], v[18:19], v[16:17]
    v_pk_fma_f32 v[22:23], v[20:21], v[22:23], v[20:21]
    v_pk_mul_f32 v[54:55], v[54:55], v[16:17]
    v_pk_mul_f32 v[58:59], v[58:59], v[20:21]
    ds_read_b128 v[24:27], v7 offset:4096
    ds_read_b128 v[28:31], v7 offset:5120
    ds_add_f64 v8, v[12:13] offset:0
    v_mfma_f32_32x32x16_bf16 v[36:51], v[76:79], v[32:35], v[36:51]
    v_rcp_f32 v18, v18
    v_rcp_f32 v19, v19
    v_rcp_f32 v22, v22
    v_rcp_f32 v23, v23
    v_pk_mul_f32 v[52:53], v[52:53], v[18:19]
    v_pk_mul_f32 v[54:55], v[54:55], v[18:19]
    v_pk_mul_f32 v[56:57], v[56:57], v[22:23]
    v_pk_mul_f32 v[58:59], v[58:59], v[22:23]
    v_pk_fma_f32 v[16:17], v[60:61], v[60:61], s[34:35]
    v_pk_fma_f32 v[18:19], v[62:63], v[62:63], s[34:35]
    v_pk_fma_f32 v[20:21], v[64:65], v[64:65], s[34:35]
    v_pk_fma_f32 v[22:23], v[66:67], v[66:67], s[34:35]
    v_pk_mul_f32 v[16:17], v[16:17], v[60:61]
    v_pk_mul_f32 v[18:19], v[18:19], v[62:63]
    v_pk_mul_f32 v[20:21], v[20:21], v[64:65]
    v_pk_mul_f32 v[22:23], v[22:23], v[66:67]
    s_waitcnt lgkmcnt(1)
    ds_read_b128 v[32:35], v7 offset:6144
    v_mfma_f32_32x32x16_bf16 v[36:51], v[80:83], v[252:255], v[36:51]
    v_exp_f32 v16, v16
    v_exp_f32 v17, v17
    v_exp_f32 v18, v18
    v_mfma_f32_32x32x16_bf16 v[36:51], v[84:87], v[24:27], v[36:51]
    v_exp_f32 v19, v19
    v_exp_f32 v20, v20
    v_exp_f32 v21, v21
    v_exp_f32 v22, v22
    v_exp_f32_e64 v23, v23
    v_pk_add_f32 v[16:17], v[16:17], 1.0 op_sel_hi:[1,0]
    v_pk_add_f32 v[20:21], v[20:21], 1.0 op_sel_hi:[1,0]
    v_pk_fma_f32 v[60:61], v[60:61], v[18:19], v[60:61]
    v_pk_fma_f32 v[64:65], v[64:65], v[22:23], v[64:65]
    v_pk_fma_f32 v[18:19], v[16:17], v[18:19], v[16:17]
    v_pk_fma_f32 v[22:23], v[20:21], v[22:23], v[20:21]
    v_pk_mul_f32 v[62:63], v[62:63], v[16:17]
    v_pk_mul_f32 v[66:67], v[66:67], v[20:21]
    ds_read_b128 v[252:255], v7 offset:7168
    ds_read_b128 v[24:27], v7 offset:8192
    v_mfma_f32_32x32x16_bf16 v[36:51], v[88:91], v[28:31], v[36:51]
    v_rcp_f32 v18, v18
    v_rcp_f32 v19, v19
    v_rcp_f32 v22, v22
    v_rcp_f32 v23, v23
    v_cvt_pk_bf16_f32 v100, v52, v53
    v_cvt_pk_bf16_f32 v101, v54, v55
    v_cvt_pk_bf16_f32 v102, v56, v57
    v_cvt_pk_bf16_f32 v103, v58, v59
    v_pk_mul_f32 v[60:61], v[60:61], v[18:19]
    v_pk_mul_f32 v[62:63], v[62:63], v[18:19]
    v_pk_mul_f32 v[64:65], v[64:65], v[22:23]
    v_pk_mul_f32 v[66:67], v[66:67], v[22:23]
    v_cvt_pk_bf16_f32 v104, v60, v61
    v_cvt_pk_bf16_f32 v105, v62, v63
    v_cvt_pk_bf16_f32 v106, v64, v65
    v_cvt_pk_bf16_f32 v107, v66, v67
    v_dot2_f32_bf16 v11, v100, v100, 0
    v_dot2_f32_bf16 v11, v101, v101, v11
    v_dot2_f32_bf16 v11, v102, v102, v11
    v_dot2_f32_bf16 v11, v103, v103, v11
    v_dot2_f32_bf16 v11, v104, v104, v11
    v_dot2_f32_bf16 v11, v105, v105, v11
    v_dot2_f32_bf16 v11, v106, v106, v11
    v_dot2_f32_bf16 v11, v107, v107, v11
    ds_read_b128 v[28:31], v7 offset:9216
    s_cmp_lg_u32 s69, 1
    s_cbranch_scc1 L_skip15
    s_waitcnt lgkmcnt(0)
    v_mov_b32 v14, 163536
    v_mov_b32_e64 v15, 1
    s_mov_b64 exec, 1
    ds_add_u32 v14, v15 offset:36
    s_mov_b64 exec, -1
L_skip15:
    v_mov_b32 v14, 163536
    s_mov_b32 s10, 0
L_aw16:
    ds_read_b32 v15, v14 offset:36
    s_add_u32 s10, s10, 1
    s_waitcnt lgkmcnt(0)
    v_readfirstlane_b32 s9, v15
    s_lshr_b32 s55, s10, 22
    s_lshl_b32 s55, s55, 3
    s_or_b32 s9, s9, s55
    s_cmp_lt_u32 s9, 4
    s_cbranch_scc1 L_aw16
    s_cmp_lg_u32 s69, 0
    s_cbranch_scc1 L_skip17
    s_add_u32 s9, s63, 3072
    buffer_store_dwordx4 v[120:123], v6, s[40:43], s9 offen sc1 nt
    s_add_u32 s9, s63, 4096
    buffer_store_dwordx4 v[156:159], v6, s[40:43], s9 offen sc1 nt
    s_add_u32 s9, s63, 5120
    buffer_store_dwordx4 v[160:163], v6, s[40:43], s9 offen sc1 nt
L_skip17:
    v_pk_fma_f32 v[16:17], v[36:37], v[36:37], s[34:35]
    v_pk_fma_f32 v[18:19], v[38:39], v[38:39], s[34:35]
    v_pk_fma_f32 v[20:21], v[40:41], v[40:41], s[34:35]
    v_pk_fma_f32 v[22:23], v[42:43], v[42:43], s[34:35]
    v_pk_mul_f32 v[16:17], v[16:17], v[36:37]
    v_pk_mul_f32 v[18:19], v[18:19], v[38:39]
    v_pk_mul_f32 v[20:21], v[20:21], v[40:41]
    v_pk_mul_f32 v[22:23], v[22:23], v[42:43]
    v_cvt_f64_f32_e64 v[12:13], v11
    v_mfma_f32_32x32x16_bf16 v[52:67], v[68:71], v[32:35], 0
    v_exp_f32 v16, v16
    v_exp_f32 v17, v17
    v_exp_f32_e64 v18, v18
    v_mfma_f32_32x32x16_bf16 v[52:67], v[72:75], v[252:255], v[52:67]
    v_exp_f32 v19, v19
    v_exp_f32 v20, v20
    v_exp_f32 v21, v21
    v_exp_f32 v22, v22
    v_exp_f32_e64 v23, v23
    v_pk_add_f32 v[16:17], v[16:17], 1.0 op_sel_hi:[1,0]
    v_pk_add_f32 v[20:21], v[20:21], 1.0 op_sel_hi:[1,0]
    v_pk_fma_f32 v[36:37], v[36:37], v[18:19], v[36:37]
    v_pk_fma_f32 v[40:41], v[40:41], v[22:23], v[40:41]
    v_pk_fma_f32 v[18:19], v[16:17], v[18:19], v[16:17]
    v_pk_fma_f32 v[22:23], v[20:21], v[22:23], v[20:21]
    v_pk_mul_f32 v[38:39], v[38:39], v[16:17]
    v_pk_mul_f32 v[42:43], v[42:43], v[20:21]
    ds_read_b128 v[32:35], v7 offset:10240
    ds_read_b128 v[252:255], v7 offset:11264
    ds_add_f64 v8, v[12:13] offset:256
    v_mfma_f32_32x32x16_bf16 v[52:67], v[76:79], v[24:27], v[52:67]
    v_rcp_f32 v18, v18
    v_rcp_f32 v19, v19
    v_rcp_f32 v22, v22
    v_rcp_f32 v23, v23
    v_pk_mul_f32 v[36:37], v[36:37], v[18:19]
    v_pk_mul_f32 v[38:39], v[38:39], v[18:19]
    v_pk_mul_f32 v[40:41], v[40:41], v[22:23]
    v_pk_mul_f32 v[42:43], v[42:43], v[22:23]
    v_pk_fma_f32 v[16:17], v[44:45], v[44:45], s[34:35]
    v_pk_fma_f32 v[18:19], v[46:47], v[46:47], s[34:35]
    v_pk_fma_f32 v[20:21], v[48:49], v[48:49], s[34:35]
    v_pk_fma_f32 v[22:23], v[50:51], v[50:51], s[34:35]
    v_pk_mul_f32 v[16:17], v[16:17], v[44:45]
    v_pk_mul_f32 v[18:19], v[18:19], v[46:47]
    v_pk_mul_f32 v[20:21], v[20:21], v[48:49]
    v_pk_mul_f32 v[22:23], v[22:23], v[50:51]
    s_waitcnt lgkmcnt(1)
    ds_read_b128 v[24:27], v6 offset:12288
    v_mfma_f32_32x32x16_bf16 v[52:67], v[80:83], v[28:31], v[52:67]
    v_exp_f32 v16, v16
    v_exp_f32 v17, v17
    v_exp_f32 v18, v18
    v_mfma_f32_32x32x16_bf16 v[52:67], v[84:87], v[32:35], v[52:67]
    v_exp_f32 v19, v19
    v_exp_f32 v20, v20
    v_exp_f32 v21, v21
    v_exp_f32 v22, v22
    v_exp_f32_e64 v23, v23
    v_pk_add_f32 v[16:17], v[16:17], 1.0 op_sel_hi:[1,0]
    v_pk_add_f32 v[20:21], v[20:21], 1.0 op_sel_hi:[1,0]
    v_pk_fma_f32 v[44:45], v[44:45], v[18:19], v[44:45]
    v_pk_fma_f32 v[48:49], v[48:49], v[22:23], v[48:49]
    v_pk_fma_f32 v[18:19], v[16:17], v[18:19], v[16:17]
    v_pk_fma_f32 v[22:23], v[20:21], v[22:23], v[20:21]
    v_pk_mul_f32 v[46:47], v[46:47], v[16:17]
    v_pk_mul_f32 v[50:51], v[50:51], v[20:21]
    ds_read_b128 v[28:31], v6 offset:13312
    ds_read_b128 v[32:35], v6 offset:14336
    v_mfma_f32_32x32x16_bf16 v[52:67], v[88:91], v[252:255], v[52:67]
    v_rcp_f32 v18, v18
    v_rcp_f32 v19, v19
    v_rcp_f32 v22, v22
    v_rcp_f32 v23, v23
    v_cvt_pk_bf16_f32 v140, v36, v37
    v_cvt_pk_bf16_f32 v141, v38, v39
    v_cvt_pk_bf16_f32 v142, v40, v41
    v_cvt_pk_bf16_f32 v143, v42, v43
    v_pk_mul_f32 v[44:45], v[44:45], v[18:19]
    v_pk_mul_f32 v[46:47], v[46:47], v[18:19]
    v_pk_mul_f32 v[48:49], v[48:49], v[22:23]
    v_pk_mul_f32 v[50:51], v[50:51], v[22:23]
    v_cvt_pk_bf16_f32 v144, v44, v45
    v_cvt_pk_bf16_f32 v145, v46, v47
    v_cvt_pk_bf16_f32 v146, v48, v49
    v_cvt_pk_bf16_f32 v147, v50, v51
    v_dot2_f32_bf16 v11, v140, v140, 0
    v_dot2_f32_bf16 v11, v141, v141, v11
    v_dot2_f32_bf16 v11, v142, v142, v11
    v_dot2_f32_bf16 v11, v143, v143, v11
    v_dot2_f32_bf16 v11, v144, v144, v11
    v_dot2_f32_bf16 v11, v145, v145, v11
    v_dot2_f32_bf16 v11, v146, v146, v11
    v_dot2_f32_bf16 v11, v147, v147, v11
    ds_read_b128 v[252:255], v6 offset:15360
    s_cmp_lg_u32 s69, 0
    s_cbranch_scc1 L_skip18
    s_waitcnt vmcnt(6)
L_skip18:
    s_cmp_lg_u32 s69, 1
    s_cbranch_scc1 L_skip19
    s_waitcnt vmcnt(0)
L_skip19:
    s_lshl_b32 s9, s69, 2
    s_add_u32 s9, s9, 163536
    v_mov_b32 v14, s9
    v_mov_b32 v15, 1
    s_mov_b64 exec, 1
    ds_add_u32 v14, v15 offset:44
    s_mov_b64 exec, -1
    s_cmp_lg_u32 s68, 0
    s_cbranch_scc1 L_skip20
    v_mov_b32 v14, 1
    v_mov_b32 v15, 0
    s_mov_b64 exec, 1
    global_atomic_add v15, v14, s[30:31]
    s_mov_b64 exec, -1
L_skip20:
    s_cmp_lg_u32 s69, 0
    s_cbranch_scc1 L_skip21
    s_nop 0
    s_add_u32 s9, s63, 6144
    buffer_store_dwordx4 v[164:167], v6, s[40:43], s9 offen sc1 nt
    s_add_u32 s9, s63, 7168
    buffer_store_dwordx4 v[168:171], v6, s[40:43], s9 offen sc1 nt
    s_add_u32 s9, s63, 8192
    buffer_store_dwordx4 v[124:127], v6, s[40:43], s9 offen sc1 nt
L_skip21:
    v_pk_fma_f32 v[16:17], v[52:53], v[52:53], s[34:35]
    v_pk_fma_f32 v[18:19], v[54:55], v[54:55], s[34:35]
    v_pk_fma_f32 v[20:21], v[56:57], v[56:57], s[34:35]
    v_pk_fma_f32 v[22:23], v[58:59], v[58:59], s[34:35]
    v_pk_mul_f32 v[16:17], v[16:17], v[52:53]
    v_pk_mul_f32 v[18:19], v[18:19], v[54:55]
    v_pk_mul_f32 v[20:21], v[20:21], v[56:57]
    v_pk_mul_f32 v[22:23], v[22:23], v[58:59]
    v_cvt_f64_f32 v[12:13], v11
    s_waitcnt lgkmcnt(2)
    v_mfma_f32_32x32x16_bf16 v[36:51], v[68:71], v[24:27], 0
    v_exp_f32 v16, v16
    v_exp_f32 v17, v17
    v_exp_f32_e64 v18, v18
    v_mfma_f32_32x32x16_bf16 v[36:51], v[72:75], v[28:31], v[36:51]
    v_exp_f32 v19, v19
    v_exp_f32 v20, v20
    v_exp_f32 v21, v21
    v_exp_f32 v22, v22
    v_exp_f32_e64 v23, v23
    v_pk_add_f32 v[16:17], v[16:17], 1.0 op_sel_hi:[1,0]
    v_pk_add_f32 v[20:21], v[20:21], 1.0 op_sel_hi:[1,0]
    v_pk_fma_f32 v[52:53], v[52:53], v[18:19], v[52:53]
    v_pk_fma_f32 v[56:57], v[56:57], v[22:23], v[56:57]
    v_pk_fma_f32 v[18:19], v[16:17], v[18:19], v[16:17]
    v_pk_fma_f32 v[22:23], v[20:21], v[22:23], v[20:21]
    v_pk_mul_f32 v[54:55], v[54:55], v[16:17]
    v_pk_mul_f32 v[58:59], v[58:59], v[20:21]
    ds_read_b128 v[24:27], v6 offset:16384
    ds_read_b128 v[28:31], v6 offset:17408
    ds_add_f64 v8, v[12:13] offset:1536
    v_mfma_f32_32x32x16_bf16 v[36:51], v[76:79], v[32:35], v[36:51]
    v_rcp_f32 v18, v18
    v_rcp_f32 v19, v19
    v_rcp_f32 v22, v22
    v_rcp_f32 v23, v23
    v_pk_mul_f32 v[52:53], v[52:53], v[18:19]
    v_pk_mul_f32 v[54:55], v[54:55], v[18:19]
    v_pk_mul_f32 v[56:57], v[56:57], v[22:23]
    v_pk_mul_f32 v[58:59], v[58:59], v[22:23]
    v_pk_fma_f32 v[16:17], v[60:61], v[60:61], s[34:35]
    v_pk_fma_f32 v[18:19], v[62:63], v[62:63], s[34:35]
    v_pk_fma_f32 v[20:21], v[64:65], v[64:65], s[34:35]
    v_pk_fma_f32 v[22:23], v[66:67], v[66:67], s[34:35]
    v_pk_mul_f32 v[16:17], v[16:17], v[60:61]
    v_pk_mul_f32 v[18:19], v[18:19], v[62:63]
    v_pk_mul_f32 v[20:21], v[20:21], v[64:65]
    v_pk_mul_f32 v[22:23], v[22:23], v[66:67]
    s_waitcnt lgkmcnt(1)
    ds_read_b128 v[32:35], v6 offset:18432
    v_mfma_f32_32x32x16_bf16 v[36:51], v[80:83], v[252:255], v[36:51]
    v_exp_f32 v16, v16
    v_exp_f32 v17, v17
    v_exp_f32 v18, v18
    v_mfma_f32_32x32x16_bf16 v[36:51], v[84:87], v[24:27], v[36:51]
    v_exp_f32 v19, v19
    v_exp_f32 v20, v20
    v_exp_f32 v21, v21
    v_exp_f32 v22, v22
    v_exp_f32_e64 v23, v23
    v_pk_add_f32 v[16:17], v[16:17], 1.0 op_sel_hi:[1,0]
    v_pk_add_f32 v[20:21], v[20:21], 1.0 op_sel_hi:[1,0]
    v_pk_fma_f32 v[60:61], v[60:61], v[18:19], v[60:61]
    v_pk_fma_f32 v[64:65], v[64:65], v[22:23], v[64:65]
    v_pk_fma_f32 v[18:19], v[16:17], v[18:19], v[16:17]
    v_pk_fma_f32 v[22:23], v[20:21], v[22:23], v[20:21]
    v_pk_mul_f32 v[62:63], v[62:63], v[16:17]
    v_pk_mul_f32 v[66:67], v[66:67], v[20:21]
    ds_read_b128 v[252:255], v6 offset:19456
    ds_read_b128 v[24:27], v6 offset:20480
    v_mfma_f32_32x32x16_bf16 v[36:51], v[88:91], v[28:31], v[36:51]
    v_rcp_f32 v18, v18
    v_rcp_f32 v19, v19
    v_rcp_f32 v22, v22
    v_rcp_f32 v23, v23
    v_cvt_pk_bf16_f32 v148, v52, v53
    v_cvt_pk_bf16_f32 v149, v54, v55
    v_cvt_pk_bf16_f32 v150, v56, v57
    v_cvt_pk_bf16_f32 v151, v58, v59
    v_pk_mul_f32 v[60:61], v[60:61], v[18:19]
    v_pk_mul_f32 v[62:63], v[62:63], v[18:19]
    v_pk_mul_f32 v[64:65], v[64:65], v[22:23]
    v_pk_mul_f32 v[66:67], v[66:67], v[22:23]
    v_cvt_pk_bf16_f32 v152, v60, v61
    v_cvt_pk_bf16_f32 v153, v62, v63
    v_cvt_pk_bf16_f32 v154, v64, v65
    v_cvt_pk_bf16_f32 v155, v66, v67
    v_dot2_f32_bf16 v11, v148, v148, 0
    v_dot2_f32_bf16 v11, v149, v149, v11
    v_dot2_f32_bf16 v11, v150, v150, v11
    v_dot2_f32_bf16 v11, v151, v151, v11
    v_dot2_f32_bf16 v11, v152, v152, v11
    v_dot2_f32_bf16 v11, v153, v153, v11
    v_dot2_f32_bf16 v11, v154, v154, v11
    v_dot2_f32_bf16 v11, v155, v155, v11
    ds_read_b128 v[28:31], v6 offset:21504
    s_cmp_lg_u32 s69, 0
    s_cbranch_scc1 L_skip22
    s_add_u32 s9, s63, 9216
    buffer_store_dwordx4 v[128:131], v6, s[40:43], s9 offen sc1 nt
    s_add_u32 s9, s63, 10240
    buffer_store_dwordx4 v[132:135], v6, s[40:43], s9 offen sc1 nt
    s_add_u32 s9, s63, 11264
    buffer_store_dwordx4 v[136:139], v6, s[40:43], s9 offen sc1 nt
L_skip22:
    s_cmp_lg_u32 s69, 1
    s_cbranch_scc1 L_skip23
    v_mov_b32 v14, 163536
    s_mov_b32 s10, 0
L_aw24:
    ds_read_b32 v15, v14 offset:24
    s_add_u32 s10, s10, 1
    s_waitcnt lgkmcnt(0)
    v_readfirstlane_b32 s9, v15
    s_lshr_b32 s55, s10, 22
    s_lshl_b32 s55, s55, 3
    s_or_b32 s9, s9, s55
    s_cmp_lt_u32 s9, 4
    s_cbranch_scc1 L_aw24
    s_mov_b32 s10, 0
L_aw25:
    ds_read_b32 v15, v14 offset:32
    s_add_u32 s10, s10, 1
    s_waitcnt lgkmcnt(0)
    v_readfirstlane_b32 s9, v15
    s_lshr_b32 s55, s10, 22
    s_lshl_b32 s55, s55, 3
    s_or_b32 s9, s9, s55
    s_cmp_lt_u32 s9, 4
    s_cbranch_scc1 L_aw25
    ds_write_b128 v236, v[164:167] offset:24576
    ds_write_b128 v236, v[168:171] offset:30720
    ds_write_b128 v236, v[124:127] offset:25600
    ds_write_b128 v236, v[128:131] offset:31744
    ds_write_b128 v236, v[132:135] offset:26624
    ds_write_b128 v236, v[136:139] offset:32768
L_skip23:
    v_mov_b32 v14, 163536
    s_mov_b32 s10, 0
L_aw26:
    ds_read_b32 v15, v14 offset:48
    s_add_u32 s10, s10, 1
    s_waitcnt lgkmcnt(0)
    v_readfirstlane_b32 s9, v15
    s_lshr_b32 s55, s10, 22
    s_lshl_b32 s55, s55, 3
    s_or_b32 s9, s9, s55
    s_cmp_lt_u32 s9, 4
    s_cbranch_scc1 L_aw26
    s_cmp_lg_u32 s69, 0
    s_cbranch_scc1 L_skip27
    v_mov_b32 v14, 163536
    s_mov_b32 s10, 0
L_aw28:
    ds_read_b32 v15, v14 offset:44
    s_add_u32 s10, s10, 1
    s_waitcnt lgkmcnt(0)
    v_readfirstlane_b32 s9, v15
    s_lshr_b32 s55, s10, 22
    s_lshl_b32 s55, s55, 3
    s_or_b32 s9, s9, s55
    s_cmp_lt_u32 s9, 4
    s_cbranch_scc1 L_aw28
L_skip27:
    v_pk_fma_f32 v[16:17], v[36:37], v[36:37], s[34:35]
    v_pk_fma_f32 v[18:19], v[38:39], v[38:39], s[34:35]
    v_pk_fma_f32 v[20:21], v[40:41], v[40:41], s[34:35]
    v_pk_fma_f32 v[22:23], v[42:43], v[42:43], s[34:35]
    v_pk_mul_f32 v[16:17], v[16:17], v[36:37]
    v_pk_mul_f32 v[18:19], v[18:19], v[38:39]
    v_pk_mul_f32 v[20:21], v[20:21], v[40:41]
    v_pk_mul_f32 v[22:23], v[22:23], v[42:43]
    s_setprio 3
    v_cvt_f64_f32 v[12:13], v11
    ds_read_b128 v[236:239], v2 offset:0
    ds_read_b128 v[240:243], v3 offset:0
    ds_read_b128 v[244:247], v2 offset:400
    ds_read_b128 v[248:251], v4 offset:0
    ds_read_b128 v[116:119], v2 offset:800
    ds_read_b128 v[120:123], v5 offset:0
    v_mfma_f32_32x32x16_bf16 v[52:67], v[68:71], v[32:35], 0
    v_exp_f32 v16, v16
    v_exp_f32 v17, v17
    v_exp_f32_e64 v18, v18
    v_mfma_f32_32x32x16_bf16 v[52:67], v[72:75], v[252:255], v[52:67]
    v_exp_f32 v19, v19
    v_exp_f32 v20, v20
    v_exp_f32 v21, v21
    v_exp_f32 v22, v22
    v_exp_f32_e64 v23, v23
    v_pk_add_f32 v[16:17], v[16:17], 1.0 op_sel_hi:[1,0]
    v_pk_add_f32 v[18:19], v[18:19], 1.0 op_sel_hi:[1,0]
    v_pk_add_f32 v[20:21], v[20:21], 1.0 op_sel_hi:[1,0]
    v_pk_add_f32 v[22:23], v[22:23], 1.0 op_sel_hi:[1,0]
    ds_read_b128 v[32:35], v6 offset:22528
    ds_read_b128 v[252:255], v6 offset:23552
    ds_add_f64 v8, v[12:13] offset:1792
    ds_read_b128 v[156:159], v2 offset:1200
    ds_read_b128 v[160:163], v3 offset:16
    ds_read_b128 v[164:167], v2 offset:1600
    ds_read_b128 v[168:171], v4 offset:16
    ds_read_b128 v[124:127], v2 offset:2000
    ds_read_b128 v[128:131], v5 offset:16
    v_mfma_f32_32x32x16_bf16 v[52:67], v[76:79], v[24:27], v[52:67]
    v_rcp_f32 v16, v16
    v_rcp_f32 v17, v17
    v_rcp_f32_e64 v18, v18
    v_mfma_f32_32x32x16_bf16 v[52:67], v[80:83], v[28:31], v[52:67]
    v_rcp_f32 v19, v19
    v_rcp_f32 v20, v20
    v_rcp_f32 v21, v21
    v_rcp_f32 v22, v22
    v_rcp_f32_e64 v23, v23
    v_pk_mul_f32 v[16:17], v[16:17], v[36:37]
    v_pk_mul_f32 v[18:19], v[18:19], v[38:39]
    v_pk_mul_f32 v[20:21], v[20:21], v[40:41]
    v_pk_mul_f32 v[22:23], v[22:23], v[42:43]
    v_cvt_pk_bf16_f32 v108, v16, v17
    v_cvt_pk_bf16_f32 v109, v18, v19
    v_cvt_pk_bf16_f32 v110, v20, v21
    v_cvt_pk_bf16_f32 v111, v22, v23
    v_dot2_f32_bf16 v11, v108, v108, 0
    v_dot2_f32_bf16 v11, v109, v109, v11
    v_dot2_f32_bf16 v11, v110, v110, v11
    v_dot2_f32_bf16 v11, v111, v111, v11
    v_pk_fma_f32 v[16:17], v[44:45], v[44:45], s[34:35]
    v_pk_fma_f32 v[18:19], v[46:47], v[46:47], s[34:35]
    v_pk_fma_f32 v[20:21], v[48:49], v[48:49], s[34:35]
    v_pk_fma_f32 v[22:23], v[50:51], v[50:51], s[34:35]
    v_pk_mul_f32 v[16:17], v[16:17], v[44:45]
    v_pk_mul_f32 v[18:19], v[18:19], v[46:47]
    v_pk_mul_f32 v[20:21], v[20:21], v[48:49]
    v_pk_mul_f32 v[22:23], v[22:23], v[50:51]
    s_waitcnt lgkmcnt(7)
    s_waitcnt lgkmcnt(0)
    ds_read_b128 v[24:27], v7 offset:12288
    ds_read_b128 v[28:31], v7 offset:13312
    v_mfma_f32_32x32x16_bf16 v[52:67], v[84:87], v[32:35], v[52:67]
    v_exp_f32 v16, v16
    v_exp_f32 v17, v17
    v_exp_f32_e64 v18, v18
    v_mfma_f32_32x32x16_bf16 v[52:67], v[88:91], v[252:255], v[52:67]
    v_exp_f32 v19, v19
    v_exp_f32 v20, v20
    v_exp_f32 v21, v21
    v_exp_f32 v22, v22
    v_exp_f32_e64 v23, v23
    v_pk_add_f32 v[16:17], v[16:17], 1.0 op_sel_hi:[1,0]
    v_pk_add_f32 v[18:19], v[18:19], 1.0 op_sel_hi:[1,0]
    v_pk_add_f32 v[20:21], v[20:21], 1.0 op_sel_hi:[1,0]
    v_pk_add_f32 v[22:23], v[22:23], 1.0 op_sel_hi:[1,0]
    ds_read_b128 v[32:35], v7 offset:14336
    ds_read_b128 v[252:255], v7 offset:15360
    v_mfma_f32_16x16x32_bf16 v[188:191], v[236:239], v[240:243], 0
    v_rcp_f32_e64 v16, v16
    v_mfma_f32_16x16x32_bf16 v[188:191], v[244:247], v[248:251], v[188:191]
    v_rcp_f32_e64 v17, v17
    v_mfma_f32_16x16x32_bf16 v[188:191], v[116:119], v[120:123], v[188:191]
    v_rcp_f32_e64 v18, v18
    v_mfma_f32_16x16x32_bf16 v[192:195], v[156:159], v[160:163], 0
    v_rcp_f32_e64 v19, v19
    v_mfma_f32_16x16x32_bf16 v[192:195], v[164:167], v[168:171], v[192:195]
    v_rcp_f32_e64 v20, v20
    v_mfma_f32_16x16x32_bf16 v[192:195], v[124:127], v[128:131], v[192:195]
    v_rcp_f32 v21, v21
    v_rcp_f32 v22, v22
    v_rcp_f32_e64 v23, v23
    v_pk_mul_f32 v[16:17], v[16:17], v[44:45]
    v_pk_mul_f32 v[18:19], v[18:19], v[46:47]
    v_pk_mul_f32 v[20:21], v[20:21], v[48:49]
    v_pk_mul_f32 v[22:23], v[22:23], v[50:51]
    v_cvt_pk_bf16_f32 v112, v16, v17
    v_cvt_pk_bf16_f32 v113, v18, v19
    v_cvt_pk_bf16_f32 v114, v20, v21
    v_cvt_pk_bf16_f32 v115, v22, v23
    v_dot2_f32_bf16 v11, v112, v112, v11
    v_dot2_f32_bf16 v11, v113, v113, v11
    v_dot2_f32_bf16 v11, v114, v114, v11
    v_dot2_f32_bf16 v11, v115, v115, v11
    s_cmp_lg_u32 s69, 1
    s_cbranch_scc1 L_skip29
    s_waitcnt lgkmcnt(0)
    v_mov_b32 v14, 163536
    v_mov_b32_e64 v15, 1
    s_mov_b64 exec, 1
    ds_add_u32 v14, v15 offset:40
    s_mov_b64 exec, -1
L_skip29:
    s_nop 0
    v_pk_fma_f32 v[16:17], v[52:53], v[52:53], s[34:35]
    v_pk_fma_f32 v[18:19], v[54:55], v[54:55], s[34:35]
    v_pk_fma_f32 v[20:21], v[56:57], v[56:57], s[34:35]
    v_pk_fma_f32 v[22:23], v[58:59], v[58:59], s[34:35]
    v_pk_mul_f32 v[16:17], v[16:17], v[52:53]
    v_pk_mul_f32 v[18:19], v[18:19], v[54:55]
    v_pk_mul_f32 v[20:21], v[20:21], v[56:57]
    v_pk_mul_f32 v[22:23], v[22:23], v[58:59]
    v_cvt_f64_f32 v[12:13], v11
    s_waitcnt lgkmcnt(0)
    ds_read_b128 v[236:239], v2 offset:2400
    ds_read_b128 v[240:243], v3 offset:32
    ds_read_b128 v[244:247], v2 offset:2800
    ds_read_b128 v[248:251], v4 offset:32
    ds_read_b128 v[156:159], v2 offset:3200
    ds_read_b128 v[160:163], v5 offset:32
    v_mfma_f32_32x32x16_bf16 v[36:51], v[68:71], v[24:27], 0
    v_exp_f32 v16, v16
    v_exp_f32 v17, v17
    v_exp_f32_e64 v18, v18
    v_mfma_f32_32x32x16_bf16 v[36:51], v[72:75], v[28:31], v[36:51]
    v_exp_f32 v19, v19
    v_exp_f32 v20, v20
    v_exp_f32 v21, v21
    v_exp_f32 v22, v22
    v_exp_f32_e64 v23, v23
    v_pk_add_f32 v[16:17], v[16:17], 1.0 op_sel_hi:[1,0]
    v_pk_add_f32 v[18:19], v[18:19], 1.0 op_sel_hi:[1,0]
    v_pk_add_f32 v[20:21], v[20:21], 1.0 op_sel_hi:[1,0]
    v_pk_add_f32 v[22:23], v[22:23], 1.0 op_sel_hi:[1,0]
    ds_read_b128 v[24:27], v7 offset:16384
    ds_read_b128 v[28:31], v7 offset:17408
    ds_add_f64 v8, v[12:13] offset:512
    ds_read_b128 v[164:167], v2 offset:3600
    ds_read_b128 v[168:171], v3 offset:48
    ds_read_b128 v[124:127], v2 offset:4000
    ds_read_b128 v[128:131], v4 offset:48
    ds_read_b128 v[132:135], v2 offset:4400
    ds_read_b128 v[136:139], v5 offset:48
    v_mfma_f32_32x32x16_bf16 v[36:51], v[76:79], v[32:35], v[36:51]
    v_rcp_f32 v16, v16
    v_rcp_f32 v17, v17
    v_rcp_f32_e64 v18, v18
    v_mfma_f32_32x32x16_bf16 v[36:51], v[80:83], v[252:255], v[36:51]
    v_rcp_f32 v19, v19
    v_rcp_f32 v20, v20
    v_rcp_f32 v21, v21
    v_rcp_f32 v22, v22
    v_rcp_f32_e64 v23, v23
    v_pk_mul_f32 v[16:17], v[16:17], v[52:53]
    v_pk_mul_f32 v[18:19], v[18:19], v[54:55]
    v_pk_mul_f32 v[20:21], v[20:21], v[56:57]
    v_pk_mul_f32 v[22:23], v[22:23], v[58:59]
    v_cvt_pk_bf16_f32 v116, v16, v17
    v_cvt_pk_bf16_f32 v117, v18, v19
    v_cvt_pk_bf16_f32 v118, v20, v21
    v_cvt_pk_bf16_f32 v119, v22, v23
    v_dot2_f32_bf16 v11, v116, v116, 0
    v_dot2_f32_bf16 v11, v117, v117, v11
    v_dot2_f32_bf16 v11, v118, v118, v11
    v_dot2_f32_bf16 v11, v119, v119, v11
    v_pk_fma_f32 v[16:17], v[60:61], v[60:61], s[34:35]
    v_pk_fma_f32 v[18:19], v[62:63], v[62:63], s[34:35]
    v_pk_fma_f32 v[20:21], v[64:65], v[64:65], s[34:35]
    v_pk_fma_f32 v[22:23], v[66:67], v[66:67], s[34:35]
    v_pk_mul_f32 v[16:17], v[16:17], v[60:61]
    v_pk_mul_f32 v[18:19], v[18:19], v[62:63]
    v_pk_mul_f32 v[20:21], v[20:21], v[64:65]
    v_pk_mul_f32 v[22:23], v[22:23], v[66:67]
    s_waitcnt lgkmcnt(7)
    s_waitcnt lgkmcnt(0)
    ds_read_b128 v[32:35], v7 offset:18432
    ds_read_b128 v[252:255], v7 offset:19456
    v_mfma_f32_32x32x16_bf16 v[36:51], v[84:87], v[24:27], v[36:51]
    v_exp_f32 v16, v16
    v_exp_f32 v17, v17
    v_exp_f32_e64 v18, v18
    v_mfma_f32_32x32x16_bf16 v[36:51], v[88:91], v[28:31], v[36:51]
    v_exp_f32 v19, v19
    v_exp_f32 v20, v20
    v_exp_f32 v21, v21
    v_exp_f32 v22, v22
    v_exp_f32_e64 v23, v23
    v_pk_add_f32 v[16:17], v[16:17], 1.0 op_sel_hi:[1,0]
    v_pk_add_f32 v[18:19], v[18:19], 1.0 op_sel_hi:[1,0]
    v_pk_add_f32 v[20:21], v[20:21], 1.0 op_sel_hi:[1,0]
    v_pk_add_f32 v[22:23], v[22:23], 1.0 op_sel_hi:[1,0]
    ds_read_b128 v[24:27], v7 offset:20480
    ds_read_b128 v[28:31], v7 offset:21504
    v_mfma_f32_16x16x32_bf16 v[196:199], v[236:239], v[240:243], 0
    v_rcp_f32_e64 v16, v16
    v_mfma_f32_16x16x32_bf16 v[196:199], v[244:247], v[248:251], v[196:199]
    v_rcp_f32_e64 v17, v17
    v_mfma_f32_16x16x32_bf16 v[196:199], v[156:159], v[160:163], v[196:199]
    v_rcp_f32_e64 v18, v18
    v_mfma_f32_16x16x32_bf16 v[200:203], v[164:167], v[168:171], 0
    v_rcp_f32_e64 v19, v19
    v_mfma_f32_16x16x32_bf16 v[200:203], v[124:127], v[128:131], v[200:203]
    v_rcp_f32_e64 v20, v20
    v_mfma_f32_16x16x32_bf16 v[200:203], v[132:135], v[136:139], v[200:203]
    v_rcp_f32 v21, v21
    v_rcp_f32 v22, v22
    v_rcp_f32_e64 v23, v23
    v_pk_mul_f32 v[16:17], v[16:17], v[60:61]
    v_pk_mul_f32 v[18:19], v[18:19], v[62:63]
    v_pk_mul_f32 v[20:21], v[20:21], v[64:65]
    v_pk_mul_f32 v[22:23], v[22:23], v[66:67]
    v_cvt_pk_bf16_f32 v120, v16, v17
    v_cvt_pk_bf16_f32 v121, v18, v19
    v_cvt_pk_bf16_f32 v122, v20, v21
    v_cvt_pk_bf16_f32 v123, v22, v23
    v_dot2_f32_bf16 v11, v120, v120, v11
    v_dot2_f32_bf16 v11, v121, v121, v11
    v_dot2_f32_bf16 v11, v122, v122, v11
    v_dot2_f32_bf16 v11, v123, v123, v11
    v_mov_b32 v14, 163536
    s_mov_b32 s10, 0
L_aw30:
    ds_read_b32 v15, v14 offset:40
    s_add_u32 s10, s10, 1
    s_waitcnt lgkmcnt(0)
    v_readfirstlane_b32 s9, v15
    s_lshr_b32 s55, s10, 22
    s_lshl_b32 s55, s55, 3
    s_or_b32 s9, s9, s55
    s_cmp_lt_u32 s9, 4
    s_cbranch_scc1 L_aw30
    s_nop 0
    v_pk_fma_f32 v[16:17], v[36:37], v[36:37], s[34:35]
    v_pk_fma_f32 v[18:19], v[38:39], v[38:39], s[34:35]
    v_pk_fma_f32 v[20:21], v[40:41], v[40:41], s[34:35]
    v_pk_fma_f32 v[22:23], v[42:43], v[42:43], s[34:35]
    v_pk_mul_f32 v[16:17], v[16:17], v[36:37]
    v_pk_mul_f32 v[18:19], v[18:19], v[38:39]
    v_pk_mul_f32 v[20:21], v[20:21], v[40:41]
    v_pk_mul_f32 v[22:23], v[22:23], v[42:43]
    v_cvt_f64_f32_e64 v[12:13], v11
    ds_read_b128 v[236:239], v2 offset:4800
    ds_read_b128 v[240:243], v3 offset:64
    ds_read_b128 v[244:247], v2 offset:5200
    ds_read_b128 v[248:251], v4 offset:64
    ds_read_b128 v[164:167], v2 offset:5600
    ds_read_b128 v[168:171], v5 offset:64
    v_mfma_f32_32x32x16_bf16 v[52:67], v[68:71], v[32:35], 0
    v_exp_f32 v16, v16
    v_exp_f32 v17, v17
    v_exp_f32_e64 v18, v18
    v_mfma_f32_32x32x16_bf16 v[52:67], v[72:75], v[252:255], v[52:67]
    v_exp_f32 v19, v19
    v_exp_f32 v20, v20
    v_exp_f32 v21, v21
    v_exp_f32 v22, v22
    v_exp_f32_e64 v23, v23
    v_pk_add_f32 v[16:17], v[16:17], 1.0 op_sel_hi:[1,0]
    v_pk_add_f32 v[18:19], v[18:19], 1.0 op_sel_hi:[1,0]
    v_pk_add_f32 v[20:21], v[20:21], 1.0 op_sel_hi:[1,0]
    v_pk_add_f32 v[22:23], v[22:23], 1.0 op_sel_hi:[1,0]
    ds_read_b128 v[32:35], v7 offset:22528
    ds_read_b128 v[252:255], v7 offset:23552
    ds_add_f64 v8, v[12:13] offset:768
    ds_read_b128 v[124:127], v2 offset:6000
    ds_read_b128 v[128:131], v3 offset:80
    ds_read_b128 v[132:135], v2 offset:6400
    ds_read_b128 v[136:139], v4 offset:80
    ds_read_b128 v[172:175], v2 offset:6800
    ds_read_b128 v[176:179], v5 offset:80
    v_mfma_f32_32x32x16_bf16 v[52:67], v[76:79], v[24:27], v[52:67]
    v_rcp_f32 v16, v16
    v_rcp_f32 v17, v17
    v_rcp_f32_e64 v18, v18
    v_mfma_f32_32x32x16_bf16 v[52:67], v[80:83], v[28:31], v[52:67]
    v_rcp_f32 v19, v19
    v_rcp_f32 v20, v20
    v_rcp_f32 v21, v21
    v_rcp_f32 v22, v22
    v_rcp_f32_e64 v23, v23
    v_pk_mul_f32 v[16:17], v[16:17], v[36:37]
    v_pk_mul_f32 v[18:19], v[18:19], v[38:39]
    v_pk_mul_f32 v[20:21], v[20:21], v[40:41]
    v_pk_mul_f32 v[22:23], v[22:23], v[42:43]
    v_cvt_pk_bf16_f32 v156, v16, v17
    v_cvt_pk_bf16_f32 v157, v18, v19
    v_cvt_pk_bf16_f32 v158, v20, v21
    v_cvt_pk_bf16_f32 v159, v22, v23
    v_dot2_f32_bf16 v11, v156, v156, 0
    v_dot2_f32_bf16 v11, v157, v157, v11
    v_dot2_f32_bf16 v11, v158, v158, v11
    v_dot2_f32_bf16 v11, v159, v159, v11
    v_pk_fma_f32 v[16:17], v[44:45], v[44:45], s[34:35]
    v_pk_fma_f32 v[18:19], v[46:47], v[46:47], s[34:35]
    v_pk_fma_f32 v[20:21], v[48:49], v[48:49], s[34:35]
    v_pk_fma_f32 v[22:23], v[50:51], v[50:51], s[34:35]
    v_pk_mul_f32 v[16:17], v[16:17], v[44:45]
    v_pk_mul_f32 v[18:19], v[18:19], v[46:47]
    v_pk_mul_f32 v[20:21], v[20:21], v[48:49]
    v_pk_mul_f32 v[22:23], v[22:23], v[50:51]
    s_waitcnt lgkmcnt(7)
    s_waitcnt lgkmcnt(0)
    ds_read_b128 v[24:27], v6 offset:24576
    ds_read_b128 v[28:31], v6 offset:25600
    v_mfma_f32_32x32x16_bf16 v[52:67], v[84:87], v[32:35], v[52:67]
    v_exp_f32 v16, v16
    v_exp_f32 v17, v17
    v_exp_f32_e64 v18, v18
    v_mfma_f32_32x32x16_bf16 v[52:67], v[88:91], v[252:255], v[52:67]
    v_exp_f32 v19, v19
    v_exp_f32 v20, v20
    v_exp_f32 v21, v21
    v_exp_f32 v22, v22
    v_exp_f32_e64 v23, v23
    v_pk_add_f32 v[16:17], v[16:17], 1.0 op_sel_hi:[1,0]
    v_pk_add_f32 v[18:19], v[18:19], 1.0 op_sel_hi:[1,0]
    v_pk_add_f32 v[20:21], v[20:21], 1.0 op_sel_hi:[1,0]
    v_pk_add_f32 v[22:23], v[22:23], 1.0 op_sel_hi:[1,0]
    ds_read_b128 v[32:35], v6 offset:26624
    ds_read_b128 v[252:255], v6 offset:27648
    v_mfma_f32_16x16x32_bf16 v[204:207], v[236:239], v[240:243], 0
    v_rcp_f32_e64 v16, v16
    v_mfma_f32_16x16x32_bf16 v[204:207], v[244:247], v[248:251], v[204:207]
    v_rcp_f32_e64 v17, v17
    v_mfma_f32_16x16x32_bf16 v[204:207], v[164:167], v[168:171], v[204:207]
    v_rcp_f32_e64 v18, v18
    v_mfma_f32_16x16x32_bf16 v[208:211], v[124:127], v[128:131], 0
    v_rcp_f32_e64 v19, v19
    v_mfma_f32_16x16x32_bf16 v[208:211], v[132:135], v[136:139], v[208:211]
    v_rcp_f32_e64 v20, v20
    v_mfma_f32_16x16x32_bf16 v[208:211], v[172:175], v[176:179], v[208:211]
    v_rcp_f32 v21, v21
    v_rcp_f32 v22, v22
    v_rcp_f32_e64 v23, v23
    v_pk_mul_f32 v[16:17], v[16:17], v[44:45]
    v_pk_mul_f32 v[18:19], v[18:19], v[46:47]
    v_pk_mul_f32 v[20:21], v[20:21], v[48:49]
    v_pk_mul_f32 v[22:23], v[22:23], v[50:51]
    v_cvt_pk_bf16_f32 v160, v16, v17
    v_cvt_pk_bf16_f32 v161, v18, v19
    v_cvt_pk_bf16_f32 v162, v20, v21
    v_cvt_pk_bf16_f32 v163, v22, v23
    v_dot2_f32_bf16 v11, v160, v160, v11
    v_dot2_f32_bf16 v11, v161, v161, v11
    v_dot2_f32_bf16 v11, v162, v162, v11
    v_dot2_f32_bf16 v11, v163, v163, v11
    v_pk_fma_f32 v[16:17], v[52:53], v[52:53], s[34:35]
    v_pk_fma_f32 v[18:19], v[54:55], v[54:55], s[34:35]
    v_pk_fma_f32 v[20:21], v[56:57], v[56:57], s[34:35]
    v_pk_fma_f32 v[22:23], v[58:59], v[58:59], s[34:35]
    v_pk_mul_f32 v[16:17], v[16:17], v[52:53]
    v_pk_mul_f32 v[18:19], v[18:19], v[54:55]
    v_pk_mul_f32 v[20:21], v[20:21], v[56:57]
    v_pk_mul_f32 v[22:23], v[22:23], v[58:59]
    v_cvt_f64_f32 v[12:13], v11
    s_waitcnt lgkmcnt(0)
    ds_read_b128 v[236:239], v2 offset:7200
    ds_read_b128 v[240:243], v3 offset:96
    ds_read_b128 v[244:247], v2 offset:7600
    ds_read_b128 v[248:251], v4 offset:96
    ds_read_b128 v[124:127], v2 offset:8000
    ds_read_b128 v[128:131], v5 offset:96
    v_mfma_f32_32x32x16_bf16 v[36:51], v[68:71], v[24:27], 0
    v_exp_f32 v16, v16
    v_exp_f32 v17, v17
    v_exp_f32_e64 v18, v18
    v_mfma_f32_32x32x16_bf16 v[36:51], v[72:75], v[28:31], v[36:51]
    v_exp_f32 v19, v19
    v_exp_f32 v20, v20
    v_exp_f32 v21, v21
    v_exp_f32 v22, v22
    v_exp_f32_e64 v23, v23
    v_pk_add_f32 v[16:17], v[16:17], 1.0 op_sel_hi:[1,0]
    v_pk_add_f32 v[18:19], v[18:19], 1.0 op_sel_hi:[1,0]
    v_pk_add_f32 v[20:21], v[20:21], 1.0 op_sel_hi:[1,0]
    v_pk_add_f32 v[22:23], v[22:23], 1.0 op_sel_hi:[1,0]
    ds_read_b128 v[24:27], v6 offset:28672
    ds_read_b128 v[28:31], v6 offset:29696
    ds_add_f64 v8, v[12:13] offset:2048
    ds_read_b128 v[132:135], v2 offset:8400
    ds_read_b128 v[136:139], v3 offset:112
    ds_read_b128 v[172:175], v2 offset:8800
    ds_read_b128 v[176:179], v4 offset:112
    ds_read_b128 v[180:183], v2 offset:9200
    ds_read_b128 v[184:187], v5 offset:112
    v_mfma_f32_32x32x16_bf16 v[36:51], v[76:79], v[32:35], v[36:51]
    v_rcp_f32 v16, v16
    v_rcp_f32 v17, v17
    v_rcp_f32_e64 v18, v18
    v_mfma_f32_32x32x16_bf16 v[36:51], v[80:83], v[252:255], v[36:51]
    v_rcp_f32 v19, v19
    v_rcp_f32 v20, v20
    v_rcp_f32 v21, v21
    v_rcp_f32 v22, v22
    v_rcp_f32_e64 v23, v23
    v_pk_mul_f32 v[16:17], v[16:17], v[52:53]
    v_pk_mul_f32 v[18:19], v[18:19], v[54:55]
    v_pk_mul_f32 v[20:21], v[20:21], v[56:57]
    v_pk_mul_f32 v[22:23], v[22:23], v[58:59]
    v_cvt_pk_bf16_f32 v164, v16, v17
    v_cvt_pk_bf16_f32 v165, v18, v19
    v_cvt_pk_bf16_f32 v166, v20, v21
    v_cvt_pk_bf16_f32 v167, v22, v23
    v_dot2_f32_bf16 v11, v164, v164, 0
    v_dot2_f32_bf16 v11, v165, v165, v11
    v_dot2_f32_bf16 v11, v166, v166, v11
    v_dot2_f32_bf16 v11, v167, v167, v11
    v_pk_fma_f32 v[16:17], v[60:61], v[60:61], s[34:35]
    v_pk_fma_f32 v[18:19], v[62:63], v[62:63], s[34:35]
    v_pk_fma_f32 v[20:21], v[64:65], v[64:65], s[34:35]
    v_pk_fma_f32 v[22:23], v[66:67], v[66:67], s[34:35]
    v_pk_mul_f32 v[16:17], v[16:17], v[60:61]
    v_pk_mul_f32 v[18:19], v[18:19], v[62:63]
    v_pk_mul_f32 v[20:21], v[20:21], v[64:65]
    v_pk_mul_f32 v[22:23], v[22:23], v[66:67]
    s_waitcnt lgkmcnt(7)
    s_waitcnt lgkmcnt(0)
    ds_read_b128 v[32:35], v6 offset:30720
    ds_read_b128 v[252:255], v6 offset:31744
    v_mfma_f32_32x32x16_bf16 v[36:51], v[84:87], v[24:27], v[36:51]
    v_exp_f32 v16, v16
    v_exp_f32 v17, v17
    v_exp_f32_e64 v18, v18
    v_mfma_f32_32x32x16_bf16 v[36:51], v[88:91], v[28:31], v[36:51]
    v_exp_f32 v19, v19
    v_exp_f32 v20, v20
    v_exp_f32 v21, v21
    v_exp_f32 v22, v22
    v_exp_f32_e64 v23, v23
    v_pk_add_f32 v[16:17], v[16:17], 1.0 op_sel_hi:[1,0]
    v_pk_add_f32 v[18:19], v[18:19], 1.0 op_sel_hi:[1,0]
    v_pk_add_f32 v[20:21], v[20:21], 1.0 op_sel_hi:[1,0]
    v_pk_add_f32 v[22:23], v[22:23], 1.0 op_sel_hi:[1,0]
    ds_read_b128 v[24:27], v6 offset:32768
    ds_read_b128 v[28:31], v6 offset:33792
    v_mfma_f32_16x16x32_bf16 v[212:215], v[236:239], v[240:243], 0
    v_rcp_f32_e64 v16, v16
    v_mfma_f32_16x16x32_bf16 v[212:215], v[244:247], v[248:251], v[212:215]
    v_rcp_f32_e64 v17, v17
    v_mfma_f32_16x16x32_bf16 v[212:215], v[124:127], v[128:131], v[212:215]
    v_rcp_f32_e64 v18, v18
    v_mfma_f32_16x16x32_bf16 v[216:219], v[132:135], v[136:139], 0
    v_rcp_f32_e64 v19, v19
    v_mfma_f32_16x16x32_bf16 v[216:219], v[172:175], v[176:179], v[216:219]
    v_rcp_f32_e64 v20, v20
    v_mfma_f32_16x16x32_bf16 v[216:219], v[180:183], v[184:187], v[216:219]
    v_rcp_f32 v21, v21
    v_rcp_f32 v22, v22
    v_rcp_f32_e64 v23, v23
    v_pk_mul_f32 v[16:17], v[16:17], v[60:61]
    v_pk_mul_f32 v[18:19], v[18:19], v[62:63]
    v_pk_mul_f32 v[20:21], v[20:21], v[64:65]
    v_pk_mul_f32 v[22:23], v[22:23], v[66:67]
    v_cvt_pk_bf16_f32 v168, v16, v17
    v_cvt_pk_bf16_f32 v169, v18, v19
    v_cvt_pk_bf16_f32 v170, v20, v21
    v_cvt_pk_bf16_f32 v171, v22, v23
    v_dot2_f32_bf16 v11, v168, v168, v11
    v_dot2_f32_bf16 v11, v169, v169, v11
    v_dot2_f32_bf16 v11, v170, v170, v11
    v_dot2_f32_bf16 v11, v171, v171, v11
    v_pk_fma_f32 v[16:17], v[36:37], v[36:37], s[34:35]
    v_pk_fma_f32 v[18:19], v[38:39], v[38:39], s[34:35]
    v_pk_fma_f32 v[20:21], v[40:41], v[40:41], s[34:35]
    v_pk_fma_f32 v[22:23], v[42:43], v[42:43], s[34:35]
    v_pk_mul_f32 v[16:17], v[16:17], v[36:37]
    v_pk_mul_f32 v[18:19], v[18:19], v[38:39]
    v_pk_mul_f32 v[20:21], v[20:21], v[40:41]
    v_pk_mul_f32 v[22:23], v[22:23], v[42:43]
    v_cvt_f64_f32 v[12:13], v11
    s_waitcnt lgkmcnt(0)
    ds_read_b128 v[236:239], v2 offset:9600
    ds_read_b128 v[240:243], v3 offset:128
    ds_read_b128 v[244:247], v2 offset:10000
    ds_read_b128 v[248:251], v4 offset:128
    ds_read_b128 v[132:135], v2 offset:10400
    ds_read_b128 v[136:139], v5 offset:128
    v_mfma_f32_32x32x16_bf16 v[52:67], v[68:71], v[32:35], 0
    v_exp_f32 v16, v16
    v_exp_f32 v17, v17
    v_exp_f32_e64 v18, v18
    v_mfma_f32_32x32x16_bf16 v[52:67], v[72:75], v[252:255], v[52:67]
    v_exp_f32 v19, v19
    v_exp_f32 v20, v20
    v_exp_f32 v21, v21
    v_exp_f32 v22, v22
    v_exp_f32_e64 v23, v23
    v_pk_add_f32 v[16:17], v[16:17], 1.0 op_sel_hi:[1,0]
    v_pk_add_f32 v[18:19], v[18:19], 1.0 op_sel_hi:[1,0]
    v_pk_add_f32 v[20:21], v[20:21], 1.0 op_sel_hi:[1,0]
    v_pk_add_f32 v[22:23], v[22:23], 1.0 op_sel_hi:[1,0]
    ds_read_b128 v[32:35], v6 offset:34816
    ds_read_b128 v[252:255], v6 offset:35840
    ds_add_f64 v8, v[12:13] offset:2304
    ds_read_b128 v[172:175], v2 offset:10800
    ds_read_b128 v[176:179], v3 offset:144
    ds_read_b128 v[180:183], v2 offset:11200
    ds_read_b128 v[184:187], v4 offset:144
    v_mfma_f32_32x32x16_bf16 v[52:67], v[76:79], v[24:27], v[52:67]
    v_rcp_f32 v16, v16
    v_rcp_f32 v17, v17
    v_rcp_f32_e64 v18, v18
    v_mfma_f32_32x32x16_bf16 v[52:67], v[80:83], v[28:31], v[52:67]
    v_rcp_f32 v19, v19
    v_rcp_f32 v20, v20
    v_rcp_f32 v21, v21
    v_rcp_f32 v22, v22
    v_rcp_f32_e64 v23, v23
    v_pk_mul_f32 v[16:17], v[16:17], v[36:37]
    v_pk_mul_f32 v[18:19], v[18:19], v[38:39]
    v_pk_mul_f32 v[20:21], v[20:21], v[40:41]
    v_pk_mul_f32 v[22:23], v[22:23], v[42:43]
    v_cvt_pk_bf16_f32 v124, v16, v17
    v_cvt_pk_bf16_f32 v125, v18, v19
    v_cvt_pk_bf16_f32 v126, v20, v21
    v_cvt_pk_bf16_f32 v127, v22, v23
    v_dot2_f32_bf16 v11, v124, v124, 0
    v_dot2_f32_bf16 v11, v125, v125, v11
    v_dot2_f32_bf16 v11, v126, v126, v11
    v_dot2_f32_bf16 v11, v127, v127, v11
    v_pk_fma_f32 v[16:17], v[44:45], v[44:45], s[34:35]
    v_pk_fma_f32 v[18:19], v[46:47], v[46:47], s[34:35]
    v_pk_fma_f32 v[20:21], v[48:49], v[48:49], s[34:35]
    v_pk_fma_f32 v[22:23], v[50:51], v[50:51], s[34:35]
    v_pk_mul_f32 v[16:17], v[16:17], v[44:45]
    v_pk_mul_f32 v[18:19], v[18:19], v[46:47]
    v_pk_mul_f32 v[20:21], v[20:21], v[48:49]
    v_pk_mul_f32 v[22:23], v[22:23], v[50:51]
    s_waitcnt lgkmcnt(5)
    s_waitcnt lgkmcnt(0)
    ds_read_b128 v[24:27], v7 offset:24576
    ds_read_b128 v[28:31], v7 offset:25600
    v_mfma_f32_32x32x16_bf16 v[52:67], v[84:87], v[32:35], v[52:67]
    v_exp_f32 v16, v16
    v_exp_f32 v17, v17
    v_exp_f32_e64 v18, v18
    v_mfma_f32_32x32x16_bf16 v[52:67], v[88:91], v[252:255], v[52:67]
    v_exp_f32 v19, v19
    v_exp_f32 v20, v20
    v_exp_f32 v21, v21
    v_exp_f32 v22, v22
    v_exp_f32_e64 v23, v23
    v_pk_add_f32 v[16:17], v[16:17], 1.0 op_sel_hi:[1,0]
    v_pk_add_f32 v[18:19], v[18:19], 1.0 op_sel_hi:[1,0]
    v_pk_add_f32 v[20:21], v[20:21], 1.0 op_sel_hi:[1,0]
    v_pk_add_f32 v[22:23], v[22:23], 1.0 op_sel_hi:[1,0]
    ds_read_b128 v[32:35], v7 offset:26624
    ds_read_b128 v[252:255], v7 offset:27648
    v_mfma_f32_16x16x32_bf16 v[220:223], v[236:239], v[240:243], 0
    v_rcp_f32_e64 v16, v16
    v_mfma_f32_16x16x32_bf16 v[220:223], v[244:247], v[248:251], v[220:223]
    v_rcp_f32_e64 v17, v17
    v_mfma_f32_16x16x32_bf16 v[220:223], v[132:135], v[136:139], v[220:223]
    v_rcp_f32_e64 v18, v18
    v_mfma_f32_16x16x32_bf16 v[224:227], v[172:175], v[176:179], 0
    v_rcp_f32_e64 v19, v19
    v_mfma_f32_16x16x32_bf16 v[224:227], v[180:183], v[184:187], v[224:227]
    v_rcp_f32 v20, v20
    v_rcp_f32 v21, v21
    v_rcp_f32 v22, v22
    v_rcp_f32 v23, v23
    v_pk_mul_f32 v[16:17], v[16:17], v[44:45]
    v_pk_mul_f32 v[18:19], v[18:19], v[46:47]
    v_pk_mul_f32 v[20:21], v[20:21], v[48:49]
    v_pk_mul_f32 v[22:23], v[22:23], v[50:51]
    v_cvt_pk_bf16_f32 v128, v16, v17
    v_cvt_pk_bf16_f32 v129, v18, v19
    v_cvt_pk_bf16_f32 v130, v20, v21
    v_cvt_pk_bf16_f32 v131, v22, v23
    v_dot2_f32_bf16 v11, v128, v128, v11
    v_dot2_f32_bf16 v11, v129, v129, v11
    v_dot2_f32_bf16 v11, v130, v130, v11
    v_dot2_f32_bf16 v11, v131, v131, v11
    v_pk_fma_f32 v[16:17], v[52:53], v[52:53], s[34:35]
    v_pk_fma_f32 v[18:19], v[54:55], v[54:55], s[34:35]
    v_pk_fma_f32 v[20:21], v[56:57], v[56:57], s[34:35]
    v_pk_fma_f32 v[22:23], v[58:59], v[58:59], s[34:35]
    v_pk_mul_f32 v[16:17], v[16:17], v[52:53]
    v_pk_mul_f32 v[18:19], v[18:19], v[54:55]
    v_pk_mul_f32 v[20:21], v[20:21], v[56:57]
    v_pk_mul_f32 v[22:23], v[22:23], v[58:59]
    v_cvt_f64_f32 v[12:13], v11
    s_waitcnt lgkmcnt(0)
    ds_read_b128 v[236:239], v2 offset:11600
    ds_read_b128 v[240:243], v5 offset:144
    ds_read_b128 v[244:247], v2 offset:12000
    ds_read_b128 v[248:251], v3 offset:160
    v_mfma_f32_32x32x16_bf16 v[36:51], v[68:71], v[24:27], 0
    v_exp_f32 v16, v16
    v_exp_f32 v17, v17
    v_exp_f32_e64 v18, v18
    v_mfma_f32_32x32x16_bf16 v[36:51], v[72:75], v[28:31], v[36:51]
    v_exp_f32 v19, v19
    v_exp_f32 v20, v20
    v_exp_f32 v21, v21
    v_exp_f32 v22, v22
    v_exp_f32_e64 v23, v23
    v_pk_add_f32 v[16:17], v[16:17], 1.0 op_sel_hi:[1,0]
    v_pk_add_f32 v[18:19], v[18:19], 1.0 op_sel_hi:[1,0]
    v_pk_add_f32 v[20:21], v[20:21], 1.0 op_sel_hi:[1,0]
    v_pk_add_f32 v[22:23], v[22:23], 1.0 op_sel_hi:[1,0]
    ds_read_b128 v[24:27], v7 offset:28672
    ds_read_b128 v[28:31], v7 offset:29696
    ds_add_f64 v8, v[12:13] offset:1024
    ds_read_b128 v[172:175], v2 offset:12400
    ds_read_b128 v[176:179], v4 offset:160
    ds_read_b128 v[180:183], v2 offset:12800
    ds_read_b128 v[184:187], v5 offset:160
    v_mfma_f32_32x32x16_bf16 v[36:51], v[76:79], v[32:35], v[36:51]
    v_rcp_f32 v16, v16
    v_rcp_f32 v17, v17
    v_rcp_f32_e64 v18, v18
    v_mfma_f32_32x32x16_bf16 v[36:51], v[80:83], v[252:255], v[36:51]
    v_rcp_f32 v19, v19
    v_rcp_f32 v20, v20
    v_rcp_f32 v21, v21
    v_rcp_f32 v22, v22
    v_rcp_f32_e64 v23, v23
    v_pk_mul_f32 v[16:17], v[16:17], v[52:53]
    v_pk_mul_f32 v[18:19], v[18:19], v[54:55]
    v_pk_mul_f32 v[20:21], v[20:21], v[56:57]
    v_pk_mul_f32 v[22:23], v[22:23], v[58:59]
    v_cvt_pk_bf16_f32 v132, v16, v17
    v_cvt_pk_bf16_f32 v133, v18, v19
    v_cvt_pk_bf16_f32 v134, v20, v21
    v_cvt_pk_bf16_f32 v135, v22, v23
    v_dot2_f32_bf16 v11, v132, v132, 0
    v_dot2_f32_bf16 v11, v133, v133, v11
    v_dot2_f32_bf16 v11, v134, v134, v11
    v_dot2_f32_bf16 v11, v135, v135, v11
    v_pk_fma_f32 v[16:17], v[60:61], v[60:61], s[34:35]
    v_pk_fma_f32 v[18:19], v[62:63], v[62:63], s[34:35]
    v_pk_fma_f32 v[20:21], v[64:65], v[64:65], s[34:35]
    v_pk_fma_f32 v[22:23], v[66:67], v[66:67], s[34:35]
    v_pk_mul_f32 v[16:17], v[16:17], v[60:61]
    v_pk_mul_f32 v[18:19], v[18:19], v[62:63]
    v_pk_mul_f32 v[20:21], v[20:21], v[64:65]
    v_pk_mul_f32 v[22:23], v[22:23], v[66:67]
    s_waitcnt lgkmcnt(5)
    s_waitcnt lgkmcnt(0)
    ds_read_b128 v[32:35], v7 offset:30720
    ds_read_b128 v[252:255], v7 offset:31744
    v_mfma_f32_32x32x16_bf16 v[36:51], v[84:87], v[24:27], v[36:51]
    v_exp_f32 v16, v16
    v_exp_f32 v17, v17
    v_exp_f32_e64 v18, v18
    v_mfma_f32_32x32x16_bf16 v[36:51], v[88:91], v[28:31], v[36:51]
    v_exp_f32 v19, v19
    v_exp_f32 v20, v20
    v_exp_f32 v21, v21
    v_exp_f32 v22, v22
    v_exp_f32_e64 v23, v23
    v_pk_add_f32 v[16:17], v[16:17], 1.0 op_sel_hi:[1,0]
    v_pk_add_f32 v[18:19], v[18:19], 1.0 op_sel_hi:[1,0]
    v_pk_add_f32 v[20:21], v[20:21], 1.0 op_sel_hi:[1,0]
    v_pk_add_f32 v[22:23], v[22:23], 1.0 op_sel_hi:[1,0]
    ds_read_b128 v[24:27], v7 offset:32768
    ds_read_b128 v[28:31], v7 offset:33792
    v_mfma_f32_16x16x32_bf16 v[224:227], v[236:239], v[240:243], v[224:227]
    v_rcp_f32_e64 v16, v16
    v_mfma_f32_16x16x32_bf16 v[228:231], v[244:247], v[248:251], 0
    v_rcp_f32_e64 v17, v17
    v_mfma_f32_16x16x32_bf16 v[228:231], v[172:175], v[176:179], v[228:231]
    v_rcp_f32_e64 v18, v18
    v_mfma_f32_16x16x32_bf16 v[228:231], v[180:183], v[184:187], v[228:231]
    v_rcp_f32 v19, v19
    v_rcp_f32 v20, v20
    v_rcp_f32 v21, v21
    v_rcp_f32 v22, v22
    v_rcp_f32_e64 v23, v23
    v_pk_mul_f32 v[16:17], v[16:17], v[60:61]
    v_pk_mul_f32 v[18:19], v[18:19], v[62:63]
    v_pk_mul_f32 v[20:21], v[20:21], v[64:65]
    v_pk_mul_f32 v[22:23], v[22:23], v[66:67]
    v_cvt_pk_bf16_f32 v136, v16, v17
    v_cvt_pk_bf16_f32 v137, v18, v19
    v_cvt_pk_bf16_f32 v138, v20, v21
    v_cvt_pk_bf16_f32 v139, v22, v23
    v_dot2_f32_bf16 v11, v136, v136, v11
    v_dot2_f32_bf16 v11, v137, v137, v11
    v_dot2_f32_bf16 v11, v138, v138, v11
    v_dot2_f32_bf16 v11, v139, v139, v11
    v_pk_fma_f32 v[16:17], v[36:37], v[36:37], s[34:35]
    v_pk_fma_f32 v[18:19], v[38:39], v[38:39], s[34:35]
    v_pk_fma_f32 v[20:21], v[40:41], v[40:41], s[34:35]
    v_pk_fma_f32 v[22:23], v[42:43], v[42:43], s[34:35]
    v_pk_mul_f32 v[16:17], v[16:17], v[36:37]
    v_pk_mul_f32 v[18:19], v[18:19], v[38:39]
    v_pk_mul_f32 v[20:21], v[20:21], v[40:41]
    v_pk_mul_f32 v[22:23], v[22:23], v[42:43]
    v_cvt_f64_f32 v[12:13], v11
    s_waitcnt lgkmcnt(0)
    ds_read_b128 v[236:239], v2 offset:13200
    ds_read_b128 v[240:243], v3 offset:176
    ds_read_b128 v[244:247], v2 offset:13600
    ds_read_b128 v[248:251], v4 offset:176
    v_mfma_f32_32x32x16_bf16 v[52:67], v[68:71], v[32:35], 0
    v_exp_f32 v16, v16
    v_exp_f32 v17, v17
    v_exp_f32_e64 v18, v18
    v_mfma_f32_32x32x16_bf16 v[52:67], v[72:75], v[252:255], v[52:67]
    v_exp_f32 v19, v19
    v_exp_f32 v20, v20
    v_exp_f32 v21, v21
    v_exp_f32 v22, v22
    v_exp_f32_e64 v23, v23
    v_pk_add_f32 v[16:17], v[16:17], 1.0 op_sel_hi:[1,0]
    v_pk_add_f32 v[18:19], v[18:19], 1.0 op_sel_hi:[1,0]
    v_pk_add_f32 v[20:21], v[20:21], 1.0 op_sel_hi:[1,0]
    v_pk_add_f32 v[22:23], v[22:23], 1.0 op_sel_hi:[1,0]
    ds_read_b128 v[32:35], v7 offset:34816
    ds_read_b128 v[252:255], v7 offset:35840
    ds_add_f64 v8, v[12:13] offset:1280
    ds_read_b128 v[180:183], v2 offset:14000
    ds_read_b128 v[184:187], v5 offset:176
    v_mfma_f32_32x32x16_bf16 v[52:67], v[76:79], v[24:27], v[52:67]
    v_rcp_f32 v16, v16
    v_rcp_f32 v17, v17
    v_rcp_f32_e64 v18, v18
    v_mfma_f32_32x32x16_bf16 v[52:67], v[80:83], v[28:31], v[52:67]
    v_rcp_f32 v19, v19
    v_rcp_f32 v20, v20
    v_rcp_f32 v21, v21
    v_rcp_f32 v22, v22
    v_rcp_f32_e64 v23, v23
    v_pk_mul_f32 v[16:17], v[16:17], v[36:37]
    v_pk_mul_f32 v[18:19], v[18:19], v[38:39]
    v_pk_mul_f32 v[20:21], v[20:21], v[40:41]
    v_pk_mul_f32 v[22:23], v[22:23], v[42:43]
    v_cvt_pk_bf16_f32 v172, v16, v17
    v_cvt_pk_bf16_f32 v173, v18, v19
    v_cvt_pk_bf16_f32 v174, v20, v21
    v_cvt_pk_bf16_f32 v175, v22, v23
    v_dot2_f32_bf16 v11, v172, v172, 0
    v_dot2_f32_bf16 v11, v173, v173, v11
    v_dot2_f32_bf16 v11, v174, v174, v11
    v_dot2_f32_bf16 v11, v175, v175, v11
    v_pk_fma_f32 v[16:17], v[44:45], v[44:45], s[34:35]
    v_pk_fma_f32 v[18:19], v[46:47], v[46:47], s[34:35]
    v_pk_fma_f32 v[20:21], v[48:49], v[48:49], s[34:35]
    v_pk_fma_f32 v[22:23], v[50:51], v[50:51], s[34:35]
    v_pk_mul_f32 v[16:17], v[16:17], v[44:45]
    v_pk_mul_f32 v[18:19], v[18:19], v[46:47]
    v_pk_mul_f32 v[20:21], v[20:21], v[48:49]
    v_pk_mul_f32 v[22:23], v[22:23], v[50:51]
    s_waitcnt lgkmcnt(3)
    s_waitcnt lgkmcnt(0)
    ds_read_b128 v[24:27], v6 offset:0
    ds_read_b128 v[28:31], v6 offset:1024
    v_mfma_f32_32x32x16_bf16 v[52:67], v[84:87], v[32:35], v[52:67]
    v_exp_f32 v16, v16
    v_exp_f32 v17, v17
    v_exp_f32_e64 v18, v18
    v_mfma_f32_32x32x16_bf16 v[52:67], v[88:91], v[252:255], v[52:67]
    v_exp_f32 v19, v19
    v_exp_f32 v20, v20
    v_exp_f32 v21, v21
    v_exp_f32 v22, v22
    v_exp_f32_e64 v23, v23
    v_pk_add_f32 v[16:17], v[16:17], 1.0 op_sel_hi:[1,0]
    v_pk_add_f32 v[18:19], v[18:19], 1.0 op_sel_hi:[1,0]
    v_pk_add_f32 v[20:21], v[20:21], 1.0 op_sel_hi:[1,0]
    v_pk_add_f32 v[22:23], v[22:23], 1.0 op_sel_hi:[1,0]
    ds_read_b128 v[32:35], v6 offset:2048
    ds_read_b128 v[252:255], v6 offset:3072
    v_mfma_f32_16x16x32_bf16 v[232:235], v[236:239], v[240:243], 0
    v_rcp_f32_e64 v16, v16
    v_mfma_f32_16x16x32_bf16 v[232:235], v[244:247], v[248:251], v[232:235]
    v_rcp_f32_e64 v17, v17
    v_mfma_f32_16x16x32_bf16 v[232:235], v[180:183], v[184:187], v[232:235]
    v_rcp_f32 v18, v18
    v_rcp_f32 v19, v19
    v_rcp_f32 v20, v20
    v_rcp_f32 v21, v21
    v_rcp_f32 v22, v22
    v_rcp_f32 v23, v23
    v_pk_mul_f32 v[16:17], v[16:17], v[44:45]
    v_pk_mul_f32 v[18:19], v[18:19], v[46:47]
    v_pk_mul_f32 v[20:21], v[20:21], v[48:49]
    v_pk_mul_f32 v[22:23], v[22:23], v[50:51]
    v_cvt_pk_bf16_f32 v176, v16, v17
    v_cvt_pk_bf16_f32 v177, v18, v19
    v_cvt_pk_bf16_f32 v178, v20, v21
    v_cvt_pk_bf16_f32 v179, v22, v23
    v_dot2_f32_bf16 v11, v176, v176, v11
    v_dot2_f32_bf16 v11, v177, v177, v11
    v_dot2_f32_bf16 v11, v178, v178, v11
    v_dot2_f32_bf16 v11, v179, v179, v11
    v_mov_b32 v14, 163536
    v_mov_b32 v15, 1
    s_mov_b64 exec, 1
    ds_add_u32 v14, v15 offset:52
    s_mov_b64 exec, -1
    s_nop 0
    v_pk_add_f32 v[16:17], v[188:189], v[190:191]
    v_pk_mul_f32 v[20:21], v[188:189], v[188:189]
    v_pk_add_f32 v[18:19], v[192:193], v[194:195]
    v_pk_mul_f32 v[22:23], v[190:191], v[190:191]
    v_pk_fma_f32 v[20:21], v[192:193], v[192:193], v[20:21]
    v_pk_fma_f32 v[22:23], v[194:195], v[194:195], v[22:23]
    v_pk_add_f32 v[16:17], v[16:17], v[196:197]
    v_pk_fma_f32 v[20:21], v[196:197], v[196:197], v[20:21]
    v_pk_add_f32 v[18:19], v[18:19], v[198:199]
    v_pk_fma_f32 v[22:23], v[198:199], v[198:199], v[22:23]
    v_pk_add_f32 v[16:17], v[16:17], v[200:201]
    v_pk_fma_f32 v[20:21], v[200:201], v[200:201], v[20:21]
    v_pk_add_f32 v[18:19], v[18:19], v[202:203]
    v_pk_fma_f32 v[22:23], v[202:203], v[202:203], v[22:23]
    v_pk_add_f32 v[16:17], v[16:17], v[204:205]
    v_pk_fma_f32 v[20:21], v[204:205], v[204:205], v[20:21]
    v_pk_add_f32 v[18:19], v[18:19], v[206:207]
    v_pk_fma_f32 v[22:23], v[206:207], v[206:207], v[22:23]
    v_pk_add_f32 v[16:17], v[16:17], v[208:209]
    v_pk_fma_f32 v[20:21], v[208:209], v[208:209], v[20:21]
    v_pk_add_f32 v[18:19], v[18:19], v[210:211]
    v_pk_fma_f32 v[22:23], v[210:211], v[210:211], v[22:23]
    v_pk_add_f32 v[16:17], v[16:17], v[212:213]
    v_pk_fma_f32 v[20:21], v[212:213], v[212:213], v[20:21]
    v_pk_add_f32 v[18:19], v[18:19], v[214:215]
    v_pk_fma_f32 v[22:23], v[214:215], v[214:215], v[22:23]
    v_pk_add_f32 v[16:17], v[16:17], v[216:217]
    v_pk_fma_f32 v[20:21], v[216:217], v[216:217], v[20:21]
    v_pk_add_f32 v[18:19], v[18:19], v[218:219]
    v_pk_fma_f32 v[22:23], v[218:219], v[218:219], v[22:23]
    v_pk_add_f32 v[16:17], v[16:17], v[220:221]
    v_pk_fma_f32 v[20:21], v[220:221], v[220:221], v[20:21]
    v_pk_add_f32 v[18:19], v[18:19], v[222:223]
    v_pk_fma_f32 v[22:23], v[222:223], v[222:223], v[22:23]
    v_pk_add_f32 v[16:17], v[16:17], v[224:225]
    v_pk_fma_f32 v[20:21], v[224:225], v[224:225], v[20:21]
    v_pk_add_f32 v[18:19], v[18:19], v[226:227]
    v_pk_fma_f32 v[22:23], v[226:227], v[226:227], v[22:23]
    v_pk_add_f32 v[16:17], v[16:17], v[228:229]
    v_pk_fma_f32 v[20:21], v[228:229], v[228:229], v[20:21]
    v_pk_add_f32 v[18:19], v[18:19], v[230:231]
    v_pk_fma_f32 v[22:23], v[230:231], v[230:231], v[22:23]
    v_pk_add_f32 v[16:17], v[16:17], v[232:233]
    v_pk_fma_f32 v[20:21], v[232:233], v[232:233], v[20:21]
    v_pk_add_f32 v[18:19], v[18:19], v[234:235]
    v_pk_fma_f32 v[22:23], v[234:235], v[234:235], v[22:23]
    v_pk_add_f32 v[16:17], v[16:17], v[18:19]
    v_pk_add_f32 v[20:21], v[20:21], v[22:23]
    v_add_f32 v16, v16, v17
    v_add_f32 v20, v20, v21
    v_mov_b32 v17, v16
    v_mov_b32 v21, v20
    s_nop 0
    v_permlane32_swap_b32 v16, v17
    v_permlane32_swap_b32 v20, v21
    v_add_f32 v16, v16, v17
    v_add_f32_e64 v20, v20, v21
    v_mul_f32 v16, 0x3c2aaaab, v16
    v_mul_f32 v20, 0x3c2aaaab, v20
    v_fma_f32 v20, -v16, v16, v20
    v_max_f32_e64 v20, 0, v20
    v_add_f32 v20, 0x3727c5ac, v20
    v_rsq_f32 v20, v20
    s_nop 0
    v_mul_f32 v18, 0xbeeff558, v20
    v_mul_f32 v19, -v16, v18
    v_pk_fma_f32 v[188:189], v[188:189], v[18:19], v[18:19] op_sel:[0,0,1] op_sel_hi:[1,0,1]
    v_pk_fma_f32 v[190:191], v[190:191], v[18:19], v[18:19] op_sel:[0,0,1] op_sel_hi:[1,0,1]
    v_pk_fma_f32 v[192:193], v[192:193], v[18:19], v[18:19] op_sel:[0,0,1] op_sel_hi:[1,0,1]
    v_pk_fma_f32 v[194:195], v[194:195], v[18:19], v[18:19] op_sel:[0,0,1] op_sel_hi:[1,0,1]
    v_pk_fma_f32 v[196:197], v[196:197], v[18:19], v[18:19] op_sel:[0,0,1] op_sel_hi:[1,0,1]
    v_pk_fma_f32 v[198:199], v[198:199], v[18:19], v[18:19] op_sel:[0,0,1] op_sel_hi:[1,0,1]
    v_pk_fma_f32 v[200:201], v[200:201], v[18:19], v[18:19] op_sel:[0,0,1] op_sel_hi:[1,0,1]
    v_pk_fma_f32 v[202:203], v[202:203], v[18:19], v[18:19] op_sel:[0,0,1] op_sel_hi:[1,0,1]
    v_pk_fma_f32 v[204:205], v[204:205], v[18:19], v[18:19] op_sel:[0,0,1] op_sel_hi:[1,0,1]
    v_pk_fma_f32 v[206:207], v[206:207], v[18:19], v[18:19] op_sel:[0,0,1] op_sel_hi:[1,0,1]
    v_pk_fma_f32 v[208:209], v[208:209], v[18:19], v[18:19] op_sel:[0,0,1] op_sel_hi:[1,0,1]
    v_pk_fma_f32 v[210:211], v[210:211], v[18:19], v[18:19] op_sel:[0,0,1] op_sel_hi:[1,0,1]
    v_pk_fma_f32 v[212:213], v[212:213], v[18:19], v[18:19] op_sel:[0,0,1] op_sel_hi:[1,0,1]
    v_pk_fma_f32 v[214:215], v[214:215], v[18:19], v[18:19] op_sel:[0,0,1] op_sel_hi:[1,0,1]
    v_pk_fma_f32 v[216:217], v[216:217], v[18:19], v[18:19] op_sel:[0,0,1] op_sel_hi:[1,0,1]
    v_pk_fma_f32 v[218:219], v[218:219], v[18:19], v[18:19] op_sel:[0,0,1] op_sel_hi:[1,0,1]
    v_pk_fma_f32 v[220:221], v[220:221], v[18:19], v[18:19] op_sel:[0,0,1] op_sel_hi:[1,0,1]
    v_pk_fma_f32 v[222:223], v[222:223], v[18:19], v[18:19] op_sel:[0,0,1] op_sel_hi:[1,0,1]
    v_pk_fma_f32 v[224:225], v[224:225], v[18:19], v[18:19] op_sel:[0,0,1] op_sel_hi:[1,0,1]
    v_pk_fma_f32 v[226:227], v[226:227], v[18:19], v[18:19] op_sel:[0,0,1] op_sel_hi:[1,0,1]
    v_pk_fma_f32 v[228:229], v[228:229], v[18:19], v[18:19] op_sel:[0,0,1] op_sel_hi:[1,0,1]
    v_pk_fma_f32 v[230:231], v[230:231], v[18:19], v[18:19] op_sel:[0,0,1] op_sel_hi:[1,0,1]
    v_pk_fma_f32 v[232:233], v[232:233], v[18:19], v[18:19] op_sel:[0,0,1] op_sel_hi:[1,0,1]
    v_pk_fma_f32 v[234:235], v[234:235], v[18:19], v[18:19] op_sel:[0,0,1] op_sel_hi:[1,0,1]
    v_cvt_pk_bf16_f32 v68, v188, v189
    v_cvt_pk_bf16_f32 v69, v190, v191
    v_cvt_pk_bf16_f32 v70, v192, v193
    v_cvt_pk_bf16_f32 v71, v194, v195
    v_cvt_pk_bf16_f32 v72, v196, v197
    v_cvt_pk_bf16_f32 v73, v198, v199
    v_cvt_pk_bf16_f32 v74, v200, v201
    v_cvt_pk_bf16_f32 v75, v202, v203
    v_cvt_pk_bf16_f32 v76, v204, v205
    v_cvt_pk_bf16_f32 v77, v206, v207
    v_cvt_pk_bf16_f32 v78, v208, v209
    v_cvt_pk_bf16_f32 v79, v210, v211
    v_cvt_pk_bf16_f32 v80, v212, v213
    v_cvt_pk_bf16_f32 v81, v214, v215
    v_cvt_pk_bf16_f32 v82, v216, v217
    v_cvt_pk_bf16_f32 v83, v218, v219
    v_cvt_pk_bf16_f32 v84, v220, v221
    v_cvt_pk_bf16_f32 v85, v222, v223
    v_cvt_pk_bf16_f32 v86, v224, v225
    v_cvt_pk_bf16_f32 v87, v226, v227
    v_cvt_pk_bf16_f32 v88, v228, v229
    v_cvt_pk_bf16_f32 v89, v230, v231
    v_cvt_pk_bf16_f32 v90, v232, v233
    v_cvt_pk_bf16_f32 v91, v234, v235
    s_lshl_b32 s9, s3, 12
    s_add_u32 s9, s9, 122880
    v_add_u32 v3, s9, v0
    v_xor_b32_e64 v4, 16, v3
    s_mul_i32 s14, s3, 9216
    v_lshlrev_b32_e64 v14, 7, v1
    buffer_load_dword v5, v14, s[44:47], s14 offen
    v_add_u32 v15, 8192, v14
    s_mov_b64 exec, 0xff
    buffer_load_dword v5, v15, s[44:47], s14 offen
    s_mov_b64 exec, 0x3f
    global_load_dword v5, v14, s[24:25]
    global_load_dword v5, v14, s[26:27]
    s_mov_b64 exec, -1
    v_pk_fma_f32 v[16:17], v[52:53], v[52:53], s[34:35]
    v_pk_fma_f32 v[18:19], v[54:55], v[54:55], s[34:35]
    v_pk_fma_f32 v[20:21], v[56:57], v[56:57], s[34:35]
    v_pk_fma_f32 v[22:23], v[58:59], v[58:59], s[34:35]
    v_pk_mul_f32 v[16:17], v[16:17], v[52:53]
    v_pk_mul_f32 v[18:19], v[18:19], v[54:55]
    v_pk_mul_f32 v[20:21], v[20:21], v[56:57]
    v_pk_mul_f32 v[22:23], v[22:23], v[58:59]
    v_cvt_f64_f32 v[12:13], v11
    s_waitcnt lgkmcnt(1)
    v_mfma_f32_32x32x16_bf16 v[36:51], v[68:71], v[24:27], 0
    v_exp_f32 v16, v16
    v_exp_f32 v17, v17
    v_exp_f32_e64 v18, v18
    v_mfma_f32_32x32x16_bf16 v[36:51], v[72:75], v[28:31], v[36:51]
    v_exp_f32 v19, v19
    v_exp_f32 v20, v20
    v_exp_f32 v21, v21
    v_exp_f32 v22, v22
    v_exp_f32_e64 v23, v23
    v_pk_add_f32 v[16:17], v[16:17], 1.0 op_sel_hi:[1,0]
    v_pk_add_f32 v[20:21], v[20:21], 1.0 op_sel_hi:[1,0]
    v_pk_fma_f32 v[52:53], v[52:53], v[18:19], v[52:53]
    v_pk_fma_f32 v[56:57], v[56:57], v[22:23], v[56:57]
    v_pk_fma_f32 v[18:19], v[16:17], v[18:19], v[16:17]
    v_pk_fma_f32 v[22:23], v[20:21], v[22:23], v[20:21]
    v_pk_mul_f32 v[54:55], v[54:55], v[16:17]
    v_pk_mul_f32 v[58:59], v[58:59], v[20:21]
    ds_read_b128 v[24:27], v6 offset:4096
    ds_read_b128 v[28:31], v6 offset:5120
    ds_add_f64 v8, v[12:13] offset:2560
    v_mfma_f32_32x32x16_bf16 v[36:51], v[76:79], v[32:35], v[36:51]
    v_rcp_f32 v18, v18
    v_rcp_f32 v19, v19
    v_rcp_f32 v22, v22
    v_rcp_f32 v23, v23
    v_pk_mul_f32 v[52:53], v[52:53], v[18:19]
    v_pk_mul_f32 v[54:55], v[54:55], v[18:19]
    v_pk_mul_f32 v[56:57], v[56:57], v[22:23]
    v_pk_mul_f32 v[58:59], v[58:59], v[22:23]
    v_pk_fma_f32 v[16:17], v[60:61], v[60:61], s[34:35]
    v_pk_fma_f32 v[18:19], v[62:63], v[62:63], s[34:35]
    v_pk_fma_f32 v[20:21], v[64:65], v[64:65], s[34:35]
    v_pk_fma_f32 v[22:23], v[66:67], v[66:67], s[34:35]
    v_pk_mul_f32 v[16:17], v[16:17], v[60:61]
    v_pk_mul_f32 v[18:19], v[18:19], v[62:63]
    v_pk_mul_f32 v[20:21], v[20:21], v[64:65]
    v_pk_mul_f32 v[22:23], v[22:23], v[66:67]
    s_waitcnt lgkmcnt(1)
    ds_read_b128 v[32:35], v6 offset:6144
    v_mfma_f32_32x32x16_bf16 v[36:51], v[80:83], v[252:255], v[36:51]
    v_exp_f32 v16, v16
    v_exp_f32 v17, v17
    v_exp_f32 v18, v18
    v_mfma_f32_32x32x16_bf16 v[36:51], v[84:87], v[24:27], v[36:51]
    v_exp_f32 v19, v19
    v_exp_f32 v20, v20
    v_exp_f32 v21, v21
    v_exp_f32 v22, v22
    v_exp_f32_e64 v23, v23
    v_pk_add_f32 v[16:17], v[16:17], 1.0 op_sel_hi:[1,0]
    v_pk_add_f32 v[20:21], v[20:21], 1.0 op_sel_hi:[1,0]
    v_pk_fma_f32 v[60:61], v[60:61], v[18:19], v[60:61]
    v_pk_fma_f32 v[64:65], v[64:65], v[22:23], v[64:65]
    v_pk_fma_f32 v[18:19], v[16:17], v[18:19], v[16:17]
    v_pk_fma_f32 v[22:23], v[20:21], v[22:23], v[20:21]
    v_pk_mul_f32 v[62:63], v[62:63], v[16:17]
    v_pk_mul_f32 v[66:67], v[66:67], v[20:21]
    ds_read_b128 v[252:255], v6 offset:7168
    ds_read_b128 v[24:27], v6 offset:8192
    v_mfma_f32_32x32x16_bf16 v[36:51], v[88:91], v[28:31], v[36:51]
    v_rcp_f32 v18, v18
    v_rcp_f32 v19, v19
    v_rcp_f32 v22, v22
    v_rcp_f32 v23, v23
    v_cvt_pk_bf16_f32 v180, v52, v53
    v_cvt_pk_bf16_f32 v181, v54, v55
    v_cvt_pk_bf16_f32 v182, v56, v57
    v_cvt_pk_bf16_f32 v183, v58, v59
    v_pk_mul_f32 v[60:61], v[60:61], v[18:19]
    v_pk_mul_f32 v[62:63], v[62:63], v[18:19]
    v_pk_mul_f32 v[64:65], v[64:65], v[22:23]
    v_pk_mul_f32 v[66:67], v[66:67], v[22:23]
    v_cvt_pk_bf16_f32 v184, v60, v61
    v_cvt_pk_bf16_f32 v185, v62, v63
    v_cvt_pk_bf16_f32 v186, v64, v65
    v_cvt_pk_bf16_f32 v187, v66, v67
    v_dot2_f32_bf16 v11, v180, v180, 0
    v_dot2_f32_bf16 v11, v181, v181, v11
    v_dot2_f32_bf16 v11, v182, v182, v11
    v_dot2_f32_bf16 v11, v183, v183, v11
    v_dot2_f32_bf16 v11, v184, v184, v11
    v_dot2_f32_bf16 v11, v185, v185, v11
    v_dot2_f32_bf16 v11, v186, v186, v11
    v_dot2_f32_bf16 v11, v187, v187, v11
    ds_read_b128 v[28:31], v6 offset:9216
    v_pk_fma_f32 v[16:17], v[36:37], v[36:37], s[34:35]
    v_pk_fma_f32 v[18:19], v[38:39], v[38:39], s[34:35]
    v_pk_fma_f32 v[20:21], v[40:41], v[40:41], s[34:35]
    v_pk_fma_f32 v[22:23], v[42:43], v[42:43], s[34:35]
    v_pk_mul_f32 v[16:17], v[16:17], v[36:37]
    v_pk_mul_f32 v[18:19], v[18:19], v[38:39]
    v_pk_mul_f32 v[20:21], v[20:21], v[40:41]
    v_pk_mul_f32 v[22:23], v[22:23], v[42:43]
    s_setprio 2
    v_cvt_f64_f32_e64 v[12:13], v11
    s_waitcnt lgkmcnt(1)
    v_mfma_f32_32x32x16_bf16 v[52:67], v[68:71], v[32:35], 0
    v_exp_f32 v16, v16
    v_exp_f32 v17, v17
    v_exp_f32_e64 v18, v18
    v_mfma_f32_32x32x16_bf16 v[52:67], v[72:75], v[252:255], v[52:67]
    v_exp_f32 v19, v19
    v_exp_f32 v20, v20
    v_exp_f32 v21, v21
    v_exp_f32 v22, v22
    v_exp_f32_e64 v23, v23
    v_pk_add_f32 v[16:17], v[16:17], 1.0 op_sel_hi:[1,0]
    v_pk_add_f32 v[20:21], v[20:21], 1.0 op_sel_hi:[1,0]
    v_pk_fma_f32 v[36:37], v[36:37], v[18:19], v[36:37]
    v_pk_fma_f32 v[40:41], v[40:41], v[22:23], v[40:41]
    v_pk_fma_f32 v[18:19], v[16:17], v[18:19], v[16:17]
    v_pk_fma_f32 v[22:23], v[20:21], v[22:23], v[20:21]
    v_pk_mul_f32 v[38:39], v[38:39], v[16:17]
    v_pk_mul_f32 v[42:43], v[42:43], v[20:21]
    ds_read_b128 v[32:35], v6 offset:10240
    ds_read_b128 v[252:255], v6 offset:11264
    ds_add_f64 v8, v[12:13] offset:2816
    v_mfma_f32_32x32x16_bf16 v[52:67], v[76:79], v[24:27], v[52:67]
    v_rcp_f32 v18, v18
    v_rcp_f32 v19, v19
    v_rcp_f32 v22, v22
    v_rcp_f32 v23, v23
    v_pk_mul_f32 v[36:37], v[36:37], v[18:19]
    v_pk_mul_f32 v[38:39], v[38:39], v[18:19]
    v_pk_mul_f32 v[40:41], v[40:41], v[22:23]
    v_pk_mul_f32 v[42:43], v[42:43], v[22:23]
    v_pk_fma_f32 v[16:17], v[44:45], v[44:45], s[34:35]
    v_pk_fma_f32 v[18:19], v[46:47], v[46:47], s[34:35]
    v_pk_fma_f32 v[20:21], v[48:49], v[48:49], s[34:35]
    v_pk_fma_f32 v[22:23], v[50:51], v[50:51], s[34:35]
    v_pk_mul_f32 v[16:17], v[16:17], v[44:45]
    v_pk_mul_f32 v[18:19], v[18:19], v[46:47]
    v_pk_mul_f32 v[20:21], v[20:21], v[48:49]
    v_pk_mul_f32 v[22:23], v[22:23], v[50:51]
    s_waitcnt lgkmcnt(1)
    ds_read_b128 v[24:27], v6 offset:12288
    v_mfma_f32_32x32x16_bf16 v[52:67], v[80:83], v[28:31], v[52:67]
    v_exp_f32 v16, v16
    v_exp_f32 v17, v17
    v_exp_f32 v18, v18
    v_mfma_f32_32x32x16_bf16 v[52:67], v[84:87], v[32:35], v[52:67]
    v_exp_f32 v19, v19
    v_exp_f32 v20, v20
    v_exp_f32 v21, v21
    v_exp_f32 v22, v22
    v_exp_f32_e64 v23, v23
    v_pk_add_f32 v[16:17], v[16:17], 1.0 op_sel_hi:[1,0]
    v_pk_add_f32 v[20:21], v[20:21], 1.0 op_sel_hi:[1,0]
    v_pk_fma_f32 v[44:45], v[44:45], v[18:19], v[44:45]
    v_pk_fma_f32 v[48:49], v[48:49], v[22:23], v[48:49]
    v_pk_fma_f32 v[18:19], v[16:17], v[18:19], v[16:17]
    v_pk_fma_f32 v[22:23], v[20:21], v[22:23], v[20:21]
    v_pk_mul_f32 v[46:47], v[46:47], v[16:17]
    v_pk_mul_f32 v[50:51], v[50:51], v[20:21]
    ds_read_b128 v[28:31], v6 offset:13312
    ds_read_b128 v[32:35], v6 offset:14336
    v_mfma_f32_32x32x16_bf16 v[52:67], v[88:91], v[252:255], v[52:67]
    v_rcp_f32 v18, v18
    v_rcp_f32 v19, v19
    v_rcp_f32 v22, v22
    v_rcp_f32 v23, v23
    v_cvt_pk_bf16_f32 v188, v36, v37
    v_cvt_pk_bf16_f32 v189, v38, v39
    v_cvt_pk_bf16_f32 v190, v40, v41
    v_cvt_pk_bf16_f32 v191, v42, v43
    v_pk_mul_f32 v[44:45], v[44:45], v[18:19]
    v_pk_mul_f32 v[46:47], v[46:47], v[18:19]
    v_pk_mul_f32 v[48:49], v[48:49], v[22:23]
    v_pk_mul_f32 v[50:51], v[50:51], v[22:23]
    v_cvt_pk_bf16_f32 v192, v44, v45
    v_cvt_pk_bf16_f32 v193, v46, v47
    v_cvt_pk_bf16_f32 v194, v48, v49
    v_cvt_pk_bf16_f32 v195, v50, v51
    v_dot2_f32_bf16 v11, v188, v188, 0
    v_dot2_f32_bf16 v11, v189, v189, v11
    v_dot2_f32_bf16 v11, v190, v190, v11
    v_dot2_f32_bf16 v11, v191, v191, v11
    v_dot2_f32_bf16 v11, v192, v192, v11
    v_dot2_f32_bf16 v11, v193, v193, v11
    v_dot2_f32_bf16 v11, v194, v194, v11
    v_dot2_f32_bf16 v11, v195, v195, v11
    ds_read_b128 v[252:255], v6 offset:15360
    v_pk_fma_f32 v[16:17], v[52:53], v[52:53], s[34:35]
    v_pk_fma_f32 v[18:19], v[54:55], v[54:55], s[34:35]
    v_pk_fma_f32 v[20:21], v[56:57], v[56:57], s[34:35]
    v_pk_fma_f32 v[22:23], v[58:59], v[58:59], s[34:35]
    v_pk_mul_f32 v[16:17], v[16:17], v[52:53]
    v_pk_mul_f32 v[18:19], v[18:19], v[54:55]
    v_pk_mul_f32 v[20:21], v[20:21], v[56:57]
    v_pk_mul_f32 v[22:23], v[22:23], v[58:59]
    v_cvt_f64_f32 v[12:13], v11
    s_waitcnt lgkmcnt(1)
    v_mfma_f32_32x32x16_bf16 v[36:51], v[68:71], v[24:27], 0
    v_exp_f32 v16, v16
    v_exp_f32 v17, v17
    v_exp_f32_e64 v18, v18
    v_mfma_f32_32x32x16_bf16 v[36:51], v[72:75], v[28:31], v[36:51]
    v_exp_f32 v19, v19
    v_exp_f32 v20, v20
    v_exp_f32 v21, v21
    v_exp_f32 v22, v22
    v_exp_f32_e64 v23, v23
    v_pk_add_f32 v[16:17], v[16:17], 1.0 op_sel_hi:[1,0]
    v_pk_add_f32 v[20:21], v[20:21], 1.0 op_sel_hi:[1,0]
    v_pk_fma_f32 v[52:53], v[52:53], v[18:19], v[52:53]
    v_pk_fma_f32 v[56:57], v[56:57], v[22:23], v[56:57]
    v_pk_fma_f32 v[18:19], v[16:17], v[18:19], v[16:17]
    v_pk_fma_f32 v[22:23], v[20:21], v[22:23], v[20:21]
    v_pk_mul_f32 v[54:55], v[54:55], v[16:17]
    v_pk_mul_f32 v[58:59], v[58:59], v[20:21]
    ds_read_b128 v[24:27], v6 offset:16384
    ds_read_b128 v[28:31], v6 offset:17408
    ds_add_f64 v8, v[12:13] offset:0
    v_mfma_f32_32x32x16_bf16 v[36:51], v[76:79], v[32:35], v[36:51]
    v_rcp_f32 v18, v18
    v_rcp_f32 v19, v19
    v_rcp_f32 v22, v22
    v_rcp_f32 v23, v23
    v_pk_mul_f32 v[52:53], v[52:53], v[18:19]
    v_pk_mul_f32 v[54:55], v[54:55], v[18:19]
    v_pk_mul_f32 v[56:57], v[56:57], v[22:23]
    v_pk_mul_f32 v[58:59], v[58:59], v[22:23]
    v_pk_fma_f32 v[16:17], v[60:61], v[60:61], s[34:35]
    v_pk_fma_f32 v[18:19], v[62:63], v[62:63], s[34:35]
    v_pk_fma_f32 v[20:21], v[64:65], v[64:65], s[34:35]
    v_pk_fma_f32 v[22:23], v[66:67], v[66:67], s[34:35]
    v_pk_mul_f32 v[16:17], v[16:17], v[60:61]
    v_pk_mul_f32 v[18:19], v[18:19], v[62:63]
    v_pk_mul_f32 v[20:21], v[20:21], v[64:65]
    v_pk_mul_f32 v[22:23], v[22:23], v[66:67]
    s_waitcnt lgkmcnt(1)
    ds_read_b128 v[32:35], v6 offset:18432
    v_mfma_f32_32x32x16_bf16 v[36:51], v[80:83], v[252:255], v[36:51]
    v_exp_f32 v16, v16
    v_exp_f32 v17, v17
    v_exp_f32 v18, v18
    v_mfma_f32_32x32x16_bf16 v[36:51], v[84:87], v[24:27], v[36:51]
    v_exp_f32 v19, v19
    v_exp_f32 v20, v20
    v_exp_f32 v21, v21
    v_exp_f32 v22, v22
    v_exp_f32_e64 v23, v23
    v_pk_add_f32 v[16:17], v[16:17], 1.0 op_sel_hi:[1,0]
    v_pk_add_f32 v[20:21], v[20:21], 1.0 op_sel_hi:[1,0]
    v_pk_fma_f32 v[60:61], v[60:61], v[18:19], v[60:61]
    v_pk_fma_f32 v[64:65], v[64:65], v[22:23], v[64:65]
    v_pk_fma_f32 v[18:19], v[16:17], v[18:19], v[16:17]
    v_pk_fma_f32 v[22:23], v[20:21], v[22:23], v[20:21]
    v_pk_mul_f32 v[62:63], v[62:63], v[16:17]
    v_pk_mul_f32 v[66:67], v[66:67], v[20:21]
    ds_read_b128 v[252:255], v6 offset:19456
    ds_read_b128 v[24:27], v6 offset:20480
    v_mfma_f32_32x32x16_bf16 v[36:51], v[88:91], v[28:31], v[36:51]
    v_rcp_f32 v18, v18
    v_rcp_f32 v19, v19
    v_rcp_f32 v22, v22
    v_rcp_f32 v23, v23
    v_cvt_pk_bf16_f32 v196, v52, v53
    v_cvt_pk_bf16_f32 v197, v54, v55
    v_cvt_pk_bf16_f32 v198, v56, v57
    v_cvt_pk_bf16_f32 v199, v58, v59
    v_pk_mul_f32 v[60:61], v[60:61], v[18:19]
    v_pk_mul_f32 v[62:63], v[62:63], v[18:19]
    v_pk_mul_f32 v[64:65], v[64:65], v[22:23]
    v_pk_mul_f32 v[66:67], v[66:67], v[22:23]
    v_cvt_pk_bf16_f32 v200, v60, v61
    v_cvt_pk_bf16_f32 v201, v62, v63
    v_cvt_pk_bf16_f32 v202, v64, v65
    v_cvt_pk_bf16_f32 v203, v66, v67
    v_dot2_f32_bf16 v11, v196, v196, 0
    v_dot2_f32_bf16 v11, v197, v197, v11
    v_dot2_f32_bf16 v11, v198, v198, v11
    v_dot2_f32_bf16 v11, v199, v199, v11
    v_dot2_f32_bf16 v11, v200, v200, v11
    v_dot2_f32_bf16 v11, v201, v201, v11
    v_dot2_f32_bf16 v11, v202, v202, v11
    v_dot2_f32_bf16 v11, v203, v203, v11
    ds_read_b128 v[28:31], v6 offset:21504
    v_pk_fma_f32 v[16:17], v[36:37], v[36:37], s[34:35]
    v_pk_fma_f32 v[18:19], v[38:39], v[38:39], s[34:35]
    v_pk_fma_f32 v[20:21], v[40:41], v[40:41], s[34:35]
    v_pk_fma_f32 v[22:23], v[42:43], v[42:43], s[34:35]
    v_pk_mul_f32 v[16:17], v[16:17], v[36:37]
    v_pk_mul_f32 v[18:19], v[18:19], v[38:39]
    v_pk_mul_f32 v[20:21], v[20:21], v[40:41]
    v_pk_mul_f32 v[22:23], v[22:23], v[42:43]
    v_cvt_f64_f32 v[12:13], v11
    s_waitcnt lgkmcnt(1)
    v_mfma_f32_32x32x16_bf16 v[52:67], v[68:71], v[32:35], 0
    v_exp_f32 v16, v16
    v_exp_f32 v17, v17
    v_exp_f32_e64 v18, v18
    v_mfma_f32_32x32x16_bf16 v[52:67], v[72:75], v[252:255], v[52:67]
    v_exp_f32 v19, v19
    v_exp_f32 v20, v20
    v_exp_f32 v21, v21
    v_exp_f32 v22, v22
    v_exp_f32_e64 v23, v23
    v_pk_add_f32 v[16:17], v[16:17], 1.0 op_sel_hi:[1,0]
    v_pk_add_f32 v[20:21], v[20:21], 1.0 op_sel_hi:[1,0]
    v_pk_fma_f32 v[36:37], v[36:37], v[18:19], v[36:37]
    v_pk_fma_f32 v[40:41], v[40:41], v[22:23], v[40:41]
    v_pk_fma_f32 v[18:19], v[16:17], v[18:19], v[16:17]
    v_pk_fma_f32 v[22:23], v[20:21], v[22:23], v[20:21]
    v_pk_mul_f32 v[38:39], v[38:39], v[16:17]
    v_pk_mul_f32 v[42:43], v[42:43], v[20:21]
    ds_read_b128 v[32:35], v6 offset:22528
    ds_read_b128 v[252:255], v6 offset:23552
    ds_add_f64 v8, v[12:13] offset:256
    v_mfma_f32_32x32x16_bf16 v[52:67], v[76:79], v[24:27], v[52:67]
    v_rcp_f32 v18, v18
    v_rcp_f32 v19, v19
    v_rcp_f32 v22, v22
    v_rcp_f32 v23, v23
    v_pk_mul_f32 v[36:37], v[36:37], v[18:19]
    v_pk_mul_f32 v[38:39], v[38:39], v[18:19]
    v_pk_mul_f32 v[40:41], v[40:41], v[22:23]
    v_pk_mul_f32 v[42:43], v[42:43], v[22:23]
    v_pk_fma_f32 v[16:17], v[44:45], v[44:45], s[34:35]
    v_pk_fma_f32 v[18:19], v[46:47], v[46:47], s[34:35]
    v_pk_fma_f32 v[20:21], v[48:49], v[48:49], s[34:35]
    v_pk_fma_f32 v[22:23], v[50:51], v[50:51], s[34:35]
    v_pk_mul_f32 v[16:17], v[16:17], v[44:45]
    v_pk_mul_f32 v[18:19], v[18:19], v[46:47]
    v_pk_mul_f32 v[20:21], v[20:21], v[48:49]
    v_pk_mul_f32 v[22:23], v[22:23], v[50:51]
    s_waitcnt lgkmcnt(1)
    ds_read_b128 v[24:27], v6 offset:24576
    v_mfma_f32_32x32x16_bf16 v[52:67], v[80:83], v[28:31], v[52:67]
    v_exp_f32 v16, v16
    v_exp_f32 v17, v17
    v_exp_f32 v18, v18
    v_mfma_f32_32x32x16_bf16 v[52:67], v[84:87], v[32:35], v[52:67]
    v_exp_f32 v19, v19
    v_exp_f32 v20, v20
    v_exp_f32 v21, v21
    v_exp_f32 v22, v22
    v_exp_f32_e64 v23, v23
    v_pk_add_f32 v[16:17], v[16:17], 1.0 op_sel_hi:[1,0]
    v_pk_add_f32 v[20:21], v[20:21], 1.0 op_sel_hi:[1,0]
    v_pk_fma_f32 v[44:45], v[44:45], v[18:19], v[44:45]
    v_pk_fma_f32 v[48:49], v[48:49], v[22:23], v[48:49]
    v_pk_fma_f32 v[18:19], v[16:17], v[18:19], v[16:17]
    v_pk_fma_f32 v[22:23], v[20:21], v[22:23], v[20:21]
    v_pk_mul_f32 v[46:47], v[46:47], v[16:17]
    v_pk_mul_f32 v[50:51], v[50:51], v[20:21]
    ds_read_b128 v[28:31], v6 offset:25600
    ds_read_b128 v[32:35], v6 offset:26624
    v_mfma_f32_32x32x16_bf16 v[52:67], v[88:91], v[252:255], v[52:67]
    v_rcp_f32 v18, v18
    v_rcp_f32 v19, v19
    v_rcp_f32 v22, v22
    v_rcp_f32 v23, v23
    v_cvt_pk_bf16_f32 v204, v36, v37
    v_cvt_pk_bf16_f32 v205, v38, v39
    v_cvt_pk_bf16_f32 v206, v40, v41
    v_cvt_pk_bf16_f32 v207, v42, v43
    v_pk_mul_f32 v[44:45], v[44:45], v[18:19]
    v_pk_mul_f32 v[46:47], v[46:47], v[18:19]
    v_pk_mul_f32 v[48:49], v[48:49], v[22:23]
    v_pk_mul_f32 v[50:51], v[50:51], v[22:23]
    v_cvt_pk_bf16_f32 v208, v44, v45
    v_cvt_pk_bf16_f32 v209, v46, v47
    v_cvt_pk_bf16_f32 v210, v48, v49
    v_cvt_pk_bf16_f32 v211, v50, v51
    v_dot2_f32_bf16 v11, v204, v204, 0
    v_dot2_f32_bf16 v11, v205, v205, v11
    v_dot2_f32_bf16 v11, v206, v206, v11
    v_dot2_f32_bf16 v11, v207, v207, v11
    v_dot2_f32_bf16 v11, v208, v208, v11
    v_dot2_f32_bf16 v11, v209, v209, v11
    v_dot2_f32_bf16 v11, v210, v210, v11
    v_dot2_f32_bf16 v11, v211, v211, v11
    ds_read_b128 v[252:255], v6 offset:27648
    v_pk_fma_f32 v[16:17], v[52:53], v[52:53], s[34:35]
    v_pk_fma_f32 v[18:19], v[54:55], v[54:55], s[34:35]
    v_pk_fma_f32 v[20:21], v[56:57], v[56:57], s[34:35]
    v_pk_fma_f32 v[22:23], v[58:59], v[58:59], s[34:35]
    v_pk_mul_f32 v[16:17], v[16:17], v[52:53]
    v_pk_mul_f32 v[18:19], v[18:19], v[54:55]
    v_pk_mul_f32 v[20:21], v[20:21], v[56:57]
    v_pk_mul_f32 v[22:23], v[22:23], v[58:59]
    v_cvt_f64_f32 v[12:13], v11
    s_waitcnt lgkmcnt(1)
    v_mfma_f32_32x32x16_bf16 v[36:51], v[68:71], v[24:27], 0
    v_exp_f32 v16, v16
    v_exp_f32 v17, v17
    v_exp_f32_e64 v18, v18
    v_mfma_f32_32x32x16_bf16 v[36:51], v[72:75], v[28:31], v[36:51]
    v_exp_f32 v19, v19
    v_exp_f32 v20, v20
    v_exp_f32 v21, v21
    v_exp_f32 v22, v22
    v_exp_f32_e64 v23, v23
    v_pk_add_f32 v[16:17], v[16:17], 1.0 op_sel_hi:[1,0]
    v_pk_add_f32 v[20:21], v[20:21], 1.0 op_sel_hi:[1,0]
    v_pk_fma_f32 v[52:53], v[52:53], v[18:19], v[52:53]
    v_pk_fma_f32 v[56:57], v[56:57], v[22:23], v[56:57]
    v_pk_fma_f32 v[18:19], v[16:17], v[18:19], v[16:17]
    v_pk_fma_f32 v[22:23], v[20:21], v[22:23], v[20:21]
    v_pk_mul_f32 v[54:55], v[54:55], v[16:17]
    v_pk_mul_f32 v[58:59], v[58:59], v[20:21]
    ds_read_b128 v[24:27], v6 offset:28672
    ds_read_b128 v[28:31], v6 offset:29696
    ds_add_f64 v8, v[12:13] offset:512
    v_mfma_f32_32x32x16_bf16 v[36:51], v[76:79], v[32:35], v[36:51]
    v_rcp_f32 v18, v18
    v_rcp_f32 v19, v19
    v_rcp_f32 v22, v22
    v_rcp_f32 v23, v23
    v_pk_mul_f32 v[52:53], v[52:53], v[18:19]
    v_pk_mul_f32 v[54:55], v[54:55], v[18:19]
    v_pk_mul_f32 v[56:57], v[56:57], v[22:23]
    v_pk_mul_f32 v[58:59], v[58:59], v[22:23]
    v_pk_fma_f32 v[16:17], v[60:61], v[60:61], s[34:35]
    v_pk_fma_f32 v[18:19], v[62:63], v[62:63], s[34:35]
    v_pk_fma_f32 v[20:21], v[64:65], v[64:65], s[34:35]
    v_pk_fma_f32 v[22:23], v[66:67], v[66:67], s[34:35]
    v_pk_mul_f32 v[16:17], v[16:17], v[60:61]
    v_pk_mul_f32 v[18:19], v[18:19], v[62:63]
    v_pk_mul_f32 v[20:21], v[20:21], v[64:65]
    v_pk_mul_f32 v[22:23], v[22:23], v[66:67]
    s_waitcnt lgkmcnt(1)
    ds_read_b128 v[32:35], v6 offset:30720
    v_mfma_f32_32x32x16_bf16 v[36:51], v[80:83], v[252:255], v[36:51]
    v_exp_f32 v16, v16
    v_exp_f32 v17, v17
    v_exp_f32 v18, v18
    v_mfma_f32_32x32x16_bf16 v[36:51], v[84:87], v[24:27], v[36:51]
    v_exp_f32 v19, v19
    v_exp_f32 v20, v20
    v_exp_f32 v21, v21
    v_exp_f32 v22, v22
    v_exp_f32_e64 v23, v23
    v_pk_add_f32 v[16:17], v[16:17], 1.0 op_sel_hi:[1,0]
    v_pk_add_f32 v[20:21], v[20:21], 1.0 op_sel_hi:[1,0]
    v_pk_fma_f32 v[60:61], v[60:61], v[18:19], v[60:61]
    v_pk_fma_f32 v[64:65], v[64:65], v[22:23], v[64:65]
    v_pk_fma_f32 v[18:19], v[16:17], v[18:19], v[16:17]
    v_pk_fma_f32 v[22:23], v[20:21], v[22:23], v[20:21]
    v_pk_mul_f32 v[62:63], v[62:63], v[16:17]
    v_pk_mul_f32 v[66:67], v[66:67], v[20:21]
    ds_read_b128 v[252:255], v6 offset:31744
    ds_read_b128 v[24:27], v6 offset:32768
    v_mfma_f32_32x32x16_bf16 v[36:51], v[88:91], v[28:31], v[36:51]
    v_rcp_f32 v18, v18
    v_rcp_f32 v19, v19
    v_rcp_f32 v22, v22
    v_rcp_f32 v23, v23
    v_cvt_pk_bf16_f32 v212, v52, v53
    v_cvt_pk_bf16_f32 v213, v54, v55
    v_cvt_pk_bf16_f32 v214, v56, v57
    v_cvt_pk_bf16_f32 v215, v58, v59
    v_pk_mul_f32 v[60:61], v[60:61], v[18:19]
    v_pk_mul_f32 v[62:63], v[62:63], v[18:19]
    v_pk_mul_f32 v[64:65], v[64:65], v[22:23]
    v_pk_mul_f32 v[66:67], v[66:67], v[22:23]
    v_cvt_pk_bf16_f32 v216, v60, v61
    v_cvt_pk_bf16_f32 v217, v62, v63
    v_cvt_pk_bf16_f32 v218, v64, v65
    v_cvt_pk_bf16_f32 v219, v66, v67
    v_dot2_f32_bf16 v11, v212, v212, 0
    v_dot2_f32_bf16 v11, v213, v213, v11
    v_dot2_f32_bf16 v11, v214, v214, v11
    v_dot2_f32_bf16 v11, v215, v215, v11
    v_dot2_f32_bf16 v11, v216, v216, v11
    v_dot2_f32_bf16 v11, v217, v217, v11
    v_dot2_f32_bf16 v11, v218, v218, v11
    v_dot2_f32_bf16 v11, v219, v219, v11
    ds_read_b128 v[28:31], v6 offset:33792
    v_pk_fma_f32 v[16:17], v[36:37], v[36:37], s[34:35]
    v_pk_fma_f32 v[18:19], v[38:39], v[38:39], s[34:35]
    v_pk_fma_f32 v[20:21], v[40:41], v[40:41], s[34:35]
    v_pk_fma_f32 v[22:23], v[42:43], v[42:43], s[34:35]
    v_pk_mul_f32 v[16:17], v[16:17], v[36:37]
    v_pk_mul_f32 v[18:19], v[18:19], v[38:39]
    v_pk_mul_f32 v[20:21], v[20:21], v[40:41]
    v_pk_mul_f32 v[22:23], v[22:23], v[42:43]
    v_cvt_f64_f32 v[12:13], v11
    s_waitcnt lgkmcnt(1)
    v_mfma_f32_32x32x16_bf16 v[52:67], v[68:71], v[32:35], 0
    v_exp_f32 v16, v16
    v_exp_f32 v17, v17
    v_exp_f32_e64 v18, v18
    v_mfma_f32_32x32x16_bf16 v[52:67], v[72:75], v[252:255], v[52:67]
    v_exp_f32 v19, v19
    v_exp_f32 v20, v20
    v_exp_f32 v21, v21
    v_exp_f32 v22, v22
    v_exp_f32_e64 v23, v23
    v_pk_add_f32 v[16:17], v[16:17], 1.0 op_sel_hi:[1,0]
    v_pk_add_f32 v[20:21], v[20:21], 1.0 op_sel_hi:[1,0]
    v_pk_fma_f32 v[36:37], v[36:37], v[18:19], v[36:37]
    v_pk_fma_f32 v[40:41], v[40:41], v[22:23], v[40:41]
    v_pk_fma_f32 v[18:19], v[16:17], v[18:19], v[16:17]
    v_pk_fma_f32 v[22:23], v[20:21], v[22:23], v[20:21]
    v_pk_mul_f32 v[38:39], v[38:39], v[16:17]
    v_pk_mul_f32 v[42:43], v[42:43], v[20:21]
    ds_read_b128 v[32:35], v6 offset:34816
    ds_read_b128 v[252:255], v6 offset:35840
    ds_add_f64 v8, v[12:13] offset:768
    v_mfma_f32_32x32x16_bf16 v[52:67], v[76:79], v[24:27], v[52:67]
    v_rcp_f32 v18, v18
    v_rcp_f32 v19, v19
    v_rcp_f32 v22, v22
    v_rcp_f32 v23, v23
    v_pk_mul_f32 v[36:37], v[36:37], v[18:19]
    v_pk_mul_f32 v[38:39], v[38:39], v[18:19]
    v_pk_mul_f32 v[40:41], v[40:41], v[22:23]
    v_pk_mul_f32 v[42:43], v[42:43], v[22:23]
    v_pk_fma_f32 v[16:17], v[44:45], v[44:45], s[34:35]
    v_pk_fma_f32 v[18:19], v[46:47], v[46:47], s[34:35]
    v_pk_fma_f32 v[20:21], v[48:49], v[48:49], s[34:35]
    v_pk_fma_f32 v[22:23], v[50:51], v[50:51], s[34:35]
    v_pk_mul_f32 v[16:17], v[16:17], v[44:45]
    v_pk_mul_f32 v[18:19], v[18:19], v[46:47]
    v_pk_mul_f32 v[20:21], v[20:21], v[48:49]
    v_pk_mul_f32 v[22:23], v[22:23], v[50:51]
    s_waitcnt lgkmcnt(1)
    ds_read_b128 v[24:27], v7 offset:0
    v_mfma_f32_32x32x16_bf16 v[52:67], v[80:83], v[28:31], v[52:67]
    v_exp_f32 v16, v16
    v_exp_f32 v17, v17
    v_exp_f32 v18, v18
    v_mfma_f32_32x32x16_bf16 v[52:67], v[84:87], v[32:35], v[52:67]
    v_exp_f32 v19, v19
    v_exp_f32 v20, v20
    v_exp_f32 v21, v21
    v_exp_f32 v22, v22
    v_exp_f32_e64 v23, v23
    v_pk_add_f32 v[16:17], v[16:17], 1.0 op_sel_hi:[1,0]
    v_pk_add_f32 v[20:21], v[20:21], 1.0 op_sel_hi:[1,0]
    v_pk_fma_f32 v[44:45], v[44:45], v[18:19], v[44:45]
    v_pk_fma_f32 v[48:49], v[48:49], v[22:23], v[48:49]
    v_pk_fma_f32 v[18:19], v[16:17], v[18:19], v[16:17]
    v_pk_fma_f32 v[22:23], v[20:21], v[22:23], v[20:21]
    v_pk_mul_f32 v[46:47], v[46:47], v[16:17]
    v_pk_mul_f32 v[50:51], v[50:51], v[20:21]
    ds_read_b128 v[28:31], v7 offset:1024
    ds_read_b128 v[32:35], v7 offset:2048
    v_mfma_f32_32x32x16_bf16 v[52:67], v[88:91], v[252:255], v[52:67]
    v_rcp_f32 v18, v18
    v_rcp_f32 v19, v19
    v_rcp_f32 v22, v22
    v_rcp_f32 v23, v23
    v_cvt_pk_bf16_f32 v220, v36, v37
    v_cvt_pk_bf16_f32 v221, v38, v39
    v_cvt_pk_bf16_f32 v222, v40, v41
    v_cvt_pk_bf16_f32 v223, v42, v43
    v_pk_mul_f32 v[44:45], v[44:45], v[18:19]
    v_pk_mul_f32 v[46:47], v[46:47], v[18:19]
    v_pk_mul_f32 v[48:49], v[48:49], v[22:23]
    v_pk_mul_f32 v[50:51], v[50:51], v[22:23]
    v_cvt_pk_bf16_f32 v224, v44, v45
    v_cvt_pk_bf16_f32 v225, v46, v47
    v_cvt_pk_bf16_f32 v226, v48, v49
    v_cvt_pk_bf16_f32 v227, v50, v51
    v_dot2_f32_bf16 v11, v220, v220, 0
    v_dot2_f32_bf16 v11, v221, v221, v11
    v_dot2_f32_bf16 v11, v222, v222, v11
    v_dot2_f32_bf16 v11, v223, v223, v11
    v_dot2_f32_bf16 v11, v224, v224, v11
    v_dot2_f32_bf16 v11, v225, v225, v11
    v_dot2_f32_bf16 v11, v226, v226, v11
    v_dot2_f32_bf16 v11, v227, v227, v11
    ds_read_b128 v[252:255], v7 offset:3072
    v_mov_b32_e64 v10, 0
    global_load_dword v2, v10, s[30:31] sc1
    v_pk_fma_f32 v[16:17], v[52:53], v[52:53], s[34:35]
    v_pk_fma_f32 v[18:19], v[54:55], v[54:55], s[34:35]
    v_pk_fma_f32 v[20:21], v[56:57], v[56:57], s[34:35]
    v_pk_fma_f32 v[22:23], v[58:59], v[58:59], s[34:35]
    v_pk_mul_f32 v[16:17], v[16:17], v[52:53]
    v_pk_mul_f32 v[18:19], v[18:19], v[54:55]
    v_pk_mul_f32 v[20:21], v[20:21], v[56:57]
    v_pk_mul_f32 v[22:23], v[22:23], v[58:59]
    v_cvt_f64_f32 v[12:13], v11
    s_waitcnt lgkmcnt(1)
    v_mfma_f32_32x32x16_bf16 v[36:51], v[68:71], v[24:27], 0
    v_exp_f32 v16, v16
    v_exp_f32 v17, v17
    v_exp_f32_e64 v18, v18
    v_mfma_f32_32x32x16_bf16 v[36:51], v[72:75], v[28:31], v[36:51]
    v_exp_f32 v19, v19
    v_exp_f32 v20, v20
    v_exp_f32 v21, v21
    v_exp_f32 v22, v22
    v_exp_f32_e64 v23, v23
    v_pk_add_f32 v[16:17], v[16:17], 1.0 op_sel_hi:[1,0]
    v_pk_add_f32 v[20:21], v[20:21], 1.0 op_sel_hi:[1,0]
    v_pk_fma_f32 v[52:53], v[52:53], v[18:19], v[52:53]
    v_pk_fma_f32 v[56:57], v[56:57], v[22:23], v[56:57]
    v_pk_fma_f32 v[18:19], v[16:17], v[18:19], v[16:17]
    v_pk_fma_f32 v[22:23], v[20:21], v[22:23], v[20:21]
    v_pk_mul_f32 v[54:55], v[54:55], v[16:17]
    v_pk_mul_f32 v[58:59], v[58:59], v[20:21]
    ds_read_b128 v[24:27], v7 offset:4096
    ds_read_b128 v[28:31], v7 offset:5120
    ds_add_f64 v8, v[12:13] offset:1024
    v_mfma_f32_32x32x16_bf16 v[36:51], v[76:79], v[32:35], v[36:51]
    v_rcp_f32 v18, v18
    v_rcp_f32 v19, v19
    v_rcp_f32 v22, v22
    v_rcp_f32 v23, v23
    v_pk_mul_f32 v[52:53], v[52:53], v[18:19]
    v_pk_mul_f32 v[54:55], v[54:55], v[18:19]
    v_pk_mul_f32 v[56:57], v[56:57], v[22:23]
    v_pk_mul_f32 v[58:59], v[58:59], v[22:23]
    v_pk_fma_f32 v[16:17], v[60:61], v[60:61], s[34:35]
    v_pk_fma_f32 v[18:19], v[62:63], v[62:63], s[34:35]
    v_pk_fma_f32 v[20:21], v[64:65], v[64:65], s[34:35]
    v_pk_fma_f32 v[22:23], v[66:67], v[66:67], s[34:35]
    v_pk_mul_f32 v[16:17], v[16:17], v[60:61]
    v_pk_mul_f32 v[18:19], v[18:19], v[62:63]
    v_pk_mul_f32 v[20:21], v[20:21], v[64:65]
    v_pk_mul_f32 v[22:23], v[22:23], v[66:67]
    s_waitcnt lgkmcnt(1)
    ds_read_b128 v[32:35], v7 offset:6144
    v_mfma_f32_32x32x16_bf16 v[36:51], v[80:83], v[252:255], v[36:51]
    v_exp_f32 v16, v16
    v_exp_f32 v17, v17
    v_exp_f32 v18, v18
    v_mfma_f32_32x32x16_bf16 v[36:51], v[84:87], v[24:27], v[36:51]
    v_exp_f32 v19, v19
    v_exp_f32 v20, v20
    v_exp_f32 v21, v21
    v_exp_f32 v22, v22
    v_exp_f32_e64 v23, v23
    v_pk_add_f32 v[16:17], v[16:17], 1.0 op_sel_hi:[1,0]
    v_pk_add_f32 v[20:21], v[20:21], 1.0 op_sel_hi:[1,0]
    v_pk_fma_f32 v[60:61], v[60:61], v[18:19], v[60:61]
    v_pk_fma_f32 v[64:65], v[64:65], v[22:23], v[64:65]
    v_pk_fma_f32 v[18:19], v[16:17], v[18:19], v[16:17]
    v_pk_fma_f32 v[22:23], v[20:21], v[22:23], v[20:21]
    v_pk_mul_f32 v[62:63], v[62:63], v[16:17]
    v_pk_mul_f32 v[66:67], v[66:67], v[20:21]
    ds_read_b128 v[252:255], v7 offset:7168
    ds_read_b128 v[24:27], v7 offset:8192
    v_mfma_f32_32x32x16_bf16 v[36:51], v[88:91], v[28:31], v[36:51]
    v_rcp_f32 v18, v18
    v_rcp_f32 v19, v19
    v_rcp_f32 v22, v22
    v_rcp_f32 v23, v23
    v_cvt_pk_bf16_f32 v228, v52, v53
    v_cvt_pk_bf16_f32 v229, v54, v55
    v_cvt_pk_bf16_f32 v230, v56, v57
    v_cvt_pk_bf16_f32 v231, v58, v59
    v_pk_mul_f32 v[60:61], v[60:61], v[18:19]
    v_pk_mul_f32 v[62:63], v[62:63], v[18:19]
    v_pk_mul_f32 v[64:65], v[64:65], v[22:23]
    v_pk_mul_f32 v[66:67], v[66:67], v[22:23]
    v_cvt_pk_bf16_f32 v232, v60, v61
    v_cvt_pk_bf16_f32 v233, v62, v63
    v_cvt_pk_bf16_f32 v234, v64, v65
    v_cvt_pk_bf16_f32 v235, v66, v67
    v_dot2_f32_bf16 v11, v228, v228, 0
    v_dot2_f32_bf16 v11, v229, v229, v11
    v_dot2_f32_bf16 v11, v230, v230, v11
    v_dot2_f32_bf16 v11, v231, v231, v11
    v_dot2_f32_bf16 v11, v232, v232, v11
    v_dot2_f32_bf16 v11, v233, v233, v11
    v_dot2_f32_bf16 v11, v234, v234, v11
    v_dot2_f32_bf16 v11, v235, v235, v11
    ds_read_b128 v[28:31], v7 offset:9216
    v_pk_fma_f32 v[16:17], v[36:37], v[36:37], s[34:35]
    v_pk_fma_f32 v[18:19], v[38:39], v[38:39], s[34:35]
    v_pk_fma_f32 v[20:21], v[40:41], v[40:41], s[34:35]
    v_pk_fma_f32 v[22:23], v[42:43], v[42:43], s[34:35]
    v_pk_mul_f32 v[16:17], v[16:17], v[36:37]
    v_pk_mul_f32 v[18:19], v[18:19], v[38:39]
    v_pk_mul_f32 v[20:21], v[20:21], v[40:41]
    v_pk_mul_f32 v[22:23], v[22:23], v[42:43]
    v_cvt_f64_f32 v[12:13], v11
    s_waitcnt lgkmcnt(1)
    v_mfma_f32_32x32x16_bf16 v[52:67], v[68:71], v[32:35], 0
    v_exp_f32 v16, v16
    v_exp_f32 v17, v17
    v_exp_f32_e64 v18, v18
    v_mfma_f32_32x32x16_bf16 v[52:67], v[72:75], v[252:255], v[52:67]
    v_exp_f32 v19, v19
    v_exp_f32 v20, v20
    v_exp_f32 v21, v21
    v_exp_f32 v22, v22
    v_exp_f32_e64 v23, v23
    v_pk_add_f32 v[16:17], v[16:17], 1.0 op_sel_hi:[1,0]
    v_pk_add_f32 v[20:21], v[20:21], 1.0 op_sel_hi:[1,0]
    v_pk_fma_f32 v[36:37], v[36:37], v[18:19], v[36:37]
    v_pk_fma_f32 v[40:41], v[40:41], v[22:23], v[40:41]
    v_pk_fma_f32 v[18:19], v[16:17], v[18:19], v[16:17]
    v_pk_fma_f32 v[22:23], v[20:21], v[22:23], v[20:21]
    v_pk_mul_f32 v[38:39], v[38:39], v[16:17]
    v_pk_mul_f32 v[42:43], v[42:43], v[20:21]
    ds_read_b128 v[32:35], v7 offset:10240
    ds_read_b128 v[252:255], v7 offset:11264
    ds_add_f64 v8, v[12:13] offset:1280
    v_mfma_f32_32x32x16_bf16 v[52:67], v[76:79], v[24:27], v[52:67]
    v_rcp_f32 v18, v18
    v_rcp_f32 v19, v19
    v_rcp_f32 v22, v22
    v_rcp_f32 v23, v23
    v_pk_mul_f32 v[36:37], v[36:37], v[18:19]
    v_pk_mul_f32 v[38:39], v[38:39], v[18:19]
    v_pk_mul_f32 v[40:41], v[40:41], v[22:23]
    v_pk_mul_f32 v[42:43], v[42:43], v[22:23]
    v_pk_fma_f32 v[16:17], v[44:45], v[44:45], s[34:35]
    v_pk_fma_f32 v[18:19], v[46:47], v[46:47], s[34:35]
    v_pk_fma_f32 v[20:21], v[48:49], v[48:49], s[34:35]
    v_pk_fma_f32 v[22:23], v[50:51], v[50:51], s[34:35]
    v_pk_mul_f32 v[16:17], v[16:17], v[44:45]
    v_pk_mul_f32 v[18:19], v[18:19], v[46:47]
    v_pk_mul_f32 v[20:21], v[20:21], v[48:49]
    v_pk_mul_f32 v[22:23], v[22:23], v[50:51]
    s_waitcnt lgkmcnt(1)
    ds_read_b128 v[24:27], v7 offset:12288
    v_mfma_f32_32x32x16_bf16 v[52:67], v[80:83], v[28:31], v[52:67]
    v_exp_f32 v16, v16
    v_exp_f32 v17, v17
    v_exp_f32 v18, v18
    v_mfma_f32_32x32x16_bf16 v[52:67], v[84:87], v[32:35], v[52:67]
    v_exp_f32 v19, v19
    v_exp_f32 v20, v20
    v_exp_f32 v21, v21
    v_exp_f32 v22, v22
    v_exp_f32_e64 v23, v23
    v_pk_add_f32 v[16:17], v[16:17], 1.0 op_sel_hi:[1,0]
    v_pk_add_f32 v[20:21], v[20:21], 1.0 op_sel_hi:[1,0]
    v_pk_fma_f32 v[44:45], v[44:45], v[18:19], v[44:45]
    v_pk_fma_f32 v[48:49], v[48:49], v[22:23], v[48:49]
    v_pk_fma_f32 v[18:19], v[16:17], v[18:19], v[16:17]
    v_pk_fma_f32 v[22:23], v[20:21], v[22:23], v[20:21]
    v_pk_mul_f32 v[46:47], v[46:47], v[16:17]
    v_pk_mul_f32 v[50:51], v[50:51], v[20:21]
    ds_read_b128 v[28:31], v7 offset:13312
    ds_read_b128 v[32:35], v7 offset:14336
    v_mfma_f32_32x32x16_bf16 v[52:67], v[88:91], v[252:255], v[52:67]
    v_rcp_f32 v18, v18
    v_rcp_f32 v19, v19
    v_rcp_f32 v22, v22
    v_rcp_f32 v23, v23
    v_cvt_pk_bf16_f32 v236, v36, v37
    v_cvt_pk_bf16_f32 v237, v38, v39
    v_cvt_pk_bf16_f32 v238, v40, v41
    v_cvt_pk_bf16_f32 v239, v42, v43
    v_pk_mul_f32 v[44:45], v[44:45], v[18:19]
    v_pk_mul_f32 v[46:47], v[46:47], v[18:19]
    v_pk_mul_f32 v[48:49], v[48:49], v[22:23]
    v_pk_mul_f32 v[50:51], v[50:51], v[22:23]
    v_cvt_pk_bf16_f32 v240, v44, v45
    v_cvt_pk_bf16_f32 v241, v46, v47
    v_cvt_pk_bf16_f32 v242, v48, v49
    v_cvt_pk_bf16_f32 v243, v50, v51
    v_dot2_f32_bf16 v11, v236, v236, 0
    v_dot2_f32_bf16 v11, v237, v237, v11
    v_dot2_f32_bf16 v11, v238, v238, v11
    v_dot2_f32_bf16 v11, v239, v239, v11
    v_dot2_f32_bf16 v11, v240, v240, v11
    v_dot2_f32_bf16 v11, v241, v241, v11
    v_dot2_f32_bf16 v11, v242, v242, v11
    v_dot2_f32_bf16 v11, v243, v243, v11
    ds_read_b128 v[252:255], v7 offset:15360
    v_pk_fma_f32 v[16:17], v[52:53], v[52:53], s[34:35]
    v_pk_fma_f32 v[18:19], v[54:55], v[54:55], s[34:35]
    v_pk_fma_f32 v[20:21], v[56:57], v[56:57], s[34:35]
    v_pk_fma_f32 v[22:23], v[58:59], v[58:59], s[34:35]
    v_pk_mul_f32 v[16:17], v[16:17], v[52:53]
    v_pk_mul_f32 v[18:19], v[18:19], v[54:55]
    v_pk_mul_f32 v[20:21], v[20:21], v[56:57]
    v_pk_mul_f32 v[22:23], v[22:23], v[58:59]
    v_cvt_f64_f32 v[12:13], v11
    s_waitcnt lgkmcnt(1)
    v_mfma_f32_32x32x16_bf16 v[36:51], v[68:71], v[24:27], 0
    v_exp_f32 v16, v16
    v_exp_f32 v17, v17
    v_exp_f32_e64 v18, v18
    v_mfma_f32_32x32x16_bf16 v[36:51], v[72:75], v[28:31], v[36:51]
    v_exp_f32 v19, v19
    v_exp_f32 v20, v20
    v_exp_f32 v21, v21
    v_exp_f32 v22, v22
    v_exp_f32_e64 v23, v23
    v_pk_add_f32 v[16:17], v[16:17], 1.0 op_sel_hi:[1,0]
    v_pk_add_f32 v[20:21], v[20:21], 1.0 op_sel_hi:[1,0]
    v_pk_fma_f32 v[52:53], v[52:53], v[18:19], v[52:53]
    v_pk_fma_f32 v[56:57], v[56:57], v[22:23], v[56:57]
    v_pk_fma_f32 v[18:19], v[16:17], v[18:19], v[16:17]
    v_pk_fma_f32 v[22:23], v[20:21], v[22:23], v[20:21]
    v_pk_mul_f32 v[54:55], v[54:55], v[16:17]
    v_pk_mul_f32 v[58:59], v[58:59], v[20:21]
    ds_read_b128 v[24:27], v7 offset:16384
    ds_read_b128 v[28:31], v7 offset:17408
    ds_add_f64 v8, v[12:13] offset:1536
    v_mfma_f32_32x32x16_bf16 v[36:51], v[76:79], v[32:35], v[36:51]
    v_rcp_f32 v18, v18
    v_rcp_f32 v19, v19
    v_rcp_f32 v22, v22
    v_rcp_f32 v23, v23
    v_pk_mul_f32 v[52:53], v[52:53], v[18:19]
    v_pk_mul_f32 v[54:55], v[54:55], v[18:19]
    v_pk_mul_f32 v[56:57], v[56:57], v[22:23]
    v_pk_mul_f32 v[58:59], v[58:59], v[22:23]
    v_pk_fma_f32 v[16:17], v[60:61], v[60:61], s[34:35]
    v_pk_fma_f32 v[18:19], v[62:63], v[62:63], s[34:35]
    v_pk_fma_f32 v[20:21], v[64:65], v[64:65], s[34:35]
    v_pk_fma_f32 v[22:23], v[66:67], v[66:67], s[34:35]
    v_pk_mul_f32 v[16:17], v[16:17], v[60:61]
    v_pk_mul_f32 v[18:19], v[18:19], v[62:63]
    v_pk_mul_f32 v[20:21], v[20:21], v[64:65]
    v_pk_mul_f32 v[22:23], v[22:23], v[66:67]
    s_waitcnt lgkmcnt(1)
    ds_read_b128 v[32:35], v7 offset:18432
    v_mfma_f32_32x32x16_bf16 v[36:51], v[80:83], v[252:255], v[36:51]
    v_exp_f32 v16, v16
    v_exp_f32 v17, v17
    v_exp_f32 v18, v18
    v_mfma_f32_32x32x16_bf16 v[36:51], v[84:87], v[24:27], v[36:51]
    v_exp_f32 v19, v19
    v_exp_f32 v20, v20
    v_exp_f32 v21, v21
    v_exp_f32 v22, v22
    v_exp_f32_e64 v23, v23
    v_pk_add_f32 v[16:17], v[16:17], 1.0 op_sel_hi:[1,0]
    v_pk_add_f32 v[20:21], v[20:21], 1.0 op_sel_hi:[1,0]
    v_pk_fma_f32 v[60:61], v[60:61], v[18:19], v[60:61]
    v_pk_fma_f32 v[64:65], v[64:65], v[22:23], v[64:65]
    v_pk_fma_f32 v[18:19], v[16:17], v[18:19], v[16:17]
    v_pk_fma_f32 v[22:23], v[20:21], v[22:23], v[20:21]
    v_pk_mul_f32 v[62:63], v[62:63], v[16:17]
    v_pk_mul_f32 v[66:67], v[66:67], v[20:21]
    ds_read_b128 v[252:255], v7 offset:19456
    ds_read_b128 v[24:27], v7 offset:20480
    v_mfma_f32_32x32x16_bf16 v[36:51], v[88:91], v[28:31], v[36:51]
    v_rcp_f32 v18, v18
    v_rcp_f32 v19, v19
    v_rcp_f32 v22, v22
    v_rcp_f32 v23, v23
    v_cvt_pk_bf16_f32 v244, v52, v53
    v_cvt_pk_bf16_f32 v245, v54, v55
    v_cvt_pk_bf16_f32 v246, v56, v57
    v_cvt_pk_bf16_f32 v247, v58, v59
    v_pk_mul_f32 v[60:61], v[60:61], v[18:19]
    v_pk_mul_f32 v[62:63], v[62:63], v[18:19]
    v_pk_mul_f32 v[64:65], v[64:65], v[22:23]
    v_pk_mul_f32 v[66:67], v[66:67], v[22:23]
    v_cvt_pk_bf16_f32 v248, v60, v61
    v_cvt_pk_bf16_f32 v249, v62, v63
    v_cvt_pk_bf16_f32 v250, v64, v65
    v_cvt_pk_bf16_f32 v251, v66, v67
    v_dot2_f32_bf16 v11, v244, v244, 0
    v_dot2_f32_bf16 v11, v245, v245, v11
    v_dot2_f32_bf16 v11, v246, v246, v11
    v_dot2_f32_bf16 v11, v247, v247, v11
    v_dot2_f32_bf16 v11, v248, v248, v11
    v_dot2_f32_bf16 v11, v249, v249, v11
    v_dot2_f32_bf16 v11, v250, v250, v11
    v_dot2_f32_bf16 v11, v251, v251, v11
    ds_read_b128 v[28:31], v7 offset:21504
    v_mov_b32_e64 v10, 0
    s_mov_b32 s10, 0
    s_waitcnt vmcnt(0)
    v_readfirstlane_b32 s9, v2
    s_nop 0
    s_cmp_ge_u32 s9, 8
    s_cbranch_scc1 L_init1_done
L_init1_loop:
    global_load_dword v12, v10, s[30:31] offset:0 sc1
    s_waitcnt vmcnt(0)
    v_readfirstlane_b32 s9, v12
    s_nop 0
    s_cmp_ge_u32 s9, 8
    s_cbranch_scc1 L_init1_done
    s_sleep 1
    s_add_u32 s10, s10, 1
    s_cmp_lt_u32 s10, 0x40000
    s_cbranch_scc1 L_init1_loop
L_init1_done:
    s_nop 4
    v_mov_b32 v14, 163536
    s_mov_b32 s10, 0
L_aw31:
    ds_read_b32 v15, v14 offset:52
    s_add_u32 s10, s10, 1
    s_waitcnt lgkmcnt(0)
    v_readfirstlane_b32 s9, v15
    s_lshr_b32 s55, s10, 22
    s_lshl_b32 s55, s55, 3
    s_or_b32 s9, s9, s55
    s_cmp_lt_u32 s9, 8
    s_cbranch_scc1 L_aw31
    s_cmp_lg_u32 s69, 0
    s_cbranch_scc1 L_skip32
    v_mov_b32 v16, 0
    v_mov_b32 v17, 0
    v_mov_b32 v18, 0
    v_mov_b32 v19, 0
    v_min_u32_e64 v12, 59, v1
    s_mul_i32 s9, s62, 960
    s_add_u32 s9, s9, 155648
    v_lshl_add_u32 v12, v12, 4, s9
    ds_write_b128 v12, v[16:19]
    v_bfe_u32 v12, v1, 3, 2
    v_and_b32 v13, 3, v1
    v_xor_b32 v12, v12, v13
    v_and_b32 v13, 1, v12
    v_lshlrev_b32 v9, 10, v13
    v_lshrrev_b32_e64 v12, 1, v12
    v_lshl_add_u32 v9, v12, 9, v9
    v_lshrrev_b32_e64 v12, 2, v1
    v_lshl_add_u32 v9, v12, 4, v9
    s_mul_i32 s15, s62, 12288
    s_add_u32 s15, s15, 73728
L_skip32:
    s_cmp_lg_u32 s69, 0
    s_cbranch_scc1 L_skip33
    s_add_u32 m0, s15, 0
    s_add_u32 s9, s63, 0
    s_nop 0
    s_nop 0
    buffer_load_dwordx4 v9, s[40:43], s9 offen nt lds
    s_add_u32 m0, s15, 1024
    s_add_u32 s9, s63, 256
    buffer_load_dwordx4 v9, s[40:43], s9 offen nt lds
    s_add_u32 m0, s15, 2048
    s_add_u32 s9, s63, 2048
    buffer_load_dwordx4 v9, s[40:43], s9 offen nt lds
L_skip33:
    v_pk_fma_f32 v[16:17], v[36:37], v[36:37], s[34:35]
    v_pk_fma_f32 v[18:19], v[38:39], v[38:39], s[34:35]
    v_pk_fma_f32 v[20:21], v[40:41], v[40:41], s[34:35]
    v_pk_fma_f32 v[22:23], v[42:43], v[42:43], s[34:35]
    v_pk_mul_f32 v[16:17], v[16:17], v[36:37]
    v_pk_mul_f32 v[18:19], v[18:19], v[38:39]
    v_pk_mul_f32 v[20:21], v[20:21], v[40:41]
    v_pk_mul_f32 v[22:23], v[22:23], v[42:43]
    s_setprio 1
    v_cvt_f64_f32 v[12:13], v11
    v_mfma_f32_32x32x16_bf16 v[52:67], v[68:71], v[32:35], 0
    v_exp_f32 v16, v16
    v_exp_f32 v17, v17
    v_exp_f32_e64 v18, v18
    v_mfma_f32_32x32x16_bf16 v[52:67], v[72:75], v[252:255], v[52:67]
    v_exp_f32 v19, v19
    v_exp_f32 v20, v20
    v_exp_f32 v21, v21
    v_exp_f32 v22, v22
    v_exp_f32_e64 v23, v23
    v_pk_add_f32 v[16:17], v[16:17], 1.0 op_sel_hi:[1,0]
    v_pk_add_f32 v[20:21], v[20:21], 1.0 op_sel_hi:[1,0]
    v_pk_fma_f32 v[36:37], v[36:37], v[18:19], v[36:37]
    v_pk_fma_f32 v[40:41], v[40:41], v[22:23], v[40:41]
    v_pk_fma_f32 v[18:19], v[16:17], v[18:19], v[16:17]
    v_pk_fma_f32 v[22:23], v[20:21], v[22:23], v[20:21]
    v_pk_mul_f32 v[38:39], v[38:39], v[16:17]
    v_pk_mul_f32 v[42:43], v[42:43], v[20:21]
    ds_read_b128 v[32:35], v7 offset:22528
    ds_read_b128 v[252:255], v7 offset:23552
    ds_add_f64 v8, v[12:13] offset:1792
    v_mfma_f32_32x32x16_bf16 v[52:67], v[76:79], v[24:27], v[52:67]
    v_rcp_f32 v18, v18
    v_rcp_f32 v19, v19
    v_rcp_f32 v22, v22
    v_rcp_f32 v23, v23
    v_pk_mul_f32 v[36:37], v[36:37], v[18:19]
    v_pk_mul_f32 v[38:39], v[38:39], v[18:19]
    v_pk_mul_f32 v[40:41], v[40:41], v[22:23]
    v_pk_mul_f32 v[42:43], v[42:43], v[22:23]
    v_pk_fma_f32 v[16:17], v[44:45], v[44:45], s[34:35]
    v_pk_fma_f32 v[18:19], v[46:47], v[46:47], s[34:35]
    v_pk_fma_f32 v[20:21], v[48:49], v[48:49], s[34:35]
    v_pk_fma_f32 v[22:23], v[50:51], v[50:51], s[34:35]
    v_pk_mul_f32 v[16:17], v[16:17], v[44:45]
    v_pk_mul_f32 v[18:19], v[18:19], v[46:47]
    v_pk_mul_f32 v[20:21], v[20:21], v[48:49]
    v_pk_mul_f32 v[22:23], v[22:23], v[50:51]
    s_waitcnt lgkmcnt(1)
    ds_read_b128 v[24:27], v7 offset:24576
    v_mfma_f32_32x32x16_bf16 v[52:67], v[80:83], v[28:31], v[52:67]
    v_exp_f32 v16, v16
    v_exp_f32 v17, v17
    v_exp_f32 v18, v18
    v_mfma_f32_32x32x16_bf16 v[52:67], v[84:87], v[32:35], v[52:67]
    v_exp_f32 v19, v19
    v_exp_f32 v20, v20
    v_exp_f32 v21, v21
    v_exp_f32 v22, v22
    v_exp_f32_e64 v23, v23
    v_pk_add_f32 v[16:17], v[16:17], 1.0 op_sel_hi:[1,0]
    v_pk_add_f32 v[20:21], v[20:21], 1.0 op_sel_hi:[1,0]
    v_pk_fma_f32 v[44:45], v[44:45], v[18:19], v[44:45]
    v_pk_fma_f32 v[48:49], v[48:49], v[22:23], v[48:49]
    v_pk_fma_f32 v[18:19], v[16:17], v[18:19], v[16:17]
    v_pk_fma_f32 v[22:23], v[20:21], v[22:23], v[20:21]
    v_pk_mul_f32 v[46:47], v[46:47], v[16:17]
    v_pk_mul_f32 v[50:51], v[50:51], v[20:21]
    ds_read_b128 v[28:31], v7 offset:25600
    ds_read_b128 v[32:35], v7 offset:26624
    v_mfma_f32_32x32x16_bf16 v[52:67], v[88:91], v[252:255], v[52:67]
    v_rcp_f32 v18, v18
    v_rcp_f32 v19, v19
    v_rcp_f32 v22, v22
    v_rcp_f32 v23, v23
    v_cvt_pk_bf16_f32 v36, v36, v37
    v_cvt_pk_bf16_f32 v37, v38, v39
    v_cvt_pk_bf16_f32 v38, v40, v41
    v_cvt_pk_bf16_f32 v39, v42, v43
    v_pk_mul_f32 v[44:45], v[44:45], v[18:19]
    v_pk_mul_f32 v[46:47], v[46:47], v[18:19]
    v_pk_mul_f32 v[48:49], v[48:49], v[22:23]
    v_pk_mul_f32 v[50:51], v[50:51], v[22:23]
    v_cvt_pk_bf16_f32 v40, v44, v45
    v_cvt_pk_bf16_f32 v41, v46, v47
    v_cvt_pk_bf16_f32 v42, v48, v49
    v_cvt_pk_bf16_f32 v43, v50, v51
    v_dot2_f32_bf16 v11, v36, v36, 0
    v_dot2_f32_bf16 v11, v37, v37, v11
    v_dot2_f32_bf16 v11, v38, v38, v11
    v_dot2_f32_bf16 v11, v39, v39, v11
    v_dot2_f32_bf16 v11, v40, v40, v11
    v_dot2_f32_bf16 v11, v41, v41, v11
    v_dot2_f32_bf16 v11, v42, v42, v11
    v_dot2_f32_bf16 v11, v43, v43, v11
    ds_read_b128 v[252:255], v7 offset:27648
    s_cmp_lg_u32 s69, 0
    s_cbranch_scc1 L_skip34
    s_add_u32 m0, s15, 3072
    s_add_u32 s9, s63, 2304
    buffer_load_dwordx4 v9, s[40:43], s9 offen nt lds
    s_add_u32 m0, s15, 4096
    s_add_u32 s9, s63, 4096
    buffer_load_dwordx4 v9, s[40:43], s9 offen nt lds
    s_add_u32 m0, s15, 5120
    s_add_u32 s9, s63, 4352
    buffer_load_dwordx4 v9, s[40:43], s9 offen nt lds
L_skip34:
    ds_write_b128 v3, v[36:39] offset:0
    ds_write_b128 v4, v[40:43] offset:0
    v_pk_fma_f32 v[16:17], v[52:53], v[52:53], s[34:35]
    v_pk_fma_f32 v[18:19], v[54:55], v[54:55], s[34:35]
    v_pk_fma_f32 v[20:21], v[56:57], v[56:57], s[34:35]
    v_pk_fma_f32 v[22:23], v[58:59], v[58:59], s[34:35]
    v_pk_mul_f32 v[16:17], v[16:17], v[52:53]
    v_pk_mul_f32 v[18:19], v[18:19], v[54:55]
    v_pk_mul_f32 v[20:21], v[20:21], v[56:57]
    v_pk_mul_f32 v[22:23], v[22:23], v[58:59]
    v_cvt_f64_f32 v[12:13], v11
    s_waitcnt lgkmcnt(3)
    v_mfma_f32_32x32x16_bf16 v[36:51], v[68:71], v[24:27], 0
    v_exp_f32 v16, v16
    v_exp_f32 v17, v17
    v_exp_f32_e64 v18, v18
    v_mfma_f32_32x32x16_bf16 v[36:51], v[72:75], v[28:31], v[36:51]
    v_exp_f32 v19, v19
    v_exp_f32 v20, v20
    v_exp_f32 v21, v21
    v_exp_f32 v22, v22
    v_exp_f32_e64 v23, v23
    v_pk_add_f32 v[16:17], v[16:17], 1.0 op_sel_hi:[1,0]
    v_pk_add_f32 v[20:21], v[20:21], 1.0 op_sel_hi:[1,0]
    v_pk_fma_f32 v[52:53], v[52:53], v[18:19], v[52:53]
    v_pk_fma_f32 v[56:57], v[56:57], v[22:23], v[56:57]
    v_pk_fma_f32 v[18:19], v[16:17], v[18:19], v[16:17]
    v_pk_fma_f32 v[22:23], v[20:21], v[22:23], v[20:21]
    v_pk_mul_f32 v[54:55], v[54:55], v[16:17]
    v_pk_mul_f32 v[58:59], v[58:59], v[20:21]
    ds_read_b128 v[24:27], v7 offset:28672
    ds_read_b128 v[28:31], v7 offset:29696
    ds_add_f64 v8, v[12:13] offset:2048
    v_mfma_f32_32x32x16_bf16 v[36:51], v[76:79], v[32:35], v[36:51]
    v_rcp_f32 v18, v18
    v_rcp_f32 v19, v19
    v_rcp_f32 v22, v22
    v_rcp_f32 v23, v23
    v_pk_mul_f32 v[52:53], v[52:53], v[18:19]
    v_pk_mul_f32 v[54:55], v[54:55], v[18:19]
    v_pk_mul_f32 v[56:57], v[56:57], v[22:23]
    v_pk_mul_f32 v[58:59], v[58:59], v[22:23]
    v_pk_fma_f32 v[16:17], v[60:61], v[60:61], s[34:35]
    v_pk_fma_f32 v[18:19], v[62:63], v[62:63], s[34:35]
    v_pk_fma_f32 v[20:21], v[64:65], v[64:65], s[34:35]
    v_pk_fma_f32 v[22:23], v[66:67], v[66:67], s[34:35]
    v_pk_mul_f32 v[16:17], v[16:17], v[60:61]
    v_pk_mul_f32 v[18:19], v[18:19], v[62:63]
    v_pk_mul_f32 v[20:21], v[20:21], v[64:65]
    v_pk_mul_f32 v[22:23], v[22:23], v[66:67]
    s_waitcnt lgkmcnt(1)
    ds_read_b128 v[32:35], v7 offset:30720
    v_mfma_f32_32x32x16_bf16 v[36:51], v[80:83], v[252:255], v[36:51]
    v_exp_f32 v16, v16
    v_exp_f32 v17, v17
    v_exp_f32 v18, v18
    v_mfma_f32_32x32x16_bf16 v[36:51], v[84:87], v[24:27], v[36:51]
    v_exp_f32 v19, v19
    v_exp_f32 v20, v20
    v_exp_f32 v21, v21
    v_exp_f32 v22, v22
    v_exp_f32_e64 v23, v23
    v_pk_add_f32 v[16:17], v[16:17], 1.0 op_sel_hi:[1,0]
    v_pk_add_f32 v[20:21], v[20:21], 1.0 op_sel_hi:[1,0]
    v_pk_fma_f32 v[60:61], v[60:61], v[18:19], v[60:61]
    v_pk_fma_f32 v[64:65], v[64:65], v[22:23], v[64:65]
    v_pk_fma_f32 v[18:19], v[16:17], v[18:19], v[16:17]
    v_pk_fma_f32 v[22:23], v[20:21], v[22:23], v[20:21]
    v_pk_mul_f32 v[62:63], v[62:63], v[16:17]
    v_pk_mul_f32 v[66:67], v[66:67], v[20:21]
    ds_read_b128 v[252:255], v7 offset:31744
    ds_read_b128 v[24:27], v7 offset:32768
    v_mfma_f32_32x32x16_bf16 v[36:51], v[88:91], v[28:31], v[36:51]
    v_rcp_f32 v18, v18
    v_rcp_f32 v19, v19
    v_rcp_f32 v22, v22
    v_rcp_f32 v23, v23
    v_cvt_pk_bf16_f32 v52, v52, v53
    v_cvt_pk_bf16_f32 v53, v54, v55
    v_cvt_pk_bf16_f32 v54, v56, v57
    v_cvt_pk_bf16_f32 v55, v58, v59
    v_pk_mul_f32 v[60:61], v[60:61], v[18:19]
    v_pk_mul_f32 v[62:63], v[62:63], v[18:19]
    v_pk_mul_f32 v[64:65], v[64:65], v[22:23]
    v_pk_mul_f32 v[66:67], v[66:67], v[22:23]
    v_cvt_pk_bf16_f32 v56, v60, v61
    v_cvt_pk_bf16_f32 v57, v62, v63
    v_cvt_pk_bf16_f32 v58, v64, v65
    v_cvt_pk_bf16_f32 v59, v66, v67
    v_dot2_f32_bf16 v11, v52, v52, 0
    v_dot2_f32_bf16 v11, v53, v53, v11
    v_dot2_f32_bf16 v11, v54, v54, v11
    v_dot2_f32_bf16 v11, v55, v55, v11
    v_dot2_f32_bf16 v11, v56, v56, v11
    v_dot2_f32_bf16 v11, v57, v57, v11
    v_dot2_f32_bf16 v11, v58, v58, v11
    v_dot2_f32_bf16 v11, v59, v59, v11
    ds_read_b128 v[28:31], v7 offset:33792
    s_cmp_lg_u32 s69, 0
    s_cbranch_scc1 L_skip35
    s_add_u32 m0, s15, 6144
    s_add_u32 s9, s63, 6144
    buffer_load_dwordx4 v9, s[40:43], s9 offen nt lds
    s_add_u32 m0, s15, 7168
    s_add_u32 s9, s63, 6400
    buffer_load_dwordx4 v9, s[40:43], s9 offen nt lds
    s_add_u32 m0, s15, 8192
    s_add_u32 s9, s63, 8192
    buffer_load_dwordx4 v9, s[40:43], s9 offen nt lds
L_skip35:
    ds_write_b128 v3, v[52:55] offset:2048
    ds_write_b128 v4, v[56:59] offset:2048
    v_pk_fma_f32 v[16:17], v[36:37], v[36:37], s[34:35]
    v_pk_fma_f32 v[18:19], v[38:39], v[38:39], s[34:35]
    v_pk_fma_f32 v[20:21], v[40:41], v[40:41], s[34:35]
    v_pk_fma_f32 v[22:23], v[42:43], v[42:43], s[34:35]
    v_pk_mul_f32 v[16:17], v[16:17], v[36:37]
    v_pk_mul_f32 v[18:19], v[18:19], v[38:39]
    v_pk_mul_f32 v[20:21], v[20:21], v[40:41]
    v_pk_mul_f32 v[22:23], v[22:23], v[42:43]
    v_cvt_f64_f32 v[12:13], v11
    s_waitcnt lgkmcnt(3)
    v_mfma_f32_32x32x16_bf16 v[52:67], v[68:71], v[32:35], 0
    v_exp_f32 v16, v16
    v_exp_f32 v17, v17
    v_exp_f32_e64 v18, v18
    v_mfma_f32_32x32x16_bf16 v[52:67], v[72:75], v[252:255], v[52:67]
    v_exp_f32 v19, v19
    v_exp_f32 v20, v20
    v_exp_f32 v21, v21
    v_exp_f32 v22, v22
    v_exp_f32_e64 v23, v23
    v_pk_add_f32 v[16:17], v[16:17], 1.0 op_sel_hi:[1,0]
    v_pk_add_f32 v[20:21], v[20:21], 1.0 op_sel_hi:[1,0]
    v_pk_fma_f32 v[36:37], v[36:37], v[18:19], v[36:37]
    v_pk_fma_f32 v[40:41], v[40:41], v[22:23], v[40:41]
    v_pk_fma_f32 v[18:19], v[16:17], v[18:19], v[16:17]
    v_pk_fma_f32 v[22:23], v[20:21], v[22:23], v[20:21]
    v_pk_mul_f32 v[38:39], v[38:39], v[16:17]
    v_pk_mul_f32 v[42:43], v[42:43], v[20:21]
    ds_read_b128 v[32:35], v7 offset:34816
    ds_read_b128 v[252:255], v7 offset:35840
    ds_add_f64 v8, v[12:13] offset:2304
    v_mfma_f32_32x32x16_bf16 v[52:67], v[76:79], v[24:27], v[52:67]
    v_rcp_f32 v18, v18
    v_rcp_f32 v19, v19
    v_rcp_f32 v22, v22
    v_rcp_f32 v23, v23
    v_pk_mul_f32 v[36:37], v[36:37], v[18:19]
    v_pk_mul_f32 v[38:39], v[38:39], v[18:19]
    v_pk_mul_f32 v[40:41], v[40:41], v[22:23]
    v_pk_mul_f32 v[42:43], v[42:43], v[22:23]
    v_pk_fma_f32 v[16:17], v[44:45], v[44:45], s[34:35]
    v_pk_fma_f32 v[18:19], v[46:47], v[46:47], s[34:35]
    v_pk_fma_f32 v[20:21], v[48:49], v[48:49], s[34:35]
    v_pk_fma_f32 v[22:23], v[50:51], v[50:51], s[34:35]
    v_pk_mul_f32 v[16:17], v[16:17], v[44:45]
    v_pk_mul_f32 v[18:19], v[18:19], v[46:47]
    v_pk_mul_f32 v[20:21], v[20:21], v[48:49]
    v_pk_mul_f32 v[22:23], v[22:23], v[50:51]
    s_waitcnt lgkmcnt(1)
    v_mfma_f32_32x32x16_bf16 v[52:67], v[80:83], v[28:31], v[52:67]
    v_exp_f32 v16, v16
    v_exp_f32 v17, v17
    v_exp_f32 v18, v18
    v_mfma_f32_32x32x16_bf16 v[52:67], v[84:87], v[32:35], v[52:67]
    v_exp_f32 v19, v19
    v_exp_f32 v20, v20
    v_exp_f32 v21, v21
    v_exp_f32 v22, v22
    v_exp_f32_e64 v23, v23
    v_pk_add_f32 v[16:17], v[16:17], 1.0 op_sel_hi:[1,0]
    v_pk_add_f32 v[20:21], v[20:21], 1.0 op_sel_hi:[1,0]
    v_pk_fma_f32 v[44:45], v[44:45], v[18:19], v[44:45]
    v_pk_fma_f32 v[48:49], v[48:49], v[22:23], v[48:49]
    v_pk_fma_f32 v[18:19], v[16:17], v[18:19], v[16:17]
    v_pk_fma_f32 v[22:23], v[20:21], v[22:23], v[20:21]
    v_pk_mul_f32 v[46:47], v[46:47], v[16:17]
    v_pk_mul_f32 v[50:51], v[50:51], v[20:21]
    v_mfma_f32_32x32x16_bf16 v[52:67], v[88:91], v[252:255], v[52:67]
    v_rcp_f32 v18, v18
    v_rcp_f32 v19, v19
    v_rcp_f32 v22, v22
    v_rcp_f32 v23, v23
    v_cvt_pk_bf16_f32 v36, v36, v37
    v_cvt_pk_bf16_f32 v37, v38, v39
    v_cvt_pk_bf16_f32 v38, v40, v41
    v_cvt_pk_bf16_f32 v39, v42, v43
    v_pk_mul_f32 v[44:45], v[44:45], v[18:19]
    v_pk_mul_f32 v[46:47], v[46:47], v[18:19]
    v_pk_mul_f32 v[48:49], v[48:49], v[22:23]
    v_pk_mul_f32 v[50:51], v[50:51], v[22:23]
    v_cvt_pk_bf16_f32 v40, v44, v45
    v_cvt_pk_bf16_f32 v41, v46, v47
    v_cvt_pk_bf16_f32 v42, v48, v49
    v_cvt_pk_bf16_f32 v43, v50, v51
    v_dot2_f32_bf16 v11, v36, v36, 0
    v_dot2_f32_bf16 v11, v37, v37, v11
    v_dot2_f32_bf16 v11, v38, v38, v11
    v_dot2_f32_bf16 v11, v39, v39, v11
    v_dot2_f32_bf16 v11, v40, v40, v11
    v_dot2_f32_bf16 v11, v41, v41, v11
    v_dot2_f32_bf16 v11, v42, v42, v11
    v_dot2_f32_bf16 v11, v43, v43, v11
    s_cmp_lg_u32 s69, 0
    s_cbranch_scc1 L_skip36
    s_add_u32 m0, s15, 9216
    s_add_u32 s9, s63, 8448
    buffer_load_dwordx4 v9, s[40:43], s9 offen nt lds
    s_add_u32 m0, s15, 10240
    s_add_u32 s9, s63, 10240
    buffer_load_dwordx4 v9, s[40:43], s9 offen nt lds
    s_add_u32 m0, s15, 11264
    s_add_u32 s9, s63, 10496
    buffer_load_dwordx4 v9, s[40:43], s9 offen nt lds
L_skip36:
    v_lshrrev_b32 v14, 5, v1
    v_lshlrev_b32 v14, 3, v14
    s_mul_i32 s9, s3, 96
    v_add_u32_e64 v14, s9, v14
    global_load_dwordx2 v[24:25], v14, s[26:27] offset:0
    global_load_dwordx2 v[26:27], v14, s[26:27] offset:16
    global_load_dwordx2 v[28:29], v14, s[26:27] offset:32
    global_load_dwordx2 v[30:31], v14, s[26:27] offset:48
    global_load_dwordx2 v[32:33], v14, s[26:27] offset:64
    global_load_dwordx2 v[34:35], v14, s[26:27] offset:80
    v_lshlrev_b32_e64 v15, 2, v1
    global_load_dword v252, v15, s[24:25] offset:0
    global_load_dword v253, v15, s[24:25] offset:256
    global_load_dword v254, v15, s[24:25] offset:512
    v_pk_fma_f32 v[16:17], v[52:53], v[52:53], s[34:35]
    v_pk_fma_f32 v[18:19], v[54:55], v[54:55], s[34:35]
    v_pk_fma_f32 v[20:21], v[56:57], v[56:57], s[34:35]
    v_pk_fma_f32 v[22:23], v[58:59], v[58:59], s[34:35]
    v_pk_mul_f32 v[16:17], v[16:17], v[52:53]
    v_pk_mul_f32 v[18:19], v[18:19], v[54:55]
    v_pk_mul_f32 v[20:21], v[20:21], v[56:57]
    v_pk_mul_f32 v[22:23], v[22:23], v[58:59]
    s_setprio 0
    v_cvt_f64_f32 v[12:13], v11
    v_exp_f32 v16, v16
    v_exp_f32 v17, v17
    v_exp_f32 v18, v18
    v_exp_f32 v19, v19
    v_exp_f32 v20, v20
    v_exp_f32 v21, v21
    v_exp_f32 v22, v22
    v_exp_f32 v23, v23
    v_pk_add_f32 v[16:17], v[16:17], 1.0 op_sel_hi:[1,0]
    v_pk_add_f32 v[20:21], v[20:21], 1.0 op_sel_hi:[1,0]
    v_pk_fma_f32 v[52:53], v[52:53], v[18:19], v[52:53]
    v_pk_fma_f32 v[56:57], v[56:57], v[22:23], v[56:57]
    v_pk_fma_f32 v[18:19], v[16:17], v[18:19], v[16:17]
    v_pk_fma_f32 v[22:23], v[20:21], v[22:23], v[20:21]
    v_pk_mul_f32 v[54:55], v[54:55], v[16:17]
    v_pk_mul_f32 v[58:59], v[58:59], v[20:21]
    ds_add_f64 v8, v[12:13] offset:2560
    v_rcp_f32 v18, v18
    v_rcp_f32 v19, v19
    v_rcp_f32 v22, v22
    v_rcp_f32 v23, v23
    v_pk_mul_f32 v[52:53], v[52:53], v[18:19]
    v_pk_mul_f32 v[54:55], v[54:55], v[18:19]
    v_pk_mul_f32 v[56:57], v[56:57], v[22:23]
    v_pk_mul_f32 v[58:59], v[58:59], v[22:23]
    v_pk_fma_f32 v[16:17], v[60:61], v[60:61], s[34:35]
    v_pk_fma_f32 v[18:19], v[62:63], v[62:63], s[34:35]
    v_pk_fma_f32 v[20:21], v[64:65], v[64:65], s[34:35]
    v_pk_fma_f32 v[22:23], v[66:67], v[66:67], s[34:35]
    v_pk_mul_f32 v[16:17], v[16:17], v[60:61]
    v_pk_mul_f32 v[18:19], v[18:19], v[62:63]
    v_pk_mul_f32 v[20:21], v[20:21], v[64:65]
    v_pk_mul_f32 v[22:23], v[22:23], v[66:67]
    v_exp_f32 v16, v16
    v_exp_f32 v17, v17
    v_exp_f32 v18, v18
    v_exp_f32 v19, v19
    v_exp_f32 v20, v20
    v_exp_f32 v21, v21
    v_exp_f32 v22, v22
    v_exp_f32 v23, v23
    v_pk_add_f32 v[16:17], v[16:17], 1.0 op_sel_hi:[1,0]
    v_pk_add_f32 v[20:21], v[20:21], 1.0 op_sel_hi:[1,0]
    v_pk_fma_f32 v[60:61], v[60:61], v[18:19], v[60:61]
    v_pk_fma_f32 v[64:65], v[64:65], v[22:23], v[64:65]
    v_pk_fma_f32 v[18:19], v[16:17], v[18:19], v[16:17]
    v_pk_fma_f32 v[22:23], v[20:21], v[22:23], v[20:21]
    v_pk_mul_f32 v[62:63], v[62:63], v[16:17]
    v_pk_mul_f32 v[66:67], v[66:67], v[20:21]
    v_rcp_f32 v18, v18
    v_rcp_f32 v19, v19
    v_rcp_f32 v22, v22
    v_rcp_f32 v23, v23
    v_cvt_pk_bf16_f32 v44, v52, v53
    v_cvt_pk_bf16_f32 v45, v54, v55
    v_cvt_pk_bf16_f32 v46, v56, v57
    v_cvt_pk_bf16_f32 v47, v58, v59
    v_pk_mul_f32 v[60:61], v[60:61], v[18:19]
    v_pk_mul_f32 v[62:63], v[62:63], v[18:19]
    v_pk_mul_f32 v[64:65], v[64:65], v[22:23]
    v_pk_mul_f32 v[66:67], v[66:67], v[22:23]
    v_cvt_pk_bf16_f32 v48, v60, v61
    v_cvt_pk_bf16_f32 v49, v62, v63
    v_cvt_pk_bf16_f32 v50, v64, v65
    v_cvt_pk_bf16_f32 v51, v66, v67
    v_dot2_f32_bf16 v11, v44, v44, 0
    v_dot2_f32_bf16 v11, v45, v45, v11
    v_dot2_f32_bf16 v11, v46, v46, v11
    v_dot2_f32_bf16 v11, v47, v47, v11
    v_dot2_f32_bf16 v11, v48, v48, v11
    v_dot2_f32_bf16 v11, v49, v49, v11
    v_dot2_f32_bf16 v11, v50, v50, v11
    v_dot2_f32_bf16 v11, v51, v51, v11
    s_nop 2
    v_cvt_f64_f32 v[12:13], v11
    ds_add_f64 v8, v[12:13] offset:2816
    s_waitcnt lgkmcnt(0)
L_streams_done:
    s_nop 3
    s_waitcnt lgkmcnt(0)
    s_barrier
    v_mov_b32 v14, 163520
    ds_read_b128 v[20:23], v14
    s_lshl_b32 s12, s3, 9
    v_lshl_add_u32 v15, v1, 3, s12
    v_add_u32 v14, 160064, v15
    ds_read_b64 v[16:17], v14
    v_mov_b32 v10, 0
    s_waitcnt lgkmcnt(1)
    v_add_f32 v20, v20, v21
    v_add_f32 v22, v22, v23
    v_add_f32 v20, v20, v22
    v_mul_f32 v20, 0x48d0c175, v20
    v_max_f32 v0, 0xda24260, v20
    v_rcp_f32 v20, v0
    s_nop 0
    v_cvt_f64_f32 v[18:19], v20
    s_waitcnt lgkmcnt(0)
    v_fma_f64 v[16:17], v[16:17], v[18:19], 1.0
    s_cmp_ge_u32 s3, 6
    s_cbranch_scc1 L_nopub
    global_atomic_add_f64 v15, v[16:17], s[64:65]
L_nopub:
    s_cmp_lg_u32 s3, 6
    s_cbranch_scc1 L_skip62
    s_setprio 3
    v_mov_b32_e64 v16, 1
    s_mov_b64 exec, 1
    global_atomic_add v17, v10, v16, s[64:65] offset:3072 sc0
    s_mov_b64 exec, -1
    s_and_b32 s9, s2, 7
    s_lshl_b32 s9, s9, 2
    s_add_u32 s9, s9, 65536
    v_lshl_add_u32 v18, v1, 7, s9
    s_waitcnt vmcnt(0)
    v_readfirstlane_b32 s9, v17
    s_nop 0
    s_cmp_lg_u32 s9, 31
    s_cbranch_scc1 L_notlast
    global_store_dword v18, v16, s[32:33] sc0 sc1
    v_add_u32 v18, 8192, v18
    global_store_dword v18, v16, s[32:33] sc0 sc1
    v_add_u32 v18, 8192, v18
    global_store_dword v18, v16, s[32:33] sc0 sc1
    v_add_u32 v18, 8192, v18
    global_store_dword v18, v16, s[32:33] sc0 sc1
    v_add_u32 v18, 8192, v18
L_notlast:
    s_setprio 0
L_skip62:
    v_rcp_f32 v0, v20
    v_and_b32 v12, 31, v1
    v_lshrrev_b32 v13, 5, v1
    v_lshlrev_b32 v13, 4, v13
    v_sub_u32 v12, v12, v13
    v_and_b32 v13, 1, v12
    v_lshlrev_b32 v13, 4, v13
    v_mov_b32 v14, 0x3f80
    v_lshlrev_b32 v13, v13, v14
    v_lshrrev_b32 v12, 1, v12
    v_mov_b32_e64 v14, 0
    v_cmp_eq_u32 s[56:57], 0, v12
    v_cmp_eq_u32 s[58:59], 1, v12
    v_cmp_eq_u32 s[60:61], 2, v12
    v_cndmask_b32 v84, v14, v13, s[56:57]
    v_cmp_eq_u32 s[56:57], 3, v12
    v_cndmask_b32 v85, v14, v13, s[58:59]
    v_cmp_eq_u32 s[58:59], 4, v12
    v_cndmask_b32 v86, v14, v13, s[60:61]
    v_cmp_eq_u32 s[60:61], 5, v12
    v_cndmask_b32 v87, v14, v13, s[56:57]
    v_cmp_eq_u32 s[56:57], 6, v12
    v_cndmask_b32 v88, v14, v13, s[58:59]
    v_cmp_eq_u32 s[58:59], 7, v12
    v_cndmask_b32 v89, v14, v13, s[60:61]
    v_cndmask_b32 v90, v14, v13, s[56:57]
    v_cndmask_b32 v91, v14, v13, s[58:59]
    v_mfma_f32_32x32x16_bf16 v[52:67], v[92:95], v[84:87], 0
    s_nop 0
    v_mfma_f32_32x32x16_bf16 v[52:67], v[96:99], v[88:91], v[52:67]
    v_mfma_f32_32x32x16_bf16 v[68:83], v[100:103], v[84:87], 0
    s_add_u32 m0, s14, 0
    s_add_u32 s55, s14, 0
    buffer_load_dwordx4 v6, s[44:47], s55 offen lds
    v_bfe_u32 v12, v1, 3, 1
    v_mul_u32_u24 v2, 73728, v12
    v_and_b32 v12, 3, v1
    v_bfe_u32 v13, v1, 2, 1
    v_lshl_add_u32 v12, v13, 3, v12
    v_bfe_u32 v13, v1, 4, 1
    v_mfma_f32_32x32x16_bf16 v[68:83], v[104:107], v[88:91], v[68:83]
    s_nop 0
    s_nop 0
    v_cvt_pk_bf16_f32 v92, v52, v53
    v_cvt_pk_bf16_f32 v93, v54, v55
    v_cvt_pk_bf16_f32 v94, v56, v57
    v_cvt_pk_bf16_f32 v95, v58, v59
    v_cvt_pk_bf16_f32 v96, v60, v61
    v_cvt_pk_bf16_f32 v97, v62, v63
    v_cvt_pk_bf16_f32 v98, v64, v65
    v_cvt_pk_bf16_f32 v99, v66, v67
    v_mfma_f32_32x32x16_bf16 v[52:67], v[108:111], v[84:87], 0
    s_add_u32 m0, s14, 1024
    s_add_u32 s55, s14, 1024
    buffer_load_dwordx4 v6, s[44:47], s55 offen lds
    v_lshl_add_u32 v12, v13, 2, v12
    v_mul_u32_u24 v12, 192, v12
    v_add_u32 v2, v2, v12
    v_lshrrev_b32 v12, 5, v1
    v_lshl_add_u32 v2, v12, 5, v2
    v_lshlrev_b32_e64 v9, 6, v12
    v_mfma_f32_32x32x16_bf16 v[52:67], v[112:115], v[88:91], v[52:67]
    v_cvt_pk_bf16_f32 v100, v68, v69
    v_cvt_pk_bf16_f32 v101, v70, v71
    v_cvt_pk_bf16_f32 v102, v72, v73
    v_cvt_pk_bf16_f32 v103, v74, v75
    v_cvt_pk_bf16_f32 v104, v76, v77
    v_cvt_pk_bf16_f32 v105, v78, v79
    v_cvt_pk_bf16_f32 v106, v80, v81
    v_cvt_pk_bf16_f32 v107, v82, v83
    v_mfma_f32_32x32x16_bf16 v[68:83], v[116:119], v[84:87], 0
    s_add_u32 m0, s14, 2048
    s_add_u32 s55, s14, 2048
    buffer_load_dwordx4 v6, s[44:47], s55 offen lds
    v_add_u32 v9, 163136, v9
    v_mul_u32_u24 v8, 73728, v12
    v_bfe_u32 v12, v1, 2, 2
    v_bfe_u32 v13, v1, 4, 1
    v_lshl_add_u32 v12, v13, 3, v12
    v_mul_u32_u24 v12, 192, v12
    v_mfma_f32_32x32x16_bf16 v[68:83], v[120:123], v[88:91], v[68:83]
    v_cvt_pk_bf16_f32 v108, v52, v53
    v_cvt_pk_bf16_f32 v109, v54, v55
    v_cvt_pk_bf16_f32 v110, v56, v57
    v_cvt_pk_bf16_f32 v111, v58, v59
    v_cvt_pk_bf16_f32 v112, v60, v61
    v_cvt_pk_bf16_f32 v113, v62, v63
    v_cvt_pk_bf16_f32 v114, v64, v65
    v_cvt_pk_bf16_f32 v115, v66, v67
    v_mfma_f32_32x32x16_bf16 v[52:67], v[124:127], v[84:87], 0
    s_add_u32 m0, s14, 3072
    s_add_u32 s55, s14, 3072
    buffer_load_dwordx4 v6, s[44:47], s55 offen lds
    v_add_u32 v8, v8, v12
    v_and_b32 v12, 3, v1
    v_lshl_add_u32 v8, v12, 4, v8
    v_bfe_u32 v13, v1, 3, 2
    v_xor_b32 v12, v12, v13
    v_lshrrev_b32 v13, 2, v1
    v_mfma_f32_32x32x16_bf16 v[52:67], v[128:131], v[88:91], v[52:67]
    v_cvt_pk_bf16_f32 v116, v68, v69
    v_cvt_pk_bf16_f32 v117, v70, v71
    v_cvt_pk_bf16_f32 v118, v72, v73
    v_cvt_pk_bf16_f32 v119, v74, v75
    v_cvt_pk_bf16_f32 v120, v76, v77
    v_cvt_pk_bf16_f32 v121, v78, v79
    v_cvt_pk_bf16_f32 v122, v80, v81
    v_cvt_pk_bf16_f32 v123, v82, v83
    v_mfma_f32_32x32x16_bf16 v[68:83], v[132:135], v[84:87], 0
    s_add_u32 m0, s14, 4096
    s_add_u32 s55, s14, 4096
    buffer_load_dwordx4 v6, s[44:47], s55 offen lds
    v_lshlrev_b32_e64 v13, 6, v13
    v_lshl_add_u32 v11, v12, 4, v13
    s_lshl_b32 s15, s3, 12
    s_add_u32 s15, s15, 122880
    v_add_u32 v11, s15, v11
    v_lshrrev_b32_e64 v12, 5, v1
    v_mfma_f32_32x32x16_bf16 v[68:83], v[136:139], v[88:91], v[68:83]
    v_cvt_pk_bf16_f32 v124, v52, v53
    v_cvt_pk_bf16_f32 v125, v54, v55
    v_cvt_pk_bf16_f32 v126, v56, v57
    v_cvt_pk_bf16_f32 v127, v58, v59
    v_cvt_pk_bf16_f32 v128, v60, v61
    v_cvt_pk_bf16_f32 v129, v62, v63
    v_cvt_pk_bf16_f32 v130, v64, v65
    v_cvt_pk_bf16_f32 v131, v66, v67
    v_mfma_f32_32x32x16_bf16 v[52:67], v[140:143], v[84:87], 0
    s_add_u32 m0, s14, 5120
    s_add_u32 s55, s14, 5120
    buffer_load_dwordx4 v6, s[44:47], s55 offen lds
    v_bfe_u32 v13, v1, 2, 2
    v_lshl_add_u32 v12, v12, 2, v13
    v_mul_u32_u24 v7, 192, v12
    v_bfe_u32 v13, v12, 1, 2
    v_bfe_u32 v14, v1, 4, 1
    v_lshl_add_u32 v7, v14, 5, v7
    v_mfma_f32_32x32x16_bf16 v[52:67], v[144:147], v[88:91], v[52:67]
    v_cvt_pk_bf16_f32 v132, v68, v69
    v_cvt_pk_bf16_f32 v133, v70, v71
    v_cvt_pk_bf16_f32 v134, v72, v73
    v_cvt_pk_bf16_f32 v135, v74, v75
    v_cvt_pk_bf16_f32 v136, v76, v77
    v_cvt_pk_bf16_f32 v137, v78, v79
    v_cvt_pk_bf16_f32 v138, v80, v81
    v_cvt_pk_bf16_f32 v139, v82, v83
    v_mfma_f32_32x32x16_bf16 v[68:83], v[148:151], v[84:87], 0
    s_add_u32 m0, s14, 6144
    s_add_u32 s55, s14, 6144
    buffer_load_dwordx4 v6, s[44:47], s55 offen lds
    v_bfe_u32 v15, v1, 1, 1
    v_lshl_add_u32 v14, v14, 1, v15
    v_xor_b32 v13, v13, v14
    v_lshlrev_b32 v12, 6, v12
    v_lshl_add_u32 v12, v13, 4, v12
    v_and_b32_e64 v13, 1, v1
    v_mfma_f32_32x32x16_bf16 v[68:83], v[152:155], v[88:91], v[68:83]
    v_cvt_pk_bf16_f32 v140, v52, v53
    v_cvt_pk_bf16_f32 v141, v54, v55
    v_cvt_pk_bf16_f32 v142, v56, v57
    v_cvt_pk_bf16_f32 v143, v58, v59
    v_cvt_pk_bf16_f32 v144, v60, v61
    v_cvt_pk_bf16_f32 v145, v62, v63
    v_cvt_pk_bf16_f32 v146, v64, v65
    v_cvt_pk_bf16_f32 v147, v66, v67
    v_mfma_f32_32x32x16_bf16 v[52:67], v[156:159], v[84:87], 0
    s_add_u32 m0, s14, 7168
    s_add_u32 s55, s14, 7168
    buffer_load_dwordx4 v6, s[44:47], s55 offen lds
    v_lshl_add_u32 v5, v13, 3, v12
    v_add_u32 v10, s15, v5
    v_and_b32 v13, 3, v1
    v_lshl_add_u32 v7, v13, 3, v7
    v_add_u32 v7, s14, v7
    s_min_u32 s9, s3, 5
    v_mfma_f32_32x32x16_bf16 v[52:67], v[160:163], v[88:91], v[52:67]
    v_cvt_pk_bf16_f32 v148, v68, v69
    v_cvt_pk_bf16_f32 v149, v70, v71
    v_cvt_pk_bf16_f32 v150, v72, v73
    v_cvt_pk_bf16_f32 v151, v74, v75
    v_cvt_pk_bf16_f32 v152, v76, v77
    v_cvt_pk_bf16_f32 v153, v78, v79
    v_cvt_pk_bf16_f32 v154, v80, v81
    v_cvt_pk_bf16_f32 v155, v82, v83
    v_mfma_f32_32x32x16_bf16 v[68:83], v[164:167], v[84:87], 0
    s_add_u32 m0, s14, 8192
    s_add_u32 s55, s14, 8192
    buffer_load_dwordx4 v6, s[44:47], s55 offen lds
    s_cmp_ge_u32 s9, 3
    s_cselect_b32 s12, 1, 0
    s_mul_i32 s13, s12, 3
    s_sub_u32 s63, s9, s13
    s_mul_i32 s9, s6, 73728
    s_mul_i32 s10, s5, 6144
    v_mfma_f32_32x32x16_bf16 v[68:83], v[168:171], v[88:91], v[68:83]
    v_cvt_pk_bf16_f32 v156, v52, v53
    v_cvt_pk_bf16_f32 v157, v54, v55
    v_cvt_pk_bf16_f32 v158, v56, v57
    v_cvt_pk_bf16_f32 v159, v58, v59
    v_cvt_pk_bf16_f32 v160, v60, v61
    v_cvt_pk_bf16_f32 v161, v62, v63
    v_cvt_pk_bf16_f32 v162, v64, v65
    v_cvt_pk_bf16_f32 v163, v66, v67
    v_mfma_f32_32x32x16_bf16 v[52:67], v[172:175], v[84:87], 0
    s_add_u32 s9, s9, s10
    s_mul_i32 s10, s12, 3072
    s_add_u32 s9, s9, s10
    s_lshl_b32 s10, s63, 6
    s_add_u32 s54, s9, s10
    s_mul_i32 s9, s12, 24576
    v_mfma_f32_32x32x16_bf16 v[52:67], v[176:179], v[88:91], v[52:67]
    v_cvt_pk_bf16_f32 v164, v68, v69
    v_cvt_pk_bf16_f32 v165, v70, v71
    v_cvt_pk_bf16_f32 v166, v72, v73
    v_cvt_pk_bf16_f32 v167, v74, v75
    v_cvt_pk_bf16_f32 v168, v76, v77
    v_cvt_pk_bf16_f32 v169, v78, v79
    v_cvt_pk_bf16_f32 v170, v80, v81
    v_cvt_pk_bf16_f32 v171, v82, v83
    v_mfma_f32_32x32x16_bf16 v[68:83], v[180:183], v[84:87], 0
    s_add_u32 s9, s9, 73728
    v_add_u32_e64 v5, s9, v5
    v_add_u32 v255, 155648, v6
    v_mfma_f32_32x32x16_bf16 v[68:83], v[184:187], v[88:91], v[68:83]
    v_cvt_pk_bf16_f32 v172, v52, v53
    v_cvt_pk_bf16_f32 v173, v54, v55
    v_cvt_pk_bf16_f32 v174, v56, v57
    v_cvt_pk_bf16_f32 v175, v58, v59
    v_cvt_pk_bf16_f32 v176, v60, v61
    v_cvt_pk_bf16_f32 v177, v62, v63
    v_cvt_pk_bf16_f32 v178, v64, v65
    v_cvt_pk_bf16_f32 v179, v66, v67
    s_nop 3
    s_nop 0
    v_cvt_pk_bf16_f32 v180, v68, v69
    v_cvt_pk_bf16_f32 v181, v70, v71
    v_cvt_pk_bf16_f32 v182, v72, v73
    v_cvt_pk_bf16_f32 v183, v74, v75
    v_cvt_pk_bf16_f32 v184, v76, v77
    v_cvt_pk_bf16_f32 v185, v78, v79
    v_cvt_pk_bf16_f32 v186, v80, v81
    v_cvt_pk_bf16_f32 v187, v82, v83
    v_mfma_f32_32x32x16_bf16 v[52:67], v[188:191], v[84:87], 0
    v_mfma_f32_32x32x16_bf16 v[52:67], v[192:195], v[88:91], v[52:67]
    v_mfma_f32_32x32x16_bf16 v[68:83], v[196:199], v[84:87], 0
    v_mfma_f32_32x32x16_bf16 v[68:83], v[200:203], v[88:91], v[68:83]
    s_nop 9
    s_nop 0
    v_cvt_pk_bf16_f32 v188, v52, v53
    v_cvt_pk_bf16_f32 v189, v54, v55
    v_cvt_pk_bf16_f32 v190, v56, v57
    v_cvt_pk_bf16_f32 v191, v58, v59
    v_cvt_pk_bf16_f32 v192, v60, v61
    v_cvt_pk_bf16_f32 v193, v62, v63
    v_cvt_pk_bf16_f32 v194, v64, v65
    v_cvt_pk_bf16_f32 v195, v66, v67
    v_mfma_f32_32x32x16_bf16 v[52:67], v[204:207], v[84:87], 0
    v_mfma_f32_32x32x16_bf16 v[52:67], v[208:211], v[88:91], v[52:67]
    v_cvt_pk_bf16_f32 v196, v68, v69
    v_cvt_pk_bf16_f32 v197, v70, v71
    v_cvt_pk_bf16_f32 v198, v72, v73
    v_cvt_pk_bf16_f32 v199, v74, v75
    v_cvt_pk_bf16_f32 v200, v76, v77
    v_cvt_pk_bf16_f32 v201, v78, v79
    v_cvt_pk_bf16_f32 v202, v80, v81
    v_cvt_pk_bf16_f32 v203, v82, v83
    v_mfma_f32_32x32x16_bf16 v[68:83], v[212:215], v[84:87], 0
    s_lshl_b32 s12, s2, 7
    s_lshl_b32 s13, s3, 2
    s_add_u32 s12, s12, s13
    s_add_u32 s12, s12, 65536
    v_mov_b32 v22, s12
    global_load_dword v23, v22, s[32:33] sc1
    v_mfma_f32_32x32x16_bf16 v[68:83], v[216:219], v[88:91], v[68:83]
    v_cvt_pk_bf16_f32 v204, v52, v53
    v_cvt_pk_bf16_f32 v205, v54, v55
    v_cvt_pk_bf16_f32 v206, v56, v57
    v_cvt_pk_bf16_f32 v207, v58, v59
    v_cvt_pk_bf16_f32 v208, v60, v61
    v_cvt_pk_bf16_f32 v209, v62, v63
    v_cvt_pk_bf16_f32 v210, v64, v65
    v_cvt_pk_bf16_f32 v211, v66, v67
    v_mfma_f32_32x32x16_bf16 v[52:67], v[220:223], v[84:87], 0
    v_mfma_f32_32x32x16_bf16 v[52:67], v[224:227], v[88:91], v[52:67]
    s_nop 1
    s_nop 0
    v_cvt_pk_bf16_f32 v212, v68, v69
    v_cvt_pk_bf16_f32 v213, v70, v71
    v_cvt_pk_bf16_f32 v214, v72, v73
    v_cvt_pk_bf16_f32 v215, v74, v75
    v_cvt_pk_bf16_f32 v216, v76, v77
    v_cvt_pk_bf16_f32 v217, v78, v79
    v_cvt_pk_bf16_f32 v218, v80, v81
    v_cvt_pk_bf16_f32 v219, v82, v83
    v_mfma_f32_32x32x16_bf16 v[68:83], v[228:231], v[84:87], 0
    v_mfma_f32_32x32x16_bf16 v[68:83], v[232:235], v[88:91], v[68:83]
    v_cvt_pk_bf16_f32 v220, v52, v53
    v_cvt_pk_bf16_f32 v221, v54, v55
    v_cvt_pk_bf16_f32 v222, v56, v57
    v_cvt_pk_bf16_f32 v223, v58, v59
    v_cvt_pk_bf16_f32 v224, v60, v61
    v_cvt_pk_bf16_f32 v225, v62, v63
    v_cvt_pk_bf16_f32 v226, v64, v65
    v_cvt_pk_bf16_f32 v227, v66, v67
    v_mfma_f32_32x32x16_bf16 v[52:67], v[236:239], v[84:87], 0
    v_mfma_f32_32x32x16_bf16 v[52:67], v[240:243], v[88:91], v[52:67]
    s_nop 1
    s_nop 0
    v_cvt_pk_bf16_f32 v228, v68, v69
    v_cvt_pk_bf16_f32 v229, v70, v71
    v_cvt_pk_bf16_f32 v230, v72, v73
    v_cvt_pk_bf16_f32 v231, v74, v75
    v_cvt_pk_bf16_f32 v232, v76, v77
    v_cvt_pk_bf16_f32 v233, v78, v79
    v_cvt_pk_bf16_f32 v234, v80, v81
    v_cvt_pk_bf16_f32 v235, v82, v83
    v_mfma_f32_32x32x16_bf16 v[68:83], v[244:247], v[84:87], 0
    v_mfma_f32_32x32x16_bf16 v[68:83], v[248:251], v[88:91], v[68:83]
    v_cvt_pk_bf16_f32 v236, v52, v53
    v_cvt_pk_bf16_f32 v237, v54, v55
    v_cvt_pk_bf16_f32 v238, v56, v57
    v_cvt_pk_bf16_f32 v239, v58, v59
    v_cvt_pk_bf16_f32 v240, v60, v61
    v_cvt_pk_bf16_f32 v241, v62, v63
    v_cvt_pk_bf16_f32 v242, v64, v65
    v_cvt_pk_bf16_f32 v243, v66, v67
    v_mfma_f32_32x32x16_bf16 v[52:67], v[36:39], v[84:87], 0
    v_mfma_f32_32x32x16_bf16 v[52:67], v[40:43], v[88:91], v[52:67]
    s_nop 1
    s_nop 0
    v_cvt_pk_bf16_f32 v244, v68, v69
    v_cvt_pk_bf16_f32 v245, v70, v71
    v_cvt_pk_bf16_f32 v246, v72, v73
    v_cvt_pk_bf16_f32 v247, v74, v75
    v_cvt_pk_bf16_f32 v248, v76, v77
    v_cvt_pk_bf16_f32 v249, v78, v79
    v_cvt_pk_bf16_f32 v250, v80, v81
    v_cvt_pk_bf16_f32 v251, v82, v83
    v_mfma_f32_32x32x16_bf16 v[68:83], v[44:47], v[84:87], 0
    s_waitcnt vmcnt(0)
    v_readfirstlane_b32 s9, v23
    v_mov_b32_e64 v13, 0
    s_cmp_eq_u32 s9, 0
    s_cbranch_scc1 L_notyet
    global_load_dwordx4 v[16:19], v6, s[66:67] offset:0 sc1
    global_load_dwordx4 v[20:23], v6, s[66:67] offset:1024 sc1
    global_load_dwordx4 v[12:15], v6, s[66:67] offset:2048 sc1
L_notyet:
    v_mfma_f32_32x32x16_bf16 v[68:83], v[48:51], v[88:91], v[68:83]
    v_cvt_pk_bf16_f32 v36, v52, v53
    v_cvt_pk_bf16_f32 v37, v54, v55
    v_cvt_pk_bf16_f32 v38, v56, v57
    v_cvt_pk_bf16_f32 v39, v58, v59
    v_cvt_pk_bf16_f32 v40, v60, v61
    v_cvt_pk_bf16_f32 v41, v62, v63
    v_cvt_pk_bf16_f32 v42, v64, v65
    v_cvt_pk_bf16_f32 v43, v66, v67
    s_nop 3
    s_nop 0
    v_cvt_pk_bf16_f32 v44, v68, v69
    v_cvt_pk_bf16_f32 v45, v70, v71
    v_cvt_pk_bf16_f32 v46, v72, v73
    v_cvt_pk_bf16_f32 v47, v74, v75
    v_cvt_pk_bf16_f32 v48, v76, v77
    v_cvt_pk_bf16_f32 v49, v78, v79
    v_cvt_pk_bf16_f32 v50, v80, v81
    v_cvt_pk_bf16_f32 v51, v82, v83
    ds_read_b64_tr_b16 v[52:53], v7 offset:0
    ds_read_b64_tr_b16 v[54:55], v7 offset:1536
    ds_read_b64_tr_b16 v[56:57], v7 offset:64
    ds_read_b64_tr_b16 v[58:59], v7 offset:1600
    ds_read_b64_tr_b16 v[60:61], v7 offset:128
    ds_read_b64_tr_b16 v[62:63], v7 offset:1664
    ds_read_b64_tr_b16 v[64:65], v7 offset:3072
    ds_read_b64_tr_b16 v[66:67], v7 offset:4608
    ds_read_b64_tr_b16 v[68:69], v7 offset:3136
    ds_read_b64_tr_b16 v[70:71], v7 offset:4672
    ds_read_b64_tr_b16 v[72:73], v7 offset:3200
    ds_read_b64_tr_b16 v[74:75], v7 offset:4736
    ds_read_b64_tr_b16 v[76:77], v7 offset:6144
    ds_read_b64_tr_b16 v[78:79], v7 offset:7680
    ds_read_b64_tr_b16 v[80:81], v7 offset:6208
    s_waitcnt lgkmcnt(14)
    ds_read_b64_tr_b16 v[82:83], v7 offset:7744
    s_waitcnt lgkmcnt(14)
    ds_read_b64_tr_b16 v[84:85], v7 offset:6272
    s_waitcnt lgkmcnt(14)
    ds_read_b64_tr_b16 v[86:87], v7 offset:7808
    v_dot2_f32_bf16 v88, v52, v24, 0
    v_dot2_f32_bf16 v89, v56, v24, 0
    s_waitcnt lgkmcnt(13)
    v_dot2_f32_bf16 v90, v60, v24, 0
    v_dot2_f32_bf16 v88, v53, v25, v88
    v_dot2_f32_bf16 v89, v57, v25, v89
    v_dot2_f32_bf16 v90, v61, v25, v90
    v_dot2_f32_bf16 v88, v54, v26, v88
    v_dot2_f32_bf16 v89, v58, v26, v89
    s_waitcnt lgkmcnt(12)
    v_dot2_f32_bf16 v90, v62, v26, v90
    v_dot2_f32_bf16 v88, v55, v27, v88
    v_dot2_f32_bf16 v89, v59, v27, v89
    v_dot2_f32_bf16 v90, v63, v27, v90
    s_waitcnt lgkmcnt(11)
    v_dot2_f32_bf16 v88, v64, v28, v88
    s_waitcnt lgkmcnt(9)
    v_dot2_f32_bf16 v89, v68, v28, v89
    s_waitcnt lgkmcnt(7)
    v_dot2_f32_bf16 v90, v72, v28, v90
    v_dot2_f32_bf16 v88, v65, v29, v88
    v_dot2_f32_bf16 v89, v69, v29, v89
    v_dot2_f32_bf16 v90, v73, v29, v90
    v_dot2_f32_bf16 v88, v66, v30, v88
    v_dot2_f32_bf16 v89, v70, v30, v89
    s_waitcnt lgkmcnt(6)
    v_dot2_f32_bf16 v90, v74, v30, v90
    v_dot2_f32_bf16 v88, v67, v31, v88
    v_dot2_f32_bf16 v89, v71, v31, v89
    v_dot2_f32_bf16 v90, v75, v31, v90
    s_waitcnt lgkmcnt(5)
    v_dot2_f32_bf16 v88, v76, v32, v88
    s_waitcnt lgkmcnt(3)
    v_dot2_f32_bf16 v89, v80, v32, v89
    s_waitcnt lgkmcnt(1)
    v_dot2_f32_bf16 v90, v84, v32, v90
    v_dot2_f32_bf16 v88, v77, v33, v88
    v_dot2_f32_bf16 v89, v81, v33, v89
    v_dot2_f32_bf16 v90, v85, v33, v90
    v_dot2_f32_bf16 v88, v78, v34, v88
    v_dot2_f32_bf16 v89, v82, v34, v89
    s_waitcnt lgkmcnt(0)
    v_dot2_f32_bf16 v90, v86, v34, v90
    v_dot2_f32_bf16 v88, v79, v35, v88
    v_dot2_f32_bf16 v89, v83, v35, v89
    v_dot2_f32_bf16 v90, v87, v35, v90
    v_and_b32 v91, 31, v1
    v_lshlrev_b32_e64 v91, 3, v91
    v_add_u32 v91, 158720, v91
    v_cvt_f64_f32_e64 v[24:25], v88
    ds_add_f64 v91, v[24:25] offset:0
    v_cvt_f64_f32_e64 v[26:27], v89
    ds_add_f64 v91, v[26:27] offset:256
    v_cvt_f64_f32_e64 v[28:29], v90
    ds_add_f64 v91, v[28:29] offset:512
    s_mov_b32 s13, 0x40400000
    s_mov_b32 s10, 0
    v_mov_b32_e64 v30, s12
    s_waitcnt vmcnt(0)
L_poll_loop:
    v_min3_u32 v31, v17, v19, v21
    v_min3_u32 v32, v23, v13, v15
    v_min_u32_e64 v31, v31, v32
    v_cmp_gt_u32 vcc, s13, v31
    s_nop 4
    s_cbranch_vccz L_poll_done
L_poll_one:
    s_add_u32 s10, s10, 1
    s_cmp_ge_u32 s10, 0x40000
    s_cbranch_scc1 L_poll_done
    s_cmp_lg_u32 s9, 0
    s_cbranch_scc1 L_poll_coh
    global_load_dword v31, v30, s[32:33] sc1
    s_waitcnt vmcnt(0)
    v_readfirstlane_b32 s9, v31
    s_nop 0
    s_cmp_lg_u32 s9, 0
    s_cbranch_scc1 L_poll_l2
    s_sleep 2
    s_branch L_poll_one
L_poll_l2:
    global_load_dwordx4 v[16:19], v6, s[66:67] offset:0 sc1
    global_load_dwordx4 v[20:23], v6, s[66:67] offset:1024 sc1
    global_load_dwordx4 v[12:15], v6, s[66:67] offset:2048 sc1
    s_waitcnt vmcnt(0)
    s_branch L_poll_loop
L_poll_coh:
    s_sleep 4
    global_load_dwordx4 v[16:19], v6, s[66:67] offset:0 sc1
    global_load_dwordx4 v[20:23], v6, s[66:67] offset:1024 sc1
    global_load_dwordx4 v[12:15], v6, s[66:67] offset:2048 sc1
    s_waitcnt vmcnt(0)
    s_branch L_poll_loop
L_poll_done:
    s_nop 0
    ds_add_f64 v255, v[16:17] offset:0
    ds_add_f64 v255, v[18:19] offset:8
    ds_add_f64 v255, v[20:21] offset:1024
    ds_add_f64 v255, v[22:23] offset:1032
    ds_add_f64 v255, v[12:13] offset:2048
    ds_add_f64 v255, v[14:15] offset:2056
    s_waitcnt lgkmcnt(0)
    s_barrier
    ds_read_b128 v[16:19], v255 offset:0
    ds_read_b128 v[20:23], v255 offset:1024
    ds_read_b128 v[24:27], v255 offset:2048
    v_min_u32 v12, 47, v1
    v_lshlrev_b32 v12, 3, v12
    v_lshlrev_b32_e64 v13, 1, v12
    v_add_u32 v13, 158720, v13
    ds_read_b128 v[28:31], v13
    v_add_u32 v12, 163136, v12
    s_mov_b32 s12, 0
    s_mov_b32 s13, 0xc0700000
    v_mul_f32 v0, 0x4091afa4, v0
    v_mov_b32 v15, 0x358637bd
    s_waitcnt lgkmcnt(3)
    v_add_f64 v[16:17], v[16:17], s[12:13]
    v_add_f64 v[18:19], v[18:19], s[12:13]
    s_waitcnt lgkmcnt(2)
    v_add_f64 v[20:21], v[20:21], s[12:13]
    v_add_f64 v[22:23], v[22:23], s[12:13]
    s_waitcnt lgkmcnt(1)
    v_add_f64 v[24:25], v[24:25], s[12:13]
    v_add_f64 v[26:27], v[26:27], s[12:13]
    v_cvt_f32_f64 v16, v[16:17]
    v_cvt_f32_f64 v17, v[18:19]
    v_cvt_f32_f64 v18, v[20:21]
    v_cvt_f32_f64 v19, v[22:23]
    v_cvt_f32_f64 v20, v[24:25]
    v_cvt_f32_f64 v21, v[26:27]
    v_fma_f32 v16, v16, v0, v15
    v_fma_f32 v17, v17, v0, v15
    v_fma_f32 v18, v18, v0, v15
    v_fma_f32 v19, v19, v0, v15
    v_fma_f32 v20, v20, v0, v15
    v_fma_f32 v21, v21, v0, v15
    v_sqrt_f32 v16, v16
    v_sqrt_f32 v17, v17
    v_sqrt_f32 v18, v18
    v_sqrt_f32 v19, v19
    v_sqrt_f32 v20, v20
    v_sqrt_f32 v21, v21
    s_waitcnt lgkmcnt(0)
    v_cvt_f32_f64 v28, v[28:29]
    v_cvt_f32_f64 v29, v[30:31]
    v_add_f32 v22, v16, v17
    v_add_f32 v23, v18, v19
    v_add_f32 v24, v20, v21
    ds_write_b64 v12, v[28:29]
    v_add_f32 v22, v22, v23
    v_add_f32_e64 v22, v22, v24
    s_nop 1
    v_add_f32_dpp v22, v22, v22 quad_perm:[1,0,3,2] row_mask:0xf bank_mask:0xf
    v_lshlrev_b32_e64 v30, 16, v252
    v_and_b32 v31, 0xffff0000, v252
    v_add_f32_dpp v22, v22, v22 quad_perm:[2,3,0,1] row_mask:0xf bank_mask:0xf
    v_lshlrev_b32_e64 v32, 16, v253
    v_and_b32 v33, 0xffff0000, v253
    v_add_f32_dpp v22, v22, v22 row_half_mirror row_mask:0xf bank_mask:0xf
    v_lshlrev_b32_e64 v34, 16, v254
    v_and_b32 v35, 0xffff0000, v254
    v_add_f32_dpp v22, v22, v22 row_mirror row_mask:0xf bank_mask:0xf
    v_mul_f32 v16, v16, v30
    v_mul_f32 v17, v17, v31
    v_readlane_b32 s9, v22, 0
    v_readlane_b32 s10, v22, 16
    v_readlane_b32 s12, v22, 32
    v_readlane_b32 s13, v22, 48
    v_mul_f32 v18, v18, v32
    v_mul_f32 v19, v19, v33
    v_mul_f32 v20, v20, v34
    v_mul_f32 v21, v21, v35
    v_mov_b32 v22, s9
    v_add_f32 v22, s10, v22
    v_add_f32 v22, s12, v22
    v_add_f32 v22, s13, v22
    s_mov_b32 s9, 0x3b2aaaab
    v_fma_f32 v22, v22, s9, v15
    v_rcp_f32_e64 v22, v22
    v_mov_b32 v23, 0xc0088e99
    v_lshrrev_b32 v12, 1, v6
    v_mul_f32 v22, v23, v22
    v_add_u32 v12, 160064, v12
    v_fma_f32 v16, v16, v22, v23
    v_fma_f32 v17, v17, v22, v23
    v_fma_f32 v18, v18, v22, v23
    v_fma_f32 v19, v19, v22, v23
    v_fma_f32 v20, v20, v22, v23
    v_fma_f32 v21, v21, v22, v23
    ds_write_b64 v12, v[16:17] offset:0
    ds_write_b64 v12, v[18:19] offset:512
    ds_write_b64 v12, v[20:21] offset:1024
    v_lshrrev_b32 v12, 5, v1
    v_lshlrev_b32 v12, 4, v12
    s_mul_i32 s9, s3, 192
    s_add_u32 s9, s9, 160064
    v_add_u32_e64 v12, s9, v12
    ds_read_b128 v[16:19], v12 offset:0
    ds_read_b128 v[20:23], v12 offset:32
    ds_read_b128 v[24:27], v12 offset:64
    ds_read_b128 v[28:31], v12 offset:96
    ds_read_b128 v[32:35], v12 offset:128
    ds_read_b128 v[252:255], v12 offset:160
    v_and_b32_e64 v0, 35, v1
    v_bfe_u32 v12, v1, 4, 1
    v_lshl_add_u32 v0, v12, 2, v0
    v_bfe_u32 v12, v1, 2, 2
    v_lshl_add_u32 v0, v12, 3, v0
    v_lshlrev_b32 v0, 4, v0
    v_add_u32 v0, s14, v0
    v_lshlrev_b32_e64 v12, 16, v52
    v_and_b32 v13, 0xffff0000, v52
    v_lshlrev_b32_e64 v14, 16, v53
    v_and_b32 v15, 0xffff0000, v53
    v_lshlrev_b32_e64 v88, 16, v54
    v_and_b32 v89, 0xffff0000, v54
    v_lshlrev_b32_e64 v90, 16, v55
    v_and_b32 v91, 0xffff0000, v55
    s_waitcnt lgkmcnt(5)
    v_pk_mul_f32 v[12:13], v[12:13], v[16:17]
    v_pk_mul_f32 v[14:15], v[14:15], v[18:19]
    s_waitcnt lgkmcnt(4)
    v_pk_mul_f32 v[88:89], v[88:89], v[20:21]
    v_pk_mul_f32 v[90:91], v[90:91], v[22:23]
    v_cvt_pk_bf16_f32 v52, v12, v13
    v_cvt_pk_bf16_f32 v53, v14, v15
    v_cvt_pk_bf16_f32 v54, v88, v89
    v_cvt_pk_bf16_f32 v55, v90, v91
    ds_write_b128 v0, v[52:55] offset:0
    v_lshlrev_b32_e64 v12, 16, v56
    v_and_b32 v13, 0xffff0000, v56
    v_lshlrev_b32_e64 v14, 16, v57
    v_and_b32 v15, 0xffff0000, v57
    v_lshlrev_b32_e64 v88, 16, v58
    v_and_b32 v89, 0xffff0000, v58
    v_lshlrev_b32_e64 v90, 16, v59
    v_and_b32 v91, 0xffff0000, v59
    v_pk_mul_f32 v[12:13], v[12:13], v[16:17]
    v_pk_mul_f32 v[14:15], v[14:15], v[18:19]
    v_pk_mul_f32 v[88:89], v[88:89], v[20:21]
    v_pk_mul_f32 v[90:91], v[90:91], v[22:23]
    v_cvt_pk_bf16_f32 v56, v12, v13
    v_cvt_pk_bf16_f32 v57, v14, v15
    v_cvt_pk_bf16_f32 v58, v88, v89
    v_cvt_pk_bf16_f32 v59, v90, v91
    ds_write_b128 v0, v[56:59] offset:1024
    v_lshlrev_b32_e64 v12, 16, v60
    v_and_b32 v13, 0xffff0000, v60
    v_lshlrev_b32_e64 v14, 16, v61
    v_and_b32 v15, 0xffff0000, v61
    v_lshlrev_b32_e64 v88, 16, v62
    v_and_b32 v89, 0xffff0000, v62
    v_lshlrev_b32_e64 v90, 16, v63
    v_and_b32 v91, 0xffff0000, v63
    v_pk_mul_f32 v[12:13], v[12:13], v[16:17]
    v_pk_mul_f32 v[14:15], v[14:15], v[18:19]
    v_pk_mul_f32 v[88:89], v[88:89], v[20:21]
    v_pk_mul_f32 v[90:91], v[90:91], v[22:23]
    v_cvt_pk_bf16_f32 v60, v12, v13
    v_cvt_pk_bf16_f32 v61, v14, v15
    v_cvt_pk_bf16_f32 v62, v88, v89
    v_cvt_pk_bf16_f32 v63, v90, v91
    ds_write_b128 v0, v[60:63] offset:2048
    v_lshlrev_b32_e64 v12, 16, v64
    v_and_b32 v13, 0xffff0000, v64
    v_lshlrev_b32_e64 v14, 16, v65
    v_and_b32 v15, 0xffff0000, v65
    v_lshlrev_b32_e64 v88, 16, v66
    v_and_b32 v89, 0xffff0000, v66
    v_lshlrev_b32_e64 v90, 16, v67
    v_and_b32 v91, 0xffff0000, v67
    s_waitcnt lgkmcnt(6)
    v_pk_mul_f32 v[12:13], v[12:13], v[24:25]
    v_pk_mul_f32 v[14:15], v[14:15], v[26:27]
    s_waitcnt lgkmcnt(5)
    v_pk_mul_f32 v[88:89], v[88:89], v[28:29]
    v_pk_mul_f32 v[90:91], v[90:91], v[30:31]
    v_cvt_pk_bf16_f32 v64, v12, v13
    v_cvt_pk_bf16_f32 v65, v14, v15
    v_cvt_pk_bf16_f32 v66, v88, v89
    v_cvt_pk_bf16_f32 v67, v90, v91
    ds_write_b128 v0, v[64:67] offset:3072
    v_lshlrev_b32_e64 v12, 16, v68
    v_and_b32 v13, 0xffff0000, v68
    v_lshlrev_b32_e64 v14, 16, v69
    v_and_b32 v15, 0xffff0000, v69
    v_lshlrev_b32_e64 v88, 16, v70
    v_and_b32 v89, 0xffff0000, v70
    v_lshlrev_b32_e64 v90, 16, v71
    v_and_b32 v91, 0xffff0000, v71
    v_pk_mul_f32 v[12:13], v[12:13], v[24:25]
    v_pk_mul_f32 v[14:15], v[14:15], v[26:27]
    v_pk_mul_f32 v[88:89], v[88:89], v[28:29]
    v_pk_mul_f32 v[90:91], v[90:91], v[30:31]
    v_cvt_pk_bf16_f32 v68, v12, v13
    v_cvt_pk_bf16_f32 v69, v14, v15
    v_cvt_pk_bf16_f32 v70, v88, v89
    v_cvt_pk_bf16_f32 v71, v90, v91
    ds_write_b128 v0, v[68:71] offset:4096
    v_lshlrev_b32_e64 v12, 16, v72
    v_and_b32 v13, 0xffff0000, v72
    v_lshlrev_b32_e64 v14, 16, v73
    v_and_b32 v15, 0xffff0000, v73
    v_lshlrev_b32_e64 v88, 16, v74
    v_and_b32 v89, 0xffff0000, v74
    v_lshlrev_b32_e64 v90, 16, v75
    v_and_b32 v91, 0xffff0000, v75
    v_pk_mul_f32 v[12:13], v[12:13], v[24:25]
    v_pk_mul_f32 v[14:15], v[14:15], v[26:27]
    v_pk_mul_f32 v[88:89], v[88:89], v[28:29]
    v_pk_mul_f32 v[90:91], v[90:91], v[30:31]
    v_cvt_pk_bf16_f32 v72, v12, v13
    v_cvt_pk_bf16_f32 v73, v14, v15
    v_cvt_pk_bf16_f32 v74, v88, v89
    v_cvt_pk_bf16_f32 v75, v90, v91
    ds_write_b128 v0, v[72:75] offset:5120
    v_lshlrev_b32_e64 v12, 16, v76
    v_and_b32 v13, 0xffff0000, v76
    v_lshlrev_b32_e64 v14, 16, v77
    v_and_b32 v15, 0xffff0000, v77
    v_lshlrev_b32_e64 v88, 16, v78
    v_and_b32 v89, 0xffff0000, v78
    v_lshlrev_b32_e64 v90, 16, v79
    v_and_b32 v91, 0xffff0000, v79
    s_waitcnt lgkmcnt(7)
    v_pk_mul_f32 v[12:13], v[12:13], v[32:33]
    v_pk_mul_f32 v[14:15], v[14:15], v[34:35]
    s_waitcnt lgkmcnt(6)
    v_pk_mul_f32 v[88:89], v[88:89], v[252:253]
    v_pk_mul_f32 v[90:91], v[90:91], v[254:255]
    v_cvt_pk_bf16_f32 v76, v12, v13
    v_cvt_pk_bf16_f32 v77, v14, v15
    v_cvt_pk_bf16_f32 v78, v88, v89
    v_cvt_pk_bf16_f32 v79, v90, v91
    ds_write_b128 v0, v[76:79] offset:6144
    v_lshlrev_b32_e64 v12, 16, v80
    v_and_b32 v13, 0xffff0000, v80
    v_lshlrev_b32_e64 v14, 16, v81
    v_and_b32 v15, 0xffff0000, v81
    v_lshlrev_b32_e64 v88, 16, v82
    v_and_b32 v89, 0xffff0000, v82
    v_lshlrev_b32_e64 v90, 16, v83
    v_and_b32 v91, 0xffff0000, v83
    v_pk_mul_f32 v[12:13], v[12:13], v[32:33]
    v_pk_mul_f32 v[14:15], v[14:15], v[34:35]
    v_pk_mul_f32 v[88:89], v[88:89], v[252:253]
    v_pk_mul_f32 v[90:91], v[90:91], v[254:255]
    v_cvt_pk_bf16_f32 v80, v12, v13
    v_cvt_pk_bf16_f32 v81, v14, v15
    v_cvt_pk_bf16_f32 v82, v88, v89
    v_cvt_pk_bf16_f32 v83, v90, v91
    ds_write_b128 v0, v[80:83] offset:7168
    v_lshlrev_b32_e64 v12, 16, v84
    v_and_b32 v13, 0xffff0000, v84
    v_lshlrev_b32_e64 v14, 16, v85
    v_and_b32 v15, 0xffff0000, v85
    v_lshlrev_b32_e64 v88, 16, v86
    v_and_b32 v89, 0xffff0000, v86
    v_lshlrev_b32_e64 v90, 16, v87
    v_and_b32 v91, 0xffff0000, v87
    v_pk_mul_f32 v[12:13], v[12:13], v[32:33]
    v_pk_mul_f32 v[14:15], v[14:15], v[34:35]
    v_pk_mul_f32 v[88:89], v[88:89], v[252:253]
    v_pk_mul_f32 v[90:91], v[90:91], v[254:255]
    v_cvt_pk_bf16_f32 v84, v12, v13
    v_cvt_pk_bf16_f32 v85, v14, v15
    v_cvt_pk_bf16_f32 v86, v88, v89
    v_cvt_pk_bf16_f32 v87, v90, v91
    ds_write_b128 v0, v[84:87] offset:8192
    v_add_u32 v7, 36864, v6
    s_waitcnt lgkmcnt(0)
    s_barrier
    s_setprio 3
    s_nop 0
    ds_read_b128 v[32:35], v6 offset:0
    ds_read_b128 v[16:19], v9 offset:0
    ds_read_b128 v[20:23], v9 offset:16
    ds_read_b128 v[24:27], v9 offset:32
    ds_read_b128 v[28:31], v9 offset:48
    ds_read_b128 v[84:87], v6 offset:1024
    ds_read_b128 v[52:55], v9 offset:128
    ds_read_b128 v[56:59], v9 offset:144
    ds_read_b128 v[60:63], v9 offset:160
    ds_read_b128 v[64:67], v9 offset:176
    ds_read_b128 v[88:91], v6 offset:2048
    ds_read_b128 v[68:71], v9 offset:256
    ds_read_b128 v[72:75], v9 offset:272
    ds_read_b128 v[76:79], v9 offset:288
    ds_read_b128 v[80:83], v9 offset:304
    s_waitcnt lgkmcnt(14)
    ds_read_b128 v[252:255], v6 offset:3072
    s_waitcnt lgkmcnt(11)
    v_mfma_f32_32x32x16_bf16 v[16:31], v[32:35], v[92:95], v[16:31]
    ds_read_b128 v[32:35], v6 offset:4096
    s_waitcnt lgkmcnt(7)
    v_mfma_f32_32x32x16_bf16 v[52:67], v[84:87], v[92:95], v[52:67]
    ds_read_b128 v[84:87], v6 offset:5120
    s_waitcnt lgkmcnt(3)
    v_mfma_f32_32x32x16_bf16 v[68:83], v[88:91], v[92:95], v[68:83]
    ds_read_b128 v[88:91], v6 offset:6144
    buffer_load_dwordx4 v[92:95], v2, s[36:39], s52 offen offset:0
    s_waitcnt lgkmcnt(3)
    v_mfma_f32_32x32x16_bf16 v[16:31], v[252:255], v[96:99], v[16:31]
    ds_read_b128 v[252:255], v6 offset:7168
    s_waitcnt lgkmcnt(3)
    v_mfma_f32_32x32x16_bf16 v[52:67], v[32:35], v[96:99], v[52:67]
    ds_read_b128 v[32:35], v6 offset:8192
    s_waitcnt lgkmcnt(3)
    v_mfma_f32_32x32x16_bf16 v[68:83], v[84:87], v[96:99], v[68:83]
    ds_read_b128 v[84:87], v6 offset:9216
    s_waitcnt lgkmcnt(3)
    v_mfma_f32_32x32x16_bf16 v[16:31], v[88:91], v[100:103], v[16:31]
    ds_read_b128 v[88:91], v6 offset:10240
    s_waitcnt lgkmcnt(3)
    v_mfma_f32_32x32x16_bf16 v[52:67], v[252:255], v[100:103], v[52:67]
    ds_read_b128 v[252:255], v6 offset:11264
    buffer_load_dwordx4 v[96:99], v2, s[36:39], s52 offen offset:16
    s_waitcnt lgkmcnt(3)
    v_mfma_f32_32x32x16_bf16 v[68:83], v[32:35], v[100:103], v[68:83]
    ds_read_b128 v[32:35], v6 offset:12288
    s_waitcnt lgkmcnt(3)
    v_mfma_f32_32x32x16_bf16 v[16:31], v[84:87], v[104:107], v[16:31]
    ds_read_b128 v[84:87], v6 offset:13312
    s_waitcnt lgkmcnt(3)
    v_mfma_f32_32x32x16_bf16 v[52:67], v[88:91], v[104:107], v[52:67]
    ds_read_b128 v[88:91], v6 offset:14336
    s_waitcnt lgkmcnt(3)
    v_mfma_f32_32x32x16_bf16 v[68:83], v[252:255], v[104:107], v[68:83]
    ds_read_b128 v[252:255], v6 offset:15360
    s_waitcnt lgkmcnt(3)
    v_mfma_f32_32x32x16_bf16 v[16:31], v[32:35], v[108:111], v[16:31]
    ds_read_b128 v[32:35], v6 offset:16384
    buffer_load_dwordx4 v[100:103], v2, s[36:39], s52 offen offset:64
    s_waitcnt lgkmcnt(3)
    v_mfma_f32_32x32x16_bf16 v[52:67], v[84:87], v[108:111], v[52:67]
    ds_read_b128 v[84:87], v6 offset:17408
    s_waitcnt lgkmcnt(3)
    v_mfma_f32_32x32x16_bf16 v[68:83], v[88:91], v[108:111], v[68:83]
    ds_read_b128 v[88:91], v6 offset:18432
    s_waitcnt lgkmcnt(3)
    v_mfma_f32_32x32x16_bf16 v[16:31], v[252:255], v[112:115], v[16:31]
    ds_read_b128 v[252:255], v6 offset:19456
    s_waitcnt lgkmcnt(3)
    v_mfma_f32_32x32x16_bf16 v[52:67], v[32:35], v[112:115], v[52:67]
    ds_read_b128 v[32:35], v6 offset:20480
    s_waitcnt lgkmcnt(3)
    v_mfma_f32_32x32x16_bf16 v[68:83], v[84:87], v[112:115], v[68:83]
    ds_read_b128 v[84:87], v6 offset:21504
    buffer_load_dwordx4 v[104:107], v2, s[36:39], s52 offen offset:80
    s_waitcnt lgkmcnt(3)
    v_mfma_f32_32x32x16_bf16 v[16:31], v[88:91], v[116:119], v[16:31]
    ds_read_b128 v[88:91], v6 offset:22528
    s_waitcnt lgkmcnt(3)
    v_mfma_f32_32x32x16_bf16 v[52:67], v[252:255], v[116:119], v[52:67]
    ds_read_b128 v[252:255], v6 offset:23552
    s_waitcnt lgkmcnt(3)
    v_mfma_f32_32x32x16_bf16 v[68:83], v[32:35], v[116:119], v[68:83]
    ds_read_b128 v[32:35], v6 offset:24576
    s_waitcnt lgkmcnt(3)
    v_mfma_f32_32x32x16_bf16 v[16:31], v[84:87], v[120:123], v[16:31]
    ds_read_b128 v[84:87], v6 offset:25600
    s_waitcnt lgkmcnt(3)
    v_mfma_f32_32x32x16_bf16 v[52:67], v[88:91], v[120:123], v[52:67]
    ds_read_b128 v[88:91], v6 offset:26624
    buffer_load_dwordx4 v[108:111], v2, s[36:39], s52 offen offset:128
    s_waitcnt lgkmcnt(3)
    v_mfma_f32_32x32x16_bf16 v[68:83], v[252:255], v[120:123], v[68:83]
    ds_read_b128 v[252:255], v6 offset:27648
    s_waitcnt lgkmcnt(3)
    v_mfma_f32_32x32x16_bf16 v[16:31], v[32:35], v[124:127], v[16:31]
    ds_read_b128 v[32:35], v6 offset:28672
    s_waitcnt lgkmcnt(3)
    v_mfma_f32_32x32x16_bf16 v[52:67], v[84:87], v[124:127], v[52:67]
    ds_read_b128 v[84:87], v6 offset:29696
    s_waitcnt lgkmcnt(3)
    v_mfma_f32_32x32x16_bf16 v[68:83], v[88:91], v[124:127], v[68:83]
    ds_read_b128 v[88:91], v6 offset:30720
    s_waitcnt lgkmcnt(3)
    v_mfma_f32_32x32x16_bf16 v[16:31], v[252:255], v[128:131], v[16:31]
    ds_read_b128 v[252:255], v6 offset:31744
    buffer_load_dwordx4 v[112:115], v2, s[36:39], s52 offen offset:144
    s_waitcnt lgkmcnt(3)
    v_mfma_f32_32x32x16_bf16 v[52:67], v[32:35], v[128:131], v[52:67]
    ds_read_b128 v[32:35], v6 offset:32768
    s_waitcnt lgkmcnt(3)
    v_mfma_f32_32x32x16_bf16 v[68:83], v[84:87], v[128:131], v[68:83]
    ds_read_b128 v[84:87], v6 offset:33792
    s_waitcnt lgkmcnt(3)
    v_mfma_f32_32x32x16_bf16 v[16:31], v[88:91], v[132:135], v[16:31]
    ds_read_b128 v[88:91], v6 offset:34816
    s_waitcnt lgkmcnt(3)
    v_mfma_f32_32x32x16_bf16 v[52:67], v[252:255], v[132:135], v[52:67]
    ds_read_b128 v[252:255], v6 offset:35840
    s_waitcnt lgkmcnt(3)
    v_mfma_f32_32x32x16_bf16 v[68:83], v[32:35], v[132:135], v[68:83]
    ds_read_b128 v[32:35], v7 offset:0
    buffer_load_dwordx4 v[116:119], v2, s[36:39], s53 offen offset:0
    s_waitcnt lgkmcnt(3)
    v_mfma_f32_32x32x16_bf16 v[16:31], v[84:87], v[136:139], v[16:31]
    ds_read_b128 v[84:87], v7 offset:1024
    s_waitcnt lgkmcnt(3)
    v_mfma_f32_32x32x16_bf16 v[52:67], v[88:91], v[136:139], v[52:67]
    ds_read_b128 v[88:91], v7 offset:2048
    s_waitcnt lgkmcnt(3)
    v_mfma_f32_32x32x16_bf16 v[68:83], v[252:255], v[136:139], v[68:83]
    ds_read_b128 v[252:255], v7 offset:3072
    s_waitcnt lgkmcnt(3)
    v_mfma_f32_32x32x16_bf16 v[16:31], v[32:35], v[140:143], v[16:31]
    ds_read_b128 v[32:35], v7 offset:4096
    s_waitcnt lgkmcnt(3)
    v_mfma_f32_32x32x16_bf16 v[52:67], v[84:87], v[140:143], v[52:67]
    ds_read_b128 v[84:87], v7 offset:5120
    buffer_load_dwordx4 v[120:123], v2, s[36:39], s53 offen offset:16
    s_waitcnt lgkmcnt(3)
    v_mfma_f32_32x32x16_bf16 v[68:83], v[88:91], v[140:143], v[68:83]
    ds_read_b128 v[88:91], v7 offset:6144
    s_waitcnt lgkmcnt(3)
    v_mfma_f32_32x32x16_bf16 v[16:31], v[252:255], v[144:147], v[16:31]
    ds_read_b128 v[252:255], v7 offset:7168
    s_waitcnt lgkmcnt(3)
    v_mfma_f32_32x32x16_bf16 v[52:67], v[32:35], v[144:147], v[52:67]
    ds_read_b128 v[32:35], v7 offset:8192
    s_waitcnt lgkmcnt(3)
    v_mfma_f32_32x32x16_bf16 v[68:83], v[84:87], v[144:147], v[68:83]
    ds_read_b128 v[84:87], v7 offset:9216
    s_waitcnt lgkmcnt(3)
    v_mfma_f32_32x32x16_bf16 v[16:31], v[88:91], v[148:151], v[16:31]
    ds_read_b128 v[88:91], v7 offset:10240
    buffer_load_dwordx4 v[124:127], v2, s[36:39], s53 offen offset:64
    s_waitcnt lgkmcnt(3)
    v_mfma_f32_32x32x16_bf16 v[52:67], v[252:255], v[148:151], v[52:67]
    ds_read_b128 v[252:255], v7 offset:11264
    s_waitcnt lgkmcnt(3)
    v_mfma_f32_32x32x16_bf16 v[68:83], v[32:35], v[148:151], v[68:83]
    ds_read_b128 v[32:35], v7 offset:12288
    s_waitcnt lgkmcnt(3)
    v_mfma_f32_32x32x16_bf16 v[16:31], v[84:87], v[152:155], v[16:31]
    ds_read_b128 v[84:87], v7 offset:13312
    s_waitcnt lgkmcnt(3)
    v_mfma_f32_32x32x16_bf16 v[52:67], v[88:91], v[152:155], v[52:67]
    ds_read_b128 v[88:91], v7 offset:14336
    s_waitcnt lgkmcnt(3)
    v_mfma_f32_32x32x16_bf16 v[68:83], v[252:255], v[152:155], v[68:83]
    ds_read_b128 v[252:255], v7 offset:15360
    buffer_load_dwordx4 v[128:131], v2, s[36:39], s53 offen offset:80
    ds_read_b64_tr_b16 v[148:149], v10 offset:0
    s_waitcnt lgkmcnt(4)
    v_mfma_f32_32x32x16_bf16 v[16:31], v[32:35], v[156:159], v[16:31]
    ds_read_b128 v[32:35], v7 offset:16384
    ds_read_b64_tr_b16 v[150:151], v10 offset:512
    s_waitcnt lgkmcnt(5)
    v_mfma_f32_32x32x16_bf16 v[52:67], v[84:87], v[156:159], v[52:67]
    ds_read_b128 v[84:87], v7 offset:17408
    ds_read_b64_tr_b16 v[152:153], v10 offset:1024
    s_waitcnt lgkmcnt(6)
    v_mfma_f32_32x32x16_bf16 v[68:83], v[88:91], v[156:159], v[68:83]
    ds_read_b128 v[88:91], v7 offset:18432
    ds_read_b64_tr_b16 v[154:155], v10 offset:1536
    s_waitcnt lgkmcnt(7)
    v_mfma_f32_32x32x16_bf16 v[16:31], v[252:255], v[160:163], v[16:31]
    ds_read_b128 v[252:255], v7 offset:19456
    s_waitcnt lgkmcnt(6)
    v_mfma_f32_32x32x16_bf16 v[52:67], v[32:35], v[160:163], v[52:67]
    ds_read_b128 v[32:35], v7 offset:20480
    buffer_load_dwordx4 v[132:135], v2, s[36:39], s53 offen offset:128
    s_waitcnt lgkmcnt(5)
    v_mfma_f32_32x32x16_bf16 v[68:83], v[84:87], v[160:163], v[68:83]
    ds_read_b128 v[84:87], v7 offset:21504
    ds_read_b64_tr_b16 v[156:157], v10 offset:2048
    s_waitcnt lgkmcnt(5)
    v_mfma_f32_32x32x16_bf16 v[16:31], v[88:91], v[164:167], v[16:31]
    ds_read_b128 v[88:91], v7 offset:22528
    ds_read_b64_tr_b16 v[158:159], v10 offset:2560
    s_waitcnt lgkmcnt(5)
    v_mfma_f32_32x32x16_bf16 v[52:67], v[252:255], v[164:167], v[52:67]
    ds_read_b128 v[252:255], v7 offset:23552
    ds_read_b64_tr_b16 v[160:161], v10 offset:3072
    s_waitcnt lgkmcnt(6)
    v_mfma_f32_32x32x16_bf16 v[68:83], v[32:35], v[164:167], v[68:83]
    ds_read_b128 v[32:35], v7 offset:24576
    ds_read_b64_tr_b16 v[162:163], v10 offset:3584
    s_waitcnt lgkmcnt(7)
    v_mfma_f32_32x32x16_bf16 v[16:31], v[84:87], v[168:171], v[16:31]
    ds_read_b128 v[84:87], v7 offset:25600
    buffer_load_dwordx4 v[136:139], v2, s[36:39], s53 offen offset:144
    s_waitcnt lgkmcnt(6)
    v_mfma_f32_32x32x16_bf16 v[52:67], v[88:91], v[168:171], v[52:67]
    ds_read_b128 v[88:91], v7 offset:26624
    s_waitcnt lgkmcnt(5)
    v_mfma_f32_32x32x16_bf16 v[68:83], v[252:255], v[168:171], v[68:83]
    ds_read_b128 v[252:255], v7 offset:27648
    s_waitcnt lgkmcnt(4)
    v_mfma_f32_32x32x16_bf16 v[16:31], v[32:35], v[172:175], v[16:31]
    ds_read_b128 v[32:35], v7 offset:28672
    s_waitcnt lgkmcnt(3)
    v_mfma_f32_32x32x16_bf16 v[52:67], v[84:87], v[172:175], v[52:67]
    ds_read_b128 v[84:87], v7 offset:29696
    s_waitcnt lgkmcnt(3)
    v_mfma_f32_32x32x16_bf16 v[68:83], v[88:91], v[172:175], v[68:83]
    ds_read_b128 v[88:91], v7 offset:30720
    buffer_load_dwordx4 v[140:143], v2, s[36:39], s54 offen offset:0
    s_waitcnt lgkmcnt(3)
    v_mfma_f32_32x32x16_bf16 v[16:31], v[252:255], v[176:179], v[16:31]
    ds_read_b128 v[252:255], v7 offset:31744
    s_waitcnt lgkmcnt(3)
    v_mfma_f32_32x32x16_bf16 v[52:67], v[32:35], v[176:179], v[52:67]
    ds_read_b128 v[32:35], v7 offset:32768
    s_waitcnt lgkmcnt(3)
    v_mfma_f32_32x32x16_bf16 v[68:83], v[84:87], v[176:179], v[68:83]
    ds_read_b128 v[84:87], v7 offset:33792
    ds_read_b128 v[164:167], v9 offset:0
    ds_read_b128 v[168:171], v9 offset:16
    s_waitcnt lgkmcnt(5)
    v_mfma_f32_32x32x16_bf16 v[16:31], v[88:91], v[180:183], v[16:31]
    ds_read_b128 v[88:91], v7 offset:34816
    ds_read_b128 v[172:175], v9 offset:32
    ds_read_b128 v[176:179], v9 offset:48
    s_waitcnt lgkmcnt(7)
    v_mfma_f32_32x32x16_bf16 v[52:67], v[252:255], v[180:183], v[52:67]
    ds_read_b128 v[252:255], v7 offset:35840
    buffer_load_dwordx4 v[144:147], v2, s[36:39], s54 offen offset:16
    s_waitcnt lgkmcnt(7)
    v_mfma_f32_32x32x16_bf16 v[68:83], v[32:35], v[180:183], v[68:83]
    ds_read_b128 v[32:35], v6 offset:0
    s_waitcnt lgkmcnt(7)
    v_mfma_f32_32x32x16_bf16 v[16:31], v[84:87], v[184:187], v[16:31]
    ds_read_b128 v[84:87], v6 offset:3072
    s_waitcnt lgkmcnt(5)
    v_mfma_f32_32x32x16_bf16 v[52:67], v[88:91], v[184:187], v[52:67]
    ds_read_b128 v[88:91], v6 offset:6144
    s_lshl_b32 s9, s63, 10
    v_add_u32 v180, s9, v6
    v_add_u32 v181, s9, v7
    s_waitcnt lgkmcnt(3)
    v_mfma_f32_32x32x16_bf16 v[68:83], v[252:255], v[184:187], v[68:83]
    ds_read_b128 v[252:255], v6 offset:9216
    s_lshl_b32 s9, s63, 7
    v_add_u32 v182, s9, v9
    s_setprio 2
    s_waitcnt lgkmcnt(3)
    v_mfma_f32_32x32x16_bf16 v[164:179], v[32:35], v[188:191], v[164:179]
    ds_read_b128 v[32:35], v6 offset:12288
    s_waitcnt lgkmcnt(3)
    v_mfma_f32_32x32x16_bf16 v[164:179], v[84:87], v[192:195], v[164:179]
    ds_read_b128 v[84:87], v6 offset:15360
    s_waitcnt vmcnt(13)
    v_lshlrev_b32_e64 v12, 16, v92
    v_and_b32 v13, 0xffff0000, v92
    v_add_f32 v12, v12, v16
    v_add_f32_e64 v13, v13, v17
    s_waitcnt lgkmcnt(3)
    v_mfma_f32_32x32x16_bf16 v[164:179], v[88:91], v[196:199], v[164:179]
    ds_read_b128 v[88:91], v6 offset:18432
    v_cvt_pk_bf16_f32 v16, v12, v13
    v_lshlrev_b32_e64 v14, 16, v93
    v_and_b32 v15, 0xffff0000, v93
    v_add_f32 v14, v14, v18
    s_waitcnt lgkmcnt(3)
    v_mfma_f32_32x32x16_bf16 v[164:179], v[252:255], v[200:203], v[164:179]
    ds_read_b128 v[252:255], v6 offset:21504
    v_add_f32_e64 v15, v15, v19
    v_cvt_pk_bf16_f32 v17, v14, v15
    v_lshlrev_b32_e64 v12, 16, v94
    v_and_b32 v13, 0xffff0000, v94
    s_waitcnt lgkmcnt(3)
    v_mfma_f32_32x32x16_bf16 v[164:179], v[32:35], v[204:207], v[164:179]
    ds_read_b128 v[32:35], v6 offset:24576
    v_add_f32 v12, v12, v20
    v_add_f32_e64 v13, v13, v21
    v_cvt_pk_bf16_f32 v18, v12, v13
    v_lshlrev_b32 v14, 16, v95
    s_waitcnt lgkmcnt(3)
    v_mfma_f32_32x32x16_bf16 v[164:179], v[84:87], v[208:211], v[164:179]
    ds_read_b128 v[84:87], v6 offset:27648
    v_and_b32 v15, 0xffff0000, v95
    v_add_f32 v14, v14, v22
    v_add_f32 v15, v15, v23
    v_cvt_pk_bf16_f32 v19, v14, v15
    s_waitcnt lgkmcnt(3)
    v_mfma_f32_32x32x16_bf16 v[164:179], v[88:91], v[212:215], v[164:179]
    ds_read_b128 v[88:91], v6 offset:30720
    ds_write_b128 v3, v[16:19] offset:0
    s_waitcnt lgkmcnt(4)
    v_mfma_f32_32x32x16_bf16 v[164:179], v[252:255], v[216:219], v[164:179]
    ds_read_b128 v[252:255], v6 offset:33792
    s_waitcnt vmcnt(12)
    v_lshlrev_b32 v12, 16, v96
    v_and_b32 v13, 0xffff0000, v96
    v_add_f32 v12, v12, v24
    v_add_f32_e64 v13, v13, v25
    s_waitcnt lgkmcnt(4)
    v_mfma_f32_32x32x16_bf16 v[164:179], v[32:35], v[220:223], v[164:179]
    ds_read_b128 v[32:35], v7 offset:0
    v_cvt_pk_bf16_f32 v20, v12, v13
    v_lshlrev_b32_e64 v14, 16, v97
    v_and_b32 v15, 0xffff0000, v97
    v_add_f32 v14, v14, v26
    s_waitcnt lgkmcnt(4)
    v_mfma_f32_32x32x16_bf16 v[164:179], v[84:87], v[224:227], v[164:179]
    ds_read_b128 v[84:87], v7 offset:3072
    v_add_f32_e64 v15, v15, v27
    v_cvt_pk_bf16_f32 v21, v14, v15
    v_lshlrev_b32_e64 v12, 16, v98
    v_and_b32 v13, 0xffff0000, v98
    s_waitcnt lgkmcnt(4)
    v_mfma_f32_32x32x16_bf16 v[164:179], v[88:91], v[228:231], v[164:179]
    ds_read_b128 v[88:91], v7 offset:6144
    v_add_f32 v12, v12, v28
    v_add_f32_e64 v13, v13, v29
    v_cvt_pk_bf16_f32 v22, v12, v13
    v_lshlrev_b32 v14, 16, v99
    s_waitcnt lgkmcnt(3)
    v_mfma_f32_32x32x16_bf16 v[164:179], v[252:255], v[232:235], v[164:179]
    ds_read_b128 v[252:255], v7 offset:9216
    v_and_b32 v15, 0xffff0000, v99
    v_add_f32 v14, v14, v30
    v_add_f32 v15, v15, v31
    v_cvt_pk_bf16_f32 v23, v14, v15
    s_waitcnt lgkmcnt(3)
    v_mfma_f32_32x32x16_bf16 v[164:179], v[32:35], v[236:239], v[164:179]
    ds_read_b128 v[32:35], v7 offset:12288
    ds_write_b128 v4, v[20:23] offset:0
    ds_read_b128 v[24:27], v11 offset:0
    ds_read_b128 v[28:31], v11 offset:1024
    s_waitcnt lgkmcnt(6)
    v_mfma_f32_32x32x16_bf16 v[164:179], v[84:87], v[240:243], v[164:179]
    ds_read_b128 v[84:87], v7 offset:15360
    s_waitcnt vmcnt(11)
    v_lshlrev_b32 v12, 16, v100
    v_and_b32 v13, 0xffff0000, v100
    v_add_f32 v12, v12, v52
    v_add_f32_e64 v13, v13, v53
    s_waitcnt lgkmcnt(6)
    v_mfma_f32_32x32x16_bf16 v[164:179], v[88:91], v[244:247], v[164:179]
    ds_read_b128 v[88:91], v7 offset:18432
    v_cvt_pk_bf16_f32 v52, v12, v13
    v_lshlrev_b32_e64 v14, 16, v101
    v_and_b32 v15, 0xffff0000, v101
    v_add_f32 v14, v14, v54
    s_waitcnt lgkmcnt(6)
    v_mfma_f32_32x32x16_bf16 v[164:179], v[252:255], v[248:251], v[164:179]
    ds_read_b128 v[252:255], v7 offset:21504
    v_add_f32_e64 v15, v15, v55
    v_cvt_pk_bf16_f32 v53, v14, v15
    v_lshlrev_b32_e64 v12, 16, v102
    v_and_b32 v13, 0xffff0000, v102
    s_waitcnt lgkmcnt(6)
    v_mfma_f32_32x32x16_bf16 v[164:179], v[32:35], v[148:151], v[164:179]
    ds_read_b128 v[32:35], v7 offset:24576
    s_waitcnt lgkmcnt(5)
    buffer_store_dwordx4 v[24:27], v8, s[48:51], s52 offen offset:0 sc1 nt
    v_add_f32 v12, v12, v56
    v_add_f32 v13, v13, v57
    v_cvt_pk_bf16_f32 v54, v12, v13
    v_lshlrev_b32 v14, 16, v103
    s_waitcnt lgkmcnt(3)
    v_mfma_f32_32x32x16_bf16 v[164:179], v[84:87], v[152:155], v[164:179]
    ds_read_b128 v[84:87], v7 offset:27648
    buffer_store_dwordx4 v[28:31], v8, s[48:51], s52 offen offset:768 sc1 nt
    v_and_b32 v15, 0xffff0000, v103
    v_add_f32 v14, v14, v58
    v_add_f32 v15, v15, v59
    v_cvt_pk_bf16_f32 v55, v14, v15
    s_waitcnt lgkmcnt(3)
    v_mfma_f32_32x32x16_bf16 v[164:179], v[88:91], v[156:159], v[164:179]
    ds_read_b128 v[88:91], v7 offset:30720
    ds_write_b128 v3, v[52:55] offset:2048
    s_waitcnt lgkmcnt(4)
    v_mfma_f32_32x32x16_bf16 v[164:179], v[252:255], v[160:163], v[164:179]
    ds_read_b128 v[252:255], v7 offset:33792
    s_waitcnt vmcnt(12)
    v_lshlrev_b32 v12, 16, v104
    v_and_b32 v13, 0xffff0000, v104
    v_add_f32 v12, v12, v60
    v_add_f32 v13, v13, v61
    ds_read_b128 v[16:19], v9 offset:128
    ds_read_b128 v[20:23], v9 offset:144
    s_waitcnt lgkmcnt(6)
    v_mfma_f32_32x32x16_bf16 v[164:179], v[32:35], v[36:39], v[164:179]
    ds_read_b128 v[32:35], v6 offset:1024
    v_cvt_pk_bf16_f32 v56, v12, v13
    v_lshlrev_b32 v14, 16, v105
    v_and_b32 v15, 0xffff0000, v105
    v_add_f32_e64 v14, v14, v62
    ds_read_b128 v[24:27], v9 offset:160
    ds_read_b128 v[28:31], v9 offset:176
    s_waitcnt lgkmcnt(8)
    v_mfma_f32_32x32x16_bf16 v[164:179], v[84:87], v[40:43], v[164:179]
    ds_read_b128 v[84:87], v6 offset:4096
    v_add_f32 v15, v15, v63
    v_cvt_pk_bf16_f32 v57, v14, v15
    v_lshlrev_b32_e64 v12, 16, v106
    v_and_b32 v13, 0xffff0000, v106
    s_waitcnt lgkmcnt(8)
    v_mfma_f32_32x32x16_bf16 v[164:179], v[88:91], v[44:47], v[164:179]
    ds_read_b128 v[88:91], v6 offset:7168
    v_add_f32 v12, v12, v64
    v_add_f32_e64 v13, v13, v65
    v_cvt_pk_bf16_f32 v58, v12, v13
    v_lshlrev_b32 v14, 16, v107
    s_waitcnt lgkmcnt(7)
    v_mfma_f32_32x32x16_bf16 v[164:179], v[252:255], v[48:51], v[164:179]
    ds_read_b128 v[252:255], v6 offset:10240
    v_and_b32 v15, 0xffff0000, v107
    v_add_f32 v14, v14, v66
    v_add_f32 v15, v15, v67
    v_cvt_pk_bf16_f32 v59, v14, v15
    s_waitcnt lgkmcnt(3)
    v_mfma_f32_32x32x16_bf16 v[16:31], v[32:35], v[188:191], v[16:31]
    ds_read_b128 v[32:35], v6 offset:13312
    ds_write_b128 v4, v[56:59] offset:2048
    ds_read_b128 v[60:63], v11 offset:2048
    ds_read_b128 v[64:67], v11 offset:3072
    s_waitcnt lgkmcnt(6)
    v_mfma_f32_32x32x16_bf16 v[16:31], v[84:87], v[192:195], v[16:31]
    ds_read_b128 v[84:87], v6 offset:16384
    s_waitcnt vmcnt(11)
    v_lshlrev_b32 v12, 16, v108
    v_and_b32 v13, 0xffff0000, v108
    v_add_f32 v12, v12, v68
    v_add_f32_e64 v13, v13, v69
    s_waitcnt lgkmcnt(6)
    v_mfma_f32_32x32x16_bf16 v[16:31], v[88:91], v[196:199], v[16:31]
    ds_read_b128 v[88:91], v6 offset:19456
    v_cvt_pk_bf16_f32 v68, v12, v13
    v_lshlrev_b32_e64 v14, 16, v109
    v_and_b32 v15, 0xffff0000, v109
    v_add_f32 v14, v14, v70
    s_waitcnt lgkmcnt(6)
    v_mfma_f32_32x32x16_bf16 v[16:31], v[252:255], v[200:203], v[16:31]
    ds_read_b128 v[252:255], v6 offset:22528
    v_add_f32_e64 v15, v15, v71
    v_cvt_pk_bf16_f32 v69, v14, v15
    v_lshlrev_b32_e64 v12, 16, v110
    v_and_b32 v13, 0xffff0000, v110
    s_waitcnt lgkmcnt(6)
    v_mfma_f32_32x32x16_bf16 v[16:31], v[32:35], v[204:207], v[16:31]
    ds_read_b128 v[32:35], v6 offset:25600
    s_waitcnt lgkmcnt(5)
    buffer_store_dwordx4 v[60:63], v8, s[48:51], s52 offen offset:64 sc1 nt
    v_add_f32 v12, v12, v72
    v_add_f32 v13, v13, v73
    v_cvt_pk_bf16_f32 v70, v12, v13
    v_lshlrev_b32 v14, 16, v111
    s_waitcnt lgkmcnt(3)
    v_mfma_f32_32x32x16_bf16 v[16:31], v[84:87], v[208:211], v[16:31]
    ds_read_b128 v[84:87], v6 offset:28672
    buffer_store_dwordx4 v[64:67], v8, s[48:51], s52 offen offset:832 sc1 nt
    v_and_b32 v15, 0xffff0000, v111
    v_add_f32 v14, v14, v74
    v_add_f32 v15, v15, v75
    v_cvt_pk_bf16_f32 v71, v14, v15
    s_waitcnt lgkmcnt(3)
    v_mfma_f32_32x32x16_bf16 v[16:31], v[88:91], v[212:215], v[16:31]
    ds_read_b128 v[88:91], v6 offset:31744
    ds_write_b128 v3, v[68:71] offset:0
    s_waitcnt lgkmcnt(4)
    v_mfma_f32_32x32x16_bf16 v[16:31], v[252:255], v[216:219], v[16:31]
    ds_read_b128 v[252:255], v6 offset:34816
    s_waitcnt vmcnt(12)
    v_lshlrev_b32 v12, 16, v112
    v_and_b32 v13, 0xffff0000, v112
    v_add_f32 v12, v12, v76
    v_add_f32_e64 v13, v13, v77
    s_waitcnt lgkmcnt(4)
    v_mfma_f32_32x32x16_bf16 v[16:31], v[32:35], v[220:223], v[16:31]
    ds_read_b128 v[32:35], v7 offset:1024
    v_cvt_pk_bf16_f32 v72, v12, v13
    v_lshlrev_b32_e64 v14, 16, v113
    v_and_b32 v15, 0xffff0000, v113
    v_add_f32 v14, v14, v78
    s_waitcnt lgkmcnt(4)
    v_mfma_f32_32x32x16_bf16 v[16:31], v[84:87], v[224:227], v[16:31]
    ds_read_b128 v[84:87], v7 offset:4096
    v_add_f32_e64 v15, v15, v79
    v_cvt_pk_bf16_f32 v73, v14, v15
    v_lshlrev_b32_e64 v12, 16, v114
    v_and_b32 v13, 0xffff0000, v114
    s_waitcnt lgkmcnt(4)
    v_mfma_f32_32x32x16_bf16 v[16:31], v[88:91], v[228:231], v[16:31]
    ds_read_b128 v[88:91], v7 offset:7168
    v_add_f32 v12, v12, v80
    v_add_f32_e64 v13, v13, v81
    v_cvt_pk_bf16_f32 v74, v12, v13
    v_lshlrev_b32 v14, 16, v115
    s_waitcnt lgkmcnt(3)
    v_mfma_f32_32x32x16_bf16 v[16:31], v[252:255], v[232:235], v[16:31]
    ds_read_b128 v[252:255], v7 offset:10240
    v_and_b32 v15, 0xffff0000, v115
    v_add_f32 v14, v14, v82
    v_add_f32 v15, v15, v83
    v_cvt_pk_bf16_f32 v75, v14, v15
    s_setprio 1
    s_waitcnt lgkmcnt(3)
    v_mfma_f32_32x32x16_bf16 v[16:31], v[32:35], v[236:239], v[16:31]
    ds_read_b128 v[32:35], v7 offset:13312
    ds_write_b128 v4, v[72:75] offset:0
    ds_read_b128 v[76:79], v11 offset:0
    ds_read_b128 v[80:83], v11 offset:1024
    s_waitcnt lgkmcnt(6)
    v_mfma_f32_32x32x16_bf16 v[16:31], v[84:87], v[240:243], v[16:31]
    ds_read_b128 v[84:87], v7 offset:16384
    s_waitcnt vmcnt(11)
    v_lshlrev_b32_e64 v12, 16, v116
    v_and_b32 v13, 0xffff0000, v116
    v_add_f32 v12, v12, v164
    v_add_f32_e64 v13, v13, v165
    s_waitcnt lgkmcnt(6)
    v_mfma_f32_32x32x16_bf16 v[16:31], v[88:91], v[244:247], v[16:31]
    ds_read_b128 v[88:91], v7 offset:19456
    v_cvt_pk_bf16_f32 v164, v12, v13
    v_lshlrev_b32_e64 v14, 16, v117
    v_and_b32 v15, 0xffff0000, v117
    v_add_f32 v14, v14, v166
    s_waitcnt lgkmcnt(6)
    v_mfma_f32_32x32x16_bf16 v[16:31], v[252:255], v[248:251], v[16:31]
    ds_read_b128 v[252:255], v7 offset:22528
    v_add_f32_e64 v15, v15, v167
    v_cvt_pk_bf16_f32 v165, v14, v15
    v_lshlrev_b32_e64 v12, 16, v118
    v_and_b32 v13, 0xffff0000, v118
    s_waitcnt lgkmcnt(6)
    v_mfma_f32_32x32x16_bf16 v[16:31], v[32:35], v[148:151], v[16:31]
    ds_read_b128 v[32:35], v7 offset:25600
    s_waitcnt lgkmcnt(5)
    buffer_store_dwordx4 v[76:79], v8, s[48:51], s52 offen offset:128 sc1 nt
    v_add_f32 v12, v12, v168
    v_add_f32 v13, v13, v169
    v_cvt_pk_bf16_f32 v166, v12, v13
    v_lshlrev_b32 v14, 16, v119
    s_waitcnt lgkmcnt(3)
    v_mfma_f32_32x32x16_bf16 v[16:31], v[84:87], v[152:155], v[16:31]
    ds_read_b128 v[84:87], v7 offset:28672
    buffer_store_dwordx4 v[80:83], v8, s[48:51], s52 offen offset:896 sc1 nt
    v_and_b32 v15, 0xffff0000, v119
    v_add_f32 v14, v14, v170
    v_add_f32 v15, v15, v171
    v_cvt_pk_bf16_f32 v167, v14, v15
    s_waitcnt lgkmcnt(3)
    v_mfma_f32_32x32x16_bf16 v[16:31], v[88:91], v[156:159], v[16:31]
    ds_read_b128 v[88:91], v7 offset:31744
    ds_write_b128 v3, v[164:167] offset:2048
    s_waitcnt lgkmcnt(4)
    v_mfma_f32_32x32x16_bf16 v[16:31], v[252:255], v[160:163], v[16:31]
    ds_read_b128 v[252:255], v7 offset:34816
    s_waitcnt vmcnt(12)
    v_lshlrev_b32 v12, 16, v120
    v_and_b32 v13, 0xffff0000, v120
    v_add_f32 v12, v12, v172
    v_add_f32 v13, v13, v173
    ds_read_b128 v[52:55], v9 offset:256
    ds_read_b128 v[56:59], v9 offset:272
    s_waitcnt lgkmcnt(6)
    v_mfma_f32_32x32x16_bf16 v[16:31], v[32:35], v[36:39], v[16:31]
    ds_read_b128 v[32:35], v6 offset:2048
    v_cvt_pk_bf16_f32 v168, v12, v13
    v_lshlrev_b32 v14, 16, v121
    v_and_b32 v15, 0xffff0000, v121
    v_add_f32_e64 v14, v14, v174
    ds_read_b128 v[60:63], v9 offset:288
    ds_read_b128 v[64:67], v9 offset:304
    s_waitcnt lgkmcnt(8)
    v_mfma_f32_32x32x16_bf16 v[16:31], v[84:87], v[40:43], v[16:31]
    ds_read_b128 v[84:87], v6 offset:5120
    v_add_f32 v15, v15, v175
    v_cvt_pk_bf16_f32 v169, v14, v15
    v_lshlrev_b32_e64 v12, 16, v122
    v_and_b32 v13, 0xffff0000, v122
    s_waitcnt lgkmcnt(8)
    v_mfma_f32_32x32x16_bf16 v[16:31], v[88:91], v[44:47], v[16:31]
    ds_read_b128 v[88:91], v6 offset:8192
    v_add_f32 v12, v12, v176
    v_add_f32_e64 v13, v13, v177
    v_cvt_pk_bf16_f32 v170, v12, v13
    v_lshlrev_b32 v14, 16, v123
    s_waitcnt lgkmcnt(7)
    v_mfma_f32_32x32x16_bf16 v[16:31], v[252:255], v[48:51], v[16:31]
    ds_read_b128 v[252:255], v6 offset:11264
    v_and_b32 v15, 0xffff0000, v123
    v_add_f32 v14, v14, v178
    v_add_f32 v15, v15, v179
    v_cvt_pk_bf16_f32 v171, v14, v15
    s_waitcnt lgkmcnt(3)
    v_mfma_f32_32x32x16_bf16 v[52:67], v[32:35], v[188:191], v[52:67]
    ds_read_b128 v[32:35], v6 offset:14336
    ds_write_b128 v4, v[168:171] offset:2048
    ds_read_b128 v[172:175], v11 offset:2048
    ds_read_b128 v[176:179], v11 offset:3072
    s_waitcnt lgkmcnt(6)
    v_mfma_f32_32x32x16_bf16 v[52:67], v[84:87], v[192:195], v[52:67]
    ds_read_b128 v[84:87], v6 offset:17408
    s_waitcnt lgkmcnt(6)
    v_mfma_f32_32x32x16_bf16 v[52:67], v[88:91], v[196:199], v[52:67]
    ds_read_b128 v[88:91], v6 offset:20480
    s_waitcnt vmcnt(11)
    v_lshlrev_b32_e64 v12, 16, v124
    v_and_b32 v13, 0xffff0000, v124
    v_add_f32 v12, v12, v16
    v_add_f32_e64 v13, v13, v17
    s_waitcnt lgkmcnt(6)
    v_mfma_f32_32x32x16_bf16 v[52:67], v[252:255], v[200:203], v[52:67]
    ds_read_b128 v[252:255], v6 offset:23552
    v_cvt_pk_bf16_f32 v16, v12, v13
    v_lshlrev_b32_e64 v14, 16, v125
    v_and_b32 v15, 0xffff0000, v125
    v_add_f32 v14, v14, v18
    s_waitcnt lgkmcnt(6)
    v_mfma_f32_32x32x16_bf16 v[52:67], v[32:35], v[204:207], v[52:67]
    ds_read_b128 v[32:35], v6 offset:26624
    s_waitcnt lgkmcnt(5)
    buffer_store_dwordx4 v[172:175], v8, s[48:51], s53 offen offset:0 sc1 nt
    v_add_f32 v15, v15, v19
    v_cvt_pk_bf16_f32 v17, v14, v15
    v_lshlrev_b32_e64 v12, 16, v126
    v_and_b32 v13, 0xffff0000, v126
    s_waitcnt lgkmcnt(3)
    v_mfma_f32_32x32x16_bf16 v[52:67], v[84:87], v[208:211], v[52:67]
    ds_read_b128 v[84:87], v6 offset:29696
    buffer_store_dwordx4 v[176:179], v8, s[48:51], s53 offen offset:768 sc1 nt
    v_add_f32 v12, v12, v20
    v_add_f32_e64 v13, v13, v21
    v_cvt_pk_bf16_f32 v18, v12, v13
    v_lshlrev_b32 v14, 16, v127
    s_waitcnt lgkmcnt(3)
    v_mfma_f32_32x32x16_bf16 v[52:67], v[88:91], v[212:215], v[52:67]
    ds_read_b128 v[88:91], v6 offset:32768
    v_and_b32 v15, 0xffff0000, v127
    v_add_f32 v14, v14, v22
    v_add_f32 v15, v15, v23
    v_cvt_pk_bf16_f32 v19, v14, v15
    s_waitcnt lgkmcnt(3)
    v_mfma_f32_32x32x16_bf16 v[52:67], v[252:255], v[216:219], v[52:67]
    ds_read_b128 v[252:255], v6 offset:35840
    ds_write_b128 v3, v[16:19] offset:0
    s_waitcnt lgkmcnt(4)
    v_mfma_f32_32x32x16_bf16 v[52:67], v[32:35], v[220:223], v[52:67]
    ds_read_b128 v[32:35], v7 offset:2048
    s_waitcnt vmcnt(12)
    v_lshlrev_b32 v12, 16, v128
    v_and_b32 v13, 0xffff0000, v128
    v_add_f32 v12, v12, v24
    v_add_f32_e64 v13, v13, v25
    s_waitcnt lgkmcnt(4)
    v_mfma_f32_32x32x16_bf16 v[52:67], v[84:87], v[224:227], v[52:67]
    ds_read_b128 v[84:87], v7 offset:5120
    v_cvt_pk_bf16_f32 v20, v12, v13
    v_lshlrev_b32_e64 v14, 16, v129
    v_and_b32 v15, 0xffff0000, v129
    v_add_f32 v14, v14, v26
    s_waitcnt lgkmcnt(4)
    v_mfma_f32_32x32x16_bf16 v[52:67], v[88:91], v[228:231], v[52:67]
    ds_read_b128 v[88:91], v7 offset:8192
    v_add_f32_e64 v15, v15, v27
    v_cvt_pk_bf16_f32 v21, v14, v15
    v_lshlrev_b32_e64 v12, 16, v130
    v_and_b32 v13, 0xffff0000, v130
    s_waitcnt lgkmcnt(4)
    v_mfma_f32_32x32x16_bf16 v[52:67], v[252:255], v[232:235], v[52:67]
    ds_read_b128 v[252:255], v7 offset:11264
    v_add_f32 v12, v12, v28
    v_add_f32_e64 v13, v13, v29
    v_cvt_pk_bf16_f32 v22, v12, v13
    v_lshlrev_b32 v14, 16, v131
    s_waitcnt lgkmcnt(3)
    v_mfma_f32_32x32x16_bf16 v[52:67], v[32:35], v[236:239], v[52:67]
    ds_read_b128 v[32:35], v7 offset:14336
    v_and_b32 v15, 0xffff0000, v131
    v_add_f32 v14, v14, v30
    v_add_f32 v15, v15, v31
    v_cvt_pk_bf16_f32 v23, v14, v15
    s_waitcnt lgkmcnt(3)
    v_mfma_f32_32x32x16_bf16 v[52:67], v[84:87], v[240:243], v[52:67]
    ds_read_b128 v[84:87], v7 offset:17408
    ds_write_b128 v4, v[20:23] offset:0
    ds_read_b128 v[24:27], v11 offset:0
    ds_read_b128 v[28:31], v11 offset:1024
    s_waitcnt lgkmcnt(6)
    v_mfma_f32_32x32x16_bf16 v[52:67], v[88:91], v[244:247], v[52:67]
    ds_read_b128 v[88:91], v7 offset:20480
    s_waitcnt lgkmcnt(6)
    v_mfma_f32_32x32x16_bf16 v[52:67], v[252:255], v[248:251], v[52:67]
    ds_read_b128 v[252:255], v7 offset:23552
    s_waitcnt lgkmcnt(6)
    v_mfma_f32_32x32x16_bf16 v[52:67], v[32:35], v[148:151], v[52:67]
    ds_read_b128 v[32:35], v7 offset:26624
    s_waitcnt lgkmcnt(6)
    v_mfma_f32_32x32x16_bf16 v[52:67], v[84:87], v[152:155], v[52:67]
    ds_read_b128 v[84:87], v7 offset:29696
    s_waitcnt lgkmcnt(5)
    buffer_store_dwordx4 v[24:27], v8, s[48:51], s53 offen offset:64 sc1 nt
    s_waitcnt lgkmcnt(3)
    v_mfma_f32_32x32x16_bf16 v[52:67], v[88:91], v[156:159], v[52:67]
    ds_read_b128 v[88:91], v7 offset:32768
    buffer_store_dwordx4 v[28:31], v8, s[48:51], s53 offen offset:832 sc1 nt
    s_waitcnt lgkmcnt(3)
    v_mfma_f32_32x32x16_bf16 v[52:67], v[252:255], v[160:163], v[52:67]
    ds_read_b128 v[252:255], v7 offset:35840
    ds_read_b128 v[68:71], v182 offset:0
    ds_read_b128 v[72:75], v182 offset:16
    s_waitcnt lgkmcnt(5)
    s_nop 0
    v_mfma_f32_32x32x16_bf16 v[52:67], v[32:35], v[36:39], v[52:67]
    ds_read_b128 v[32:35], v180 offset:0
    ds_read_b64_tr_b16 v[92:93], v5 offset:0
    ds_read_b64_tr_b16 v[94:95], v5 offset:512
    ds_read_b128 v[76:79], v182 offset:32
    ds_read_b128 v[80:83], v182 offset:48
    s_setprio 0
    s_waitcnt lgkmcnt(9)
    v_mfma_f32_32x32x16_bf16 v[52:67], v[84:87], v[40:43], v[52:67]
    ds_read_b128 v[84:87], v180 offset:3072
    ds_read_b64_tr_b16 v[96:97], v5 offset:1024
    ds_read_b64_tr_b16 v[98:99], v5 offset:1536
    s_waitcnt lgkmcnt(11)
    v_mfma_f32_32x32x16_bf16 v[52:67], v[88:91], v[44:47], v[52:67]
    ds_read_b128 v[88:91], v180 offset:6144
    ds_read_b64_tr_b16 v[100:101], v5 offset:2048
    ds_read_b64_tr_b16 v[102:103], v5 offset:2560
    s_waitcnt lgkmcnt(13)
    v_mfma_f32_32x32x16_bf16 v[52:67], v[252:255], v[48:51], v[52:67]
    ds_read_b128 v[252:255], v180 offset:9216
    ds_read_b64_tr_b16 v[104:105], v5 offset:3072
    s_waitcnt lgkmcnt(14)
    ds_read_b64_tr_b16 v[106:107], v5 offset:3584
    s_cmp_ge_u32 s3, 6
    s_cbranch_scc1 L_noshare
    s_waitcnt lgkmcnt(9)
    v_mfma_f32_32x32x16_bf16 v[68:83], v[32:35], v[92:95], v[68:83]
    ds_read_b128 v[32:35], v180 offset:12288
    ds_read_b64_tr_b16 v[92:93], v5 offset:4096
    ds_read_b64_tr_b16 v[94:95], v5 offset:4608
    s_waitcnt lgkmcnt(9)
    v_mfma_f32_32x32x16_bf16 v[68:83], v[84:87], v[96:99], v[68:83]
    ds_read_b128 v[84:87], v180 offset:15360
    ds_read_b64_tr_b16 v[96:97], v5 offset:5120
    ds_read_b64_tr_b16 v[98:99], v5 offset:5632
    s_waitcnt lgkmcnt(9)
    v_mfma_f32_32x32x16_bf16 v[68:83], v[88:91], v[100:103], v[68:83]
    ds_read_b128 v[88:91], v180 offset:18432
    ds_read_b64_tr_b16 v[100:101], v5 offset:6144
    ds_read_b64_tr_b16 v[102:103], v5 offset:6656
    s_waitcnt vmcnt(13)
    v_lshlrev_b32 v12, 16, v132
    v_and_b32 v13, 0xffff0000, v132
    v_add_f32 v12, v12, v52
    v_add_f32_e64 v13, v13, v53
    s_waitcnt lgkmcnt(9)
    v_mfma_f32_32x32x16_bf16 v[68:83], v[252:255], v[104:107], v[68:83]
    ds_read_b128 v[252:255], v180 offset:21504
    ds_read_b64_tr_b16 v[104:105], v5 offset:7168
    ds_read_b64_tr_b16 v[106:107], v5 offset:7680
    v_cvt_pk_bf16_f32 v52, v12, v13
    v_lshlrev_b32_e64 v14, 16, v133
    v_and_b32 v15, 0xffff0000, v133
    v_add_f32 v14, v14, v54
    s_waitcnt lgkmcnt(9)
    v_mfma_f32_32x32x16_bf16 v[68:83], v[32:35], v[92:95], v[68:83]
    ds_read_b128 v[32:35], v180 offset:24576
    ds_read_b64_tr_b16 v[92:93], v5 offset:8192
    ds_read_b64_tr_b16 v[94:95], v5 offset:8704
    v_add_f32_e64 v15, v15, v55
    v_cvt_pk_bf16_f32 v53, v14, v15
    v_lshlrev_b32_e64 v12, 16, v134
    v_and_b32 v13, 0xffff0000, v134
    s_waitcnt lgkmcnt(9)
    v_mfma_f32_32x32x16_bf16 v[68:83], v[84:87], v[96:99], v[68:83]
    ds_read_b128 v[84:87], v180 offset:27648
    ds_read_b64_tr_b16 v[96:97], v5 offset:9216
    ds_read_b64_tr_b16 v[98:99], v5 offset:9728
    v_add_f32 v12, v12, v56
    v_add_f32_e64 v13, v13, v57
    v_cvt_pk_bf16_f32 v54, v12, v13
    v_lshlrev_b32 v14, 16, v135
    s_waitcnt lgkmcnt(9)
    v_mfma_f32_32x32x16_bf16 v[68:83], v[88:91], v[100:103], v[68:83]
    ds_read_b128 v[88:91], v180 offset:30720
    ds_read_b64_tr_b16 v[100:101], v5 offset:10240
    ds_read_b64_tr_b16 v[102:103], v5 offset:10752
    v_and_b32 v15, 0xffff0000, v135
    v_add_f32 v14, v14, v58
    v_add_f32 v15, v15, v59
    v_cvt_pk_bf16_f32 v55, v14, v15
    s_waitcnt lgkmcnt(9)
    v_mfma_f32_32x32x16_bf16 v[68:83], v[252:255], v[104:107], v[68:83]
    ds_read_b128 v[252:255], v180 offset:33792
    ds_read_b64_tr_b16 v[104:105], v5 offset:11264
    ds_read_b64_tr_b16 v[106:107], v5 offset:11776
    ds_write_b128 v3, v[52:55] offset:2048
    s_waitcnt lgkmcnt(10)
    v_mfma_f32_32x32x16_bf16 v[68:83], v[32:35], v[92:95], v[68:83]
    ds_read_b128 v[32:35], v181 offset:0
    ds_read_b64_tr_b16 v[92:93], v5 offset:12288
    ds_read_b64_tr_b16 v[94:95], v5 offset:12800
    s_waitcnt vmcnt(12)
    v_lshlrev_b32 v12, 16, v136
    v_and_b32 v13, 0xffff0000, v136
    v_add_f32 v12, v12, v60
    v_add_f32_e64 v13, v13, v61
    s_waitcnt lgkmcnt(10)
    v_mfma_f32_32x32x16_bf16 v[68:83], v[84:87], v[96:99], v[68:83]
    ds_read_b128 v[84:87], v181 offset:3072
    ds_read_b64_tr_b16 v[96:97], v5 offset:13312
    ds_read_b64_tr_b16 v[98:99], v5 offset:13824
    v_cvt_pk_bf16_f32 v56, v12, v13
    v_lshlrev_b32_e64 v14, 16, v137
    v_and_b32 v15, 0xffff0000, v137
    v_add_f32 v14, v14, v62
    s_waitcnt lgkmcnt(10)
    v_mfma_f32_32x32x16_bf16 v[68:83], v[88:91], v[100:103], v[68:83]
    ds_read_b128 v[88:91], v181 offset:6144
    ds_read_b64_tr_b16 v[100:101], v5 offset:14336
    ds_read_b64_tr_b16 v[102:103], v5 offset:14848
    v_add_f32_e64 v15, v15, v63
    v_cvt_pk_bf16_f32 v57, v14, v15
    v_lshlrev_b32_e64 v12, 16, v138
    v_and_b32 v13, 0xffff0000, v138
    s_waitcnt lgkmcnt(10)
    v_mfma_f32_32x32x16_bf16 v[68:83], v[252:255], v[104:107], v[68:83]
    ds_read_b128 v[252:255], v181 offset:9216
    ds_read_b64_tr_b16 v[104:105], v5 offset:15360
    ds_read_b64_tr_b16 v[106:107], v5 offset:15872
    v_add_f32 v12, v12, v64
    v_add_f32_e64 v13, v13, v65
    v_cvt_pk_bf16_f32 v58, v12, v13
    v_lshlrev_b32 v14, 16, v139
    s_waitcnt lgkmcnt(9)
    v_mfma_f32_32x32x16_bf16 v[68:83], v[32:35], v[92:95], v[68:83]
    ds_read_b128 v[32:35], v181 offset:12288
    ds_read_b64_tr_b16 v[92:93], v5 offset:16384
    ds_read_b64_tr_b16 v[94:95], v5 offset:16896
    v_and_b32 v15, 0xffff0000, v139
    v_add_f32 v14, v14, v66
    v_add_f32 v15, v15, v67
    v_cvt_pk_bf16_f32 v59, v14, v15
    s_waitcnt lgkmcnt(9)
    s_nop 0
    v_mfma_f32_32x32x16_bf16 v[68:83], v[84:87], v[96:99], v[68:83]
    ds_read_b128 v[84:87], v181 offset:15360
    ds_read_b64_tr_b16 v[96:97], v5 offset:17408
    ds_read_b64_tr_b16 v[98:99], v5 offset:17920
    ds_write_b128 v4, v[56:59] offset:2048
    ds_read_b128 v[60:63], v11 offset:2048
    ds_read_b128 v[64:67], v11 offset:3072
    s_waitcnt lgkmcnt(12)
    v_mfma_f32_32x32x16_bf16 v[68:83], v[88:91], v[100:103], v[68:83]
    ds_read_b128 v[88:91], v181 offset:18432
    ds_read_b64_tr_b16 v[100:101], v5 offset:18432
    ds_read_b64_tr_b16 v[102:103], v5 offset:18944
    s_waitcnt lgkmcnt(12)
    v_mfma_f32_32x32x16_bf16 v[68:83], v[252:255], v[104:107], v[68:83]
    ds_read_b128 v[252:255], v181 offset:21504
    ds_read_b64_tr_b16 v[104:105], v5 offset:19456
    ds_read_b64_tr_b16 v[106:107], v5 offset:19968
    s_waitcnt lgkmcnt(12)
    v_mfma_f32_32x32x16_bf16 v[68:83], v[32:35], v[92:95], v[68:83]
    ds_read_b128 v[32:35], v181 offset:24576
    ds_read_b64_tr_b16 v[92:93], v5 offset:20480
    ds_read_b64_tr_b16 v[94:95], v5 offset:20992
    s_waitcnt lgkmcnt(12)
    v_mfma_f32_32x32x16_bf16 v[68:83], v[84:87], v[96:99], v[68:83]
    ds_read_b128 v[84:87], v181 offset:27648
    ds_read_b64_tr_b16 v[96:97], v5 offset:21504
    ds_read_b64_tr_b16 v[98:99], v5 offset:22016
    s_waitcnt lgkmcnt(13)
    buffer_store_dwordx4 v[60:63], v8, s[48:51], s53 offen offset:128 sc1 nt
    s_waitcnt lgkmcnt(9)
    v_mfma_f32_32x32x16_bf16 v[68:83], v[88:91], v[100:103], v[68:83]
    ds_read_b128 v[88:91], v181 offset:30720
    ds_read_b64_tr_b16 v[100:101], v5 offset:22528
    ds_read_b64_tr_b16 v[102:103], v5 offset:23040
    buffer_store_dwordx4 v[64:67], v8, s[48:51], s53 offen offset:896 sc1 nt
    s_waitcnt lgkmcnt(9)
    v_mfma_f32_32x32x16_bf16 v[68:83], v[252:255], v[104:107], v[68:83]
    ds_read_b128 v[252:255], v181 offset:33792
    ds_read_b64_tr_b16 v[104:105], v5 offset:23552
    ds_read_b64_tr_b16 v[106:107], v5 offset:24064
    s_waitcnt lgkmcnt(9)
    v_mfma_f32_32x32x16_bf16 v[68:83], v[32:35], v[92:95], v[68:83]
    s_waitcnt lgkmcnt(6)
    v_mfma_f32_32x32x16_bf16 v[68:83], v[84:87], v[96:99], v[68:83]
    s_waitcnt lgkmcnt(3)
    v_mfma_f32_32x32x16_bf16 v[68:83], v[88:91], v[100:103], v[68:83]
    s_waitcnt lgkmcnt(0)
    v_mfma_f32_32x32x16_bf16 v[68:83], v[252:255], v[104:107], v[68:83]
    s_waitcnt vmcnt(13)
    v_lshlrev_b32_e64 v12, 16, v140
    v_and_b32 v13, 0xffff0000, v140
    s_nop 8
    v_add_f32 v12, v12, v68
    v_add_f32_e64 v13, v13, v69
    v_cvt_pk_bf16_f32 v68, v12, v13
    v_lshlrev_b32_e64 v14, 16, v141
    v_and_b32 v15, 0xffff0000, v141
    v_add_f32 v14, v14, v70
    v_add_f32 v15, v15, v71
    v_cvt_pk_bf16_f32 v69, v14, v15
    v_lshlrev_b32_e64 v12, 16, v142
    v_and_b32 v13, 0xffff0000, v142
    v_add_f32 v12, v12, v72
    v_add_f32 v13, v13, v73
    v_cvt_pk_bf16_f32 v70, v12, v13
    v_lshlrev_b32_e64 v14, 16, v143
    v_and_b32 v15, 0xffff0000, v143
    v_add_f32 v14, v14, v74
    v_add_f32 v15, v15, v75
    v_cvt_pk_bf16_f32 v71, v14, v15
    ds_write_b128 v3, v[68:71] offset:0
    s_waitcnt vmcnt(12)
    v_lshlrev_b32 v12, 16, v144
    v_and_b32 v13, 0xffff0000, v144
    v_add_f32 v12, v12, v76
    v_add_f32 v13, v13, v77
    v_cvt_pk_bf16_f32 v72, v12, v13
    v_lshlrev_b32_e64 v14, 16, v145
    v_and_b32 v15, 0xffff0000, v145
    v_add_f32 v14, v14, v78
    v_add_f32 v15, v15, v79
    v_cvt_pk_bf16_f32 v73, v14, v15
    v_lshlrev_b32_e64 v12, 16, v146
    v_and_b32 v13, 0xffff0000, v146
    v_add_f32 v12, v12, v80
    v_add_f32 v13, v13, v81
    v_cvt_pk_bf16_f32 v74, v12, v13
    v_lshlrev_b32_e64 v14, 16, v147
    v_and_b32 v15, 0xffff0000, v147
    v_add_f32 v14, v14, v82
    v_add_f32 v15, v15, v83
    v_cvt_pk_bf16_f32 v75, v14, v15
    ds_write_b128 v4, v[72:75] offset:0
    ds_read_b128 v[76:79], v11 offset:0
    ds_read_b128 v[80:83], v11 offset:1024
    s_waitcnt lgkmcnt(1)
    buffer_store_dwordx4 v[76:79], v8, s[48:51], s54 offen offset:0 sc1 nt
    s_waitcnt lgkmcnt(0)
    buffer_store_dwordx4 v[80:83], v8, s[48:51], s54 offen offset:768 sc1 nt
    s_branch L_fin
L_noshare:
    s_waitcnt vmcnt(13)
    v_lshlrev_b32_e64 v12, 16, v132
    v_and_b32 v13, 0xffff0000, v132
    s_nop 2
    v_add_f32 v12, v12, v52
    v_add_f32_e64 v13, v13, v53
    v_cvt_pk_bf16_f32 v52, v12, v13
    v_lshlrev_b32_e64 v14, 16, v133
    v_and_b32 v15, 0xffff0000, v133
    v_add_f32 v14, v14, v54
    v_add_f32 v15, v15, v55
    v_cvt_pk_bf16_f32 v53, v14, v15
    v_lshlrev_b32_e64 v12, 16, v134
    v_and_b32 v13, 0xffff0000, v134
    v_add_f32 v12, v12, v56
    v_add_f32 v13, v13, v57
    v_cvt_pk_bf16_f32 v54, v12, v13
    v_lshlrev_b32_e64 v14, 16, v135
    v_and_b32 v15, 0xffff0000, v135
    v_add_f32 v14, v14, v58
    v_add_f32 v15, v15, v59
    v_cvt_pk_bf16_f32 v55, v14, v15
    s_waitcnt lgkmcnt(14)
    ds_write_b128 v3, v[52:55] offset:2048
    s_waitcnt vmcnt(12)
    v_lshlrev_b32_e64 v12, 16, v136
    v_and_b32 v13, 0xffff0000, v136
    v_add_f32 v12, v12, v60
    v_add_f32 v13, v13, v61
    v_cvt_pk_bf16_f32 v56, v12, v13
    v_lshlrev_b32_e64 v14, 16, v137
    v_and_b32 v15, 0xffff0000, v137
    v_add_f32 v14, v14, v62
    v_add_f32 v15, v15, v63
    v_cvt_pk_bf16_f32 v57, v14, v15
    v_lshlrev_b32_e64 v12, 16, v138
    v_and_b32 v13, 0xffff0000, v138
    v_add_f32 v12, v12, v64
    v_add_f32 v13, v13, v65
    v_cvt_pk_bf16_f32 v58, v12, v13
    v_lshlrev_b32_e64 v14, 16, v139
    v_and_b32 v15, 0xffff0000, v139
    v_add_f32 v14, v14, v66
    v_add_f32 v15, v15, v67
    v_cvt_pk_bf16_f32 v59, v14, v15
    s_waitcnt lgkmcnt(14)
    ds_write_b128 v4, v[56:59] offset:2048
    s_waitcnt lgkmcnt(14)
    ds_read_b128 v[60:63], v11 offset:2048
    s_waitcnt lgkmcnt(14)
    ds_read_b128 v[64:67], v11 offset:3072
    s_waitcnt lgkmcnt(1)
    buffer_store_dwordx4 v[60:63], v8, s[48:51], s53 offen offset:128 sc1 nt
    s_waitcnt lgkmcnt(0)
    buffer_store_dwordx4 v[64:67], v8, s[48:51], s53 offen offset:896 sc1 nt
L_fin:
    s_nop 15
    s_nop 3
L_end:
    s_endpgm
L_slow:
    v_pk_fma_f32 v[16:17], v[36:37], v[36:37], s[34:35]
    v_pk_fma_f32 v[18:19], v[38:39], v[38:39], s[34:35]
    v_pk_fma_f32 v[20:21], v[40:41], v[40:41], s[34:35]
    v_pk_fma_f32 v[22:23], v[42:43], v[42:43], s[34:35]
    v_pk_mul_f32 v[16:17], v[16:17], v[36:37]
    v_pk_mul_f32 v[18:19], v[18:19], v[38:39]
    v_pk_mul_f32 v[20:21], v[20:21], v[40:41]
    v_pk_mul_f32 v[22:23], v[22:23], v[42:43]
    s_setprio 1
    v_mfma_f32_32x32x16_bf16 v[52:67], v[68:71], v[32:35], 0
    v_exp_f32 v16, v16
    v_exp_f32 v17, v17
    v_exp_f32 v18, v18
    v_mfma_f32_32x32x16_bf16 v[52:67], v[72:75], v[252:255], v[52:67]
    v_exp_f32 v19, v19
    v_exp_f32 v20, v20
    v_exp_f32 v21, v21
    v_exp_f32 v22, v22
    v_exp_f32_e64 v23, v23
    v_pk_add_f32 v[16:17], v[16:17], 1.0 op_sel_hi:[1,0]
    v_pk_add_f32 v[18:19], v[18:19], 1.0 op_sel_hi:[1,0]
    v_pk_add_f32 v[20:21], v[20:21], 1.0 op_sel_hi:[1,0]
    v_pk_add_f32 v[22:23], v[22:23], 1.0 op_sel_hi:[1,0]
    ds_read_b128 v[32:35], v6 offset:10240
    ds_read_b128 v[252:255], v6 offset:11264
    v_mfma_f32_32x32x16_bf16 v[52:67], v[76:79], v[24:27], v[52:67]
    v_rcp_f32 v16, v16
    v_rcp_f32 v17, v17
    v_rcp_f32_e64 v18, v18
    v_mfma_f32_32x32x16_bf16 v[52:67], v[80:83], v[28:31], v[52:67]
    v_rcp_f32 v19, v19
    v_rcp_f32 v20, v20
    v_rcp_f32 v21, v21
    v_rcp_f32 v22, v22
    v_rcp_f32_e64 v23, v23
    v_pk_mul_f32 v[16:17], v[16:17], v[36:37]
    v_pk_mul_f32 v[18:19], v[18:19], v[38:39]
    v_pk_mul_f32 v[20:21], v[20:21], v[40:41]
    v_pk_mul_f32 v[22:23], v[22:23], v[42:43]
    v_cvt_pk_bf16_f32 v92, v16, v17
    v_cvt_pk_bf16_f32 v93, v18, v19
    v_cvt_pk_bf16_f32 v94, v20, v21
    v_cvt_pk_bf16_f32 v95, v22, v23
    v_dot2_f32_bf16 v11, v92, v92, 0
    v_dot2_f32_bf16 v11, v93, v93, v11
    v_dot2_f32_bf16 v11, v94, v94, v11
    v_dot2_f32_bf16 v11, v95, v95, v11
    v_pk_fma_f32 v[16:17], v[44:45], v[44:45], s[34:35]
    v_pk_fma_f32 v[18:19], v[46:47], v[46:47], s[34:35]
    v_pk_fma_f32 v[20:21], v[48:49], v[48:49], s[34:35]
    v_pk_fma_f32 v[22:23], v[50:51], v[50:51], s[34:35]
    v_pk_mul_f32 v[16:17], v[16:17], v[44:45]
    v_pk_mul_f32 v[18:19], v[18:19], v[46:47]
    v_pk_mul_f32 v[20:21], v[20:21], v[48:49]
    v_pk_mul_f32 v[22:23], v[22:23], v[50:51]
    s_waitcnt lgkmcnt(0)
    ds_read_b128 v[24:27], v7 offset:0
    ds_read_b128 v[28:31], v7 offset:1024
    v_mfma_f32_32x32x16_bf16 v[52:67], v[84:87], v[32:35], v[52:67]
    v_exp_f32 v16, v16
    v_exp_f32 v17, v17
    v_exp_f32 v18, v18
    v_mfma_f32_32x32x16_bf16 v[52:67], v[88:91], v[252:255], v[52:67]
    v_exp_f32 v19, v19
    v_exp_f32 v20, v20
    v_exp_f32 v21, v21
    v_exp_f32 v22, v22
    v_exp_f32_e64 v23, v23
    v_pk_add_f32 v[16:17], v[16:17], 1.0 op_sel_hi:[1,0]
    v_pk_add_f32 v[18:19], v[18:19], 1.0 op_sel_hi:[1,0]
    v_pk_add_f32 v[20:21], v[20:21], 1.0 op_sel_hi:[1,0]
    v_pk_add_f32 v[22:23], v[22:23], 1.0 op_sel_hi:[1,0]
    ds_read_b128 v[32:35], v7 offset:2048
    ds_read_b128 v[252:255], v7 offset:3072
    v_rcp_f32 v16, v16
    v_rcp_f32 v17, v17
    v_rcp_f32 v18, v18
    v_rcp_f32 v19, v19
    v_rcp_f32 v20, v20
    v_rcp_f32 v21, v21
    v_rcp_f32 v22, v22
    v_rcp_f32 v23, v23
    v_pk_mul_f32 v[16:17], v[16:17], v[44:45]
    v_pk_mul_f32 v[18:19], v[18:19], v[46:47]
    v_pk_mul_f32 v[20:21], v[20:21], v[48:49]
    v_pk_mul_f32 v[22:23], v[22:23], v[50:51]
    v_cvt_pk_bf16_f32 v96, v16, v17
    v_cvt_pk_bf16_f32 v97, v18, v19
    v_cvt_pk_bf16_f32 v98, v20, v21
    v_cvt_pk_bf16_f32 v99, v22, v23
    v_dot2_f32_bf16 v11, v96, v96, v11
    v_dot2_f32_bf16 v11, v97, v97, v11
    v_dot2_f32_bf16 v11, v98, v98, v11
    v_dot2_f32_bf16 v11, v99, v99, v11
    s_cmp_lg_u32 s69, 1
    s_cbranch_scc1 L_skip37
    v_mov_b32 v14, 163536
    s_mov_b32 s10, 0
L_aw38:
    ds_read_b32 v15, v14 offset:20
    s_add_u32 s10, s10, 1
    s_waitcnt lgkmcnt(0)
    v_readfirstlane_b32 s9, v15
    s_lshr_b32 s55, s10, 22
    s_lshl_b32 s55, s55, 3
    s_or_b32 s9, s9, s55
    s_cmp_lt_u32 s9, 4
    s_cbranch_scc1 L_aw38
    s_nop 0
    ds_write_b128 v236, v[108:111] offset:12288
    ds_write_b128 v236, v[112:115] offset:18432
    ds_write_b128 v236, v[116:119] offset:13312
    ds_write_b128 v236, v[120:123] offset:19456
    ds_write_b128 v236, v[156:159] offset:14336
    ds_write_b128 v236, v[160:163] offset:20480
L_skip37:
    s_cmp_lg_u32 s69, 0
    s_cbranch_scc1 L_skip39
    s_add_u32 s9, s63, 0
    s_nop 1
    buffer_store_dwordx4 v[108:111], v6, s[40:43], s9 offen sc1 nt
    s_add_u32 s9, s63, 1024
    buffer_store_dwordx4 v[112:115], v6, s[40:43], s9 offen sc1 nt
    s_add_u32 s9, s63, 2048
    buffer_store_dwordx4 v[116:119], v6, s[40:43], s9 offen sc1 nt
L_skip39:
    v_pk_fma_f32 v[16:17], v[52:53], v[52:53], s[34:35]
    v_pk_fma_f32 v[18:19], v[54:55], v[54:55], s[34:35]
    v_pk_fma_f32 v[20:21], v[56:57], v[56:57], s[34:35]
    v_pk_fma_f32 v[22:23], v[58:59], v[58:59], s[34:35]
    v_pk_mul_f32 v[16:17], v[16:17], v[52:53]
    v_pk_mul_f32 v[18:19], v[18:19], v[54:55]
    v_pk_mul_f32 v[20:21], v[20:21], v[56:57]
    v_pk_mul_f32 v[22:23], v[22:23], v[58:59]
    v_cvt_f64_f32 v[12:13], v11
    s_waitcnt lgkmcnt(0)
    v_mfma_f32_32x32x16_bf16 v[36:51], v[68:71], v[24:27], 0
    v_exp_f32 v16, v16
    v_exp_f32 v17, v17
    v_exp_f32_e64 v18, v18
    v_mfma_f32_32x32x16_bf16 v[36:51], v[72:75], v[28:31], v[36:51]
    v_exp_f32 v19, v19
    v_exp_f32 v20, v20
    v_exp_f32 v21, v21
    v_exp_f32 v22, v22
    v_exp_f32_e64 v23, v23
    v_pk_add_f32 v[16:17], v[16:17], 1.0 op_sel_hi:[1,0]
    v_pk_add_f32 v[18:19], v[18:19], 1.0 op_sel_hi:[1,0]
    v_pk_add_f32 v[20:21], v[20:21], 1.0 op_sel_hi:[1,0]
    v_pk_add_f32 v[22:23], v[22:23], 1.0 op_sel_hi:[1,0]
    ds_read_b128 v[24:27], v7 offset:4096
    ds_read_b128 v[28:31], v7 offset:5120
    ds_add_f64 v8, v[12:13] offset:0
    v_mfma_f32_32x32x16_bf16 v[36:51], v[76:79], v[32:35], v[36:51]
    v_rcp_f32 v16, v16
    v_rcp_f32 v17, v17
    v_rcp_f32_e64 v18, v18
    v_mfma_f32_32x32x16_bf16 v[36:51], v[80:83], v[252:255], v[36:51]
    v_rcp_f32 v19, v19
    v_rcp_f32 v20, v20
    v_rcp_f32 v21, v21
    v_rcp_f32 v22, v22
    v_rcp_f32_e64 v23, v23
    v_pk_mul_f32 v[16:17], v[16:17], v[52:53]
    v_pk_mul_f32 v[18:19], v[18:19], v[54:55]
    v_pk_mul_f32 v[20:21], v[20:21], v[56:57]
    v_pk_mul_f32 v[22:23], v[22:23], v[58:59]
    v_cvt_pk_bf16_f32 v100, v16, v17
    v_cvt_pk_bf16_f32 v101, v18, v19
    v_cvt_pk_bf16_f32 v102, v20, v21
    v_cvt_pk_bf16_f32 v103, v22, v23
    v_dot2_f32_bf16 v11, v100, v100, 0
    v_dot2_f32_bf16 v11, v101, v101, v11
    v_dot2_f32_bf16 v11, v102, v102, v11
    v_dot2_f32_bf16 v11, v103, v103, v11
    v_pk_fma_f32 v[16:17], v[60:61], v[60:61], s[34:35]
    v_pk_fma_f32 v[18:19], v[62:63], v[62:63], s[34:35]
    v_pk_fma_f32 v[20:21], v[64:65], v[64:65], s[34:35]
    v_pk_fma_f32 v[22:23], v[66:67], v[66:67], s[34:35]
    v_pk_mul_f32 v[16:17], v[16:17], v[60:61]
    v_pk_mul_f32 v[18:19], v[18:19], v[62:63]
    v_pk_mul_f32 v[20:21], v[20:21], v[64:65]
    v_pk_mul_f32 v[22:23], v[22:23], v[66:67]
    s_waitcnt lgkmcnt(1)
    ds_read_b128 v[32:35], v7 offset:6144
    ds_read_b128 v[252:255], v7 offset:7168
    v_mfma_f32_32x32x16_bf16 v[36:51], v[84:87], v[24:27], v[36:51]
    v_exp_f32 v16, v16
    v_exp_f32 v17, v17
    v_exp_f32 v18, v18
    v_mfma_f32_32x32x16_bf16 v[36:51], v[88:91], v[28:31], v[36:51]
    v_exp_f32 v19, v19
    v_exp_f32 v20, v20
    v_exp_f32 v21, v21
    v_exp_f32 v22, v22
    v_exp_f32_e64 v23, v23
    v_pk_add_f32 v[16:17], v[16:17], 1.0 op_sel_hi:[1,0]
    v_pk_add_f32 v[18:19], v[18:19], 1.0 op_sel_hi:[1,0]
    v_pk_add_f32 v[20:21], v[20:21], 1.0 op_sel_hi:[1,0]
    v_pk_add_f32 v[22:23], v[22:23], 1.0 op_sel_hi:[1,0]
    ds_read_b128 v[24:27], v7 offset:8192
    ds_read_b128 v[28:31], v7 offset:9216
    v_rcp_f32 v16, v16
    v_rcp_f32 v17, v17
    v_rcp_f32 v18, v18
    v_rcp_f32 v19, v19
    v_rcp_f32 v20, v20
    v_rcp_f32 v21, v21
    v_rcp_f32 v22, v22
    v_rcp_f32 v23, v23
    v_pk_mul_f32 v[16:17], v[16:17], v[60:61]
    v_pk_mul_f32 v[18:19], v[18:19], v[62:63]
    v_pk_mul_f32 v[20:21], v[20:21], v[64:65]
    v_pk_mul_f32 v[22:23], v[22:23], v[66:67]
    v_cvt_pk_bf16_f32 v104, v16, v17
    v_cvt_pk_bf16_f32 v105, v18, v19
    v_cvt_pk_bf16_f32 v106, v20, v21
    v_cvt_pk_bf16_f32 v107, v22, v23
    v_dot2_f32_bf16 v11, v104, v104, v11
    v_dot2_f32_bf16 v11, v105, v105, v11
    v_dot2_f32_bf16 v11, v106, v106, v11
    v_dot2_f32_bf16 v11, v107, v107, v11
    s_cmp_lg_u32 s69, 1
    s_cbranch_scc1 L_skip40
    s_waitcnt lgkmcnt(0)
    v_mov_b32 v14, 163536
    v_mov_b32_e64 v15, 1
    s_mov_b64 exec, 1
    ds_add_u32 v14, v15 offset:36
    s_mov_b64 exec, -1
L_skip40:
    v_mov_b32 v14, 163536
    s_mov_b32 s10, 0
L_aw41:
    ds_read_b32 v15, v14 offset:36
    s_add_u32 s10, s10, 1
    s_waitcnt lgkmcnt(0)
    v_readfirstlane_b32 s9, v15
    s_lshr_b32 s55, s10, 22
    s_lshl_b32 s55, s55, 3
    s_or_b32 s9, s9, s55
    s_cmp_lt_u32 s9, 4
    s_cbranch_scc1 L_aw41
    s_cmp_lg_u32 s69, 0
    s_cbranch_scc1 L_skip42
    s_add_u32 s9, s63, 3072
    buffer_store_dwordx4 v[120:123], v6, s[40:43], s9 offen sc1 nt
    s_add_u32 s9, s63, 4096
    buffer_store_dwordx4 v[156:159], v6, s[40:43], s9 offen sc1 nt
    s_add_u32 s9, s63, 5120
    buffer_store_dwordx4 v[160:163], v6, s[40:43], s9 offen sc1 nt
L_skip42:
    v_pk_fma_f32 v[16:17], v[36:37], v[36:37], s[34:35]
    v_pk_fma_f32 v[18:19], v[38:39], v[38:39], s[34:35]
    v_pk_fma_f32 v[20:21], v[40:41], v[40:41], s[34:35]
    v_pk_fma_f32 v[22:23], v[42:43], v[42:43], s[34:35]
    v_pk_mul_f32 v[16:17], v[16:17], v[36:37]
    v_pk_mul_f32 v[18:19], v[18:19], v[38:39]
    v_pk_mul_f32 v[20:21], v[20:21], v[40:41]
    v_pk_mul_f32 v[22:23], v[22:23], v[42:43]
    v_cvt_f64_f32_e64 v[12:13], v11
    v_mfma_f32_32x32x16_bf16 v[52:67], v[68:71], v[32:35], 0
    v_exp_f32 v16, v16
    v_exp_f32 v17, v17
    v_exp_f32_e64 v18, v18
    v_mfma_f32_32x32x16_bf16 v[52:67], v[72:75], v[252:255], v[52:67]
    v_exp_f32 v19, v19
    v_exp_f32 v20, v20
    v_exp_f32 v21, v21
    v_exp_f32 v22, v22
    v_exp_f32_e64 v23, v23
    v_pk_add_f32 v[16:17], v[16:17], 1.0 op_sel_hi:[1,0]
    v_pk_add_f32 v[18:19], v[18:19], 1.0 op_sel_hi:[1,0]
    v_pk_add_f32 v[20:21], v[20:21], 1.0 op_sel_hi:[1,0]
    v_pk_add_f32 v[22:23], v[22:23], 1.0 op_sel_hi:[1,0]
    ds_read_b128 v[32:35], v7 offset:10240
    ds_read_b128 v[252:255], v7 offset:11264
    ds_add_f64 v8, v[12:13] offset:256
    v_mfma_f32_32x32x16_bf16 v[52:67], v[76:79], v[24:27], v[52:67]
    v_rcp_f32 v16, v16
    v_rcp_f32 v17, v17
    v_rcp_f32_e64 v18, v18
    v_mfma_f32_32x32x16_bf16 v[52:67], v[80:83], v[28:31], v[52:67]
    v_rcp_f32 v19, v19
    v_rcp_f32 v20, v20
    v_rcp_f32 v21, v21
    v_rcp_f32 v22, v22
    v_rcp_f32_e64 v23, v23
    v_pk_mul_f32 v[16:17], v[16:17], v[36:37]
    v_pk_mul_f32 v[18:19], v[18:19], v[38:39]
    v_pk_mul_f32 v[20:21], v[20:21], v[40:41]
    v_pk_mul_f32 v[22:23], v[22:23], v[42:43]
    v_cvt_pk_bf16_f32 v140, v16, v17
    v_cvt_pk_bf16_f32 v141, v18, v19
    v_cvt_pk_bf16_f32 v142, v20, v21
    v_cvt_pk_bf16_f32 v143, v22, v23
    v_dot2_f32_bf16 v11, v140, v140, 0
    v_dot2_f32_bf16 v11, v141, v141, v11
    v_dot2_f32_bf16 v11, v142, v142, v11
    v_dot2_f32_bf16 v11, v143, v143, v11
    v_pk_fma_f32 v[16:17], v[44:45], v[44:45], s[34:35]
    v_pk_fma_f32 v[18:19], v[46:47], v[46:47], s[34:35]
    v_pk_fma_f32 v[20:21], v[48:49], v[48:49], s[34:35]
    v_pk_fma_f32 v[22:23], v[50:51], v[50:51], s[34:35]
    v_pk_mul_f32 v[16:17], v[16:17], v[44:45]
    v_pk_mul_f32 v[18:19], v[18:19], v[46:47]
    v_pk_mul_f32 v[20:21], v[20:21], v[48:49]
    v_pk_mul_f32 v[22:23], v[22:23], v[50:51]
    s_waitcnt lgkmcnt(1)
    ds_read_b128 v[24:27], v6 offset:12288
    ds_read_b128 v[28:31], v6 offset:13312
    v_mfma_f32_32x32x16_bf16 v[52:67], v[84:87], v[32:35], v[52:67]
    v_exp_f32 v16, v16
    v_exp_f32 v17, v17
    v_exp_f32 v18, v18
    v_mfma_f32_32x32x16_bf16 v[52:67], v[88:91], v[252:255], v[52:67]
    v_exp_f32 v19, v19
    v_exp_f32 v20, v20
    v_exp_f32 v21, v21
    v_exp_f32 v22, v22
    v_exp_f32_e64 v23, v23
    v_pk_add_f32 v[16:17], v[16:17], 1.0 op_sel_hi:[1,0]
    v_pk_add_f32 v[18:19], v[18:19], 1.0 op_sel_hi:[1,0]
    v_pk_add_f32 v[20:21], v[20:21], 1.0 op_sel_hi:[1,0]
    v_pk_add_f32 v[22:23], v[22:23], 1.0 op_sel_hi:[1,0]
    ds_read_b128 v[32:35], v6 offset:14336
    ds_read_b128 v[252:255], v6 offset:15360
    v_rcp_f32 v16, v16
    v_rcp_f32 v17, v17
    v_rcp_f32 v18, v18
    v_rcp_f32 v19, v19
    v_rcp_f32 v20, v20
    v_rcp_f32 v21, v21
    v_rcp_f32 v22, v22
    v_rcp_f32 v23, v23
    v_pk_mul_f32 v[16:17], v[16:17], v[44:45]
    v_pk_mul_f32 v[18:19], v[18:19], v[46:47]
    v_pk_mul_f32 v[20:21], v[20:21], v[48:49]
    v_pk_mul_f32 v[22:23], v[22:23], v[50:51]
    v_cvt_pk_bf16_f32 v144, v16, v17
    v_cvt_pk_bf16_f32 v145, v18, v19
    v_cvt_pk_bf16_f32 v146, v20, v21
    v_cvt_pk_bf16_f32 v147, v22, v23
    v_dot2_f32_bf16 v11, v144, v144, v11
    v_dot2_f32_bf16 v11, v145, v145, v11
    v_dot2_f32_bf16 v11, v146, v146, v11
    v_dot2_f32_bf16 v11, v147, v147, v11
    s_cmp_lg_u32 s69, 0
    s_cbranch_scc1 L_skip43
    s_waitcnt vmcnt(6)
L_skip43:
    s_cmp_lg_u32 s69, 1
    s_cbranch_scc1 L_skip44
    s_waitcnt vmcnt(0)
L_skip44:
    s_lshl_b32 s9, s69, 2
    s_add_u32 s9, s9, 163536
    v_mov_b32 v14, s9
    v_mov_b32 v15, 1
    s_mov_b64 exec, 1
    ds_add_u32 v14, v15 offset:44
    s_mov_b64 exec, -1
    s_cmp_lg_u32 s68, 0
    s_cbranch_scc1 L_skip45
    v_mov_b32 v14, 1
    v_mov_b32 v15, 0
    s_mov_b64 exec, 1
    global_atomic_add v15, v14, s[30:31]
    s_mov_b64 exec, -1
L_skip45:
    s_cmp_lg_u32 s69, 0
    s_cbranch_scc1 L_skip46
    s_nop 0
    s_add_u32 s9, s63, 6144
    buffer_store_dwordx4 v[164:167], v6, s[40:43], s9 offen sc1 nt
    s_add_u32 s9, s63, 7168
    buffer_store_dwordx4 v[168:171], v6, s[40:43], s9 offen sc1 nt
    s_add_u32 s9, s63, 8192
    buffer_store_dwordx4 v[124:127], v6, s[40:43], s9 offen sc1 nt
L_skip46:
    v_pk_fma_f32 v[16:17], v[52:53], v[52:53], s[34:35]
    v_pk_fma_f32 v[18:19], v[54:55], v[54:55], s[34:35]
    v_pk_fma_f32 v[20:21], v[56:57], v[56:57], s[34:35]
    v_pk_fma_f32 v[22:23], v[58:59], v[58:59], s[34:35]
    v_pk_mul_f32 v[16:17], v[16:17], v[52:53]
    v_pk_mul_f32 v[18:19], v[18:19], v[54:55]
    v_pk_mul_f32 v[20:21], v[20:21], v[56:57]
    v_pk_mul_f32 v[22:23], v[22:23], v[58:59]
    v_cvt_f64_f32 v[12:13], v11
    s_waitcnt lgkmcnt(1)
    v_mfma_f32_32x32x16_bf16 v[36:51], v[68:71], v[24:27], 0
    v_exp_f32 v16, v16
    v_exp_f32 v17, v17
    v_exp_f32_e64 v18, v18
    v_mfma_f32_32x32x16_bf16 v[36:51], v[72:75], v[28:31], v[36:51]
    v_exp_f32 v19, v19
    v_exp_f32 v20, v20
    v_exp_f32 v21, v21
    v_exp_f32 v22, v22
    v_exp_f32_e64 v23, v23
    v_pk_add_f32 v[16:17], v[16:17], 1.0 op_sel_hi:[1,0]
    v_pk_add_f32 v[18:19], v[18:19], 1.0 op_sel_hi:[1,0]
    v_pk_add_f32 v[20:21], v[20:21], 1.0 op_sel_hi:[1,0]
    v_pk_add_f32 v[22:23], v[22:23], 1.0 op_sel_hi:[1,0]
    ds_read_b128 v[24:27], v6 offset:16384
    ds_read_b128 v[28:31], v6 offset:17408
    ds_add_f64 v8, v[12:13] offset:1536
    v_mfma_f32_32x32x16_bf16 v[36:51], v[76:79], v[32:35], v[36:51]
    v_rcp_f32 v16, v16
    v_rcp_f32 v17, v17
    v_rcp_f32_e64 v18, v18
    v_mfma_f32_32x32x16_bf16 v[36:51], v[80:83], v[252:255], v[36:51]
    v_rcp_f32 v19, v19
    v_rcp_f32 v20, v20
    v_rcp_f32 v21, v21
    v_rcp_f32 v22, v22
    v_rcp_f32_e64 v23, v23
    v_pk_mul_f32 v[16:17], v[16:17], v[52:53]
    v_pk_mul_f32 v[18:19], v[18:19], v[54:55]
    v_pk_mul_f32 v[20:21], v[20:21], v[56:57]
    v_pk_mul_f32 v[22:23], v[22:23], v[58:59]
    v_cvt_pk_bf16_f32 v148, v16, v17
    v_cvt_pk_bf16_f32 v149, v18, v19
    v_cvt_pk_bf16_f32 v150, v20, v21
    v_cvt_pk_bf16_f32 v151, v22, v23
    v_dot2_f32_bf16 v11, v148, v148, 0
    v_dot2_f32_bf16 v11, v149, v149, v11
    v_dot2_f32_bf16 v11, v150, v150, v11
    v_dot2_f32_bf16 v11, v151, v151, v11
    v_pk_fma_f32 v[16:17], v[60:61], v[60:61], s[34:35]
    v_pk_fma_f32 v[18:19], v[62:63], v[62:63], s[34:35]
    v_pk_fma_f32 v[20:21], v[64:65], v[64:65], s[34:35]
    v_pk_fma_f32 v[22:23], v[66:67], v[66:67], s[34:35]
    v_pk_mul_f32 v[16:17], v[16:17], v[60:61]
    v_pk_mul_f32 v[18:19], v[18:19], v[62:63]
    v_pk_mul_f32 v[20:21], v[20:21], v[64:65]
    v_pk_mul_f32 v[22:23], v[22:23], v[66:67]
    s_waitcnt lgkmcnt(1)
    ds_read_b128 v[32:35], v6 offset:18432
    ds_read_b128 v[252:255], v6 offset:19456
    v_mfma_f32_32x32x16_bf16 v[36:51], v[84:87], v[24:27], v[36:51]
    v_exp_f32 v16, v16
    v_exp_f32 v17, v17
    v_exp_f32 v18, v18
    v_mfma_f32_32x32x16_bf16 v[36:51], v[88:91], v[28:31], v[36:51]
    v_exp_f32 v19, v19
    v_exp_f32 v20, v20
    v_exp_f32 v21, v21
    v_exp_f32 v22, v22
    v_exp_f32_e64 v23, v23
    v_pk_add_f32 v[16:17], v[16:17], 1.0 op_sel_hi:[1,0]
    v_pk_add_f32 v[18:19], v[18:19], 1.0 op_sel_hi:[1,0]
    v_pk_add_f32 v[20:21], v[20:21], 1.0 op_sel_hi:[1,0]
    v_pk_add_f32 v[22:23], v[22:23], 1.0 op_sel_hi:[1,0]
    ds_read_b128 v[24:27], v6 offset:20480
    ds_read_b128 v[28:31], v6 offset:21504
    v_rcp_f32 v16, v16
    v_rcp_f32 v17, v17
    v_rcp_f32 v18, v18
    v_rcp_f32 v19, v19
    v_rcp_f32 v20, v20
    v_rcp_f32 v21, v21
    v_rcp_f32 v22, v22
    v_rcp_f32 v23, v23
    v_pk_mul_f32 v[16:17], v[16:17], v[60:61]
    v_pk_mul_f32 v[18:19], v[18:19], v[62:63]
    v_pk_mul_f32 v[20:21], v[20:21], v[64:65]
    v_pk_mul_f32 v[22:23], v[22:23], v[66:67]
    v_cvt_pk_bf16_f32 v152, v16, v17
    v_cvt_pk_bf16_f32 v153, v18, v19
    v_cvt_pk_bf16_f32 v154, v20, v21
    v_cvt_pk_bf16_f32 v155, v22, v23
    v_dot2_f32_bf16 v11, v152, v152, v11
    v_dot2_f32_bf16 v11, v153, v153, v11
    v_dot2_f32_bf16 v11, v154, v154, v11
    v_dot2_f32_bf16 v11, v155, v155, v11
    s_cmp_lg_u32 s69, 0
    s_cbranch_scc1 L_skip47
    s_add_u32 s9, s63, 9216
    buffer_store_dwordx4 v[128:131], v6, s[40:43], s9 offen sc1 nt
    s_add_u32 s9, s63, 10240
    buffer_store_dwordx4 v[132:135], v6, s[40:43], s9 offen sc1 nt
    s_add_u32 s9, s63, 11264
    buffer_store_dwordx4 v[136:139], v6, s[40:43], s9 offen sc1 nt
L_skip47:
    s_cmp_lg_u32 s69, 1
    s_cbranch_scc1 L_skip48
    v_mov_b32 v14, 163536
    s_mov_b32 s10, 0
L_aw49:
    ds_read_b32 v15, v14 offset:24
    s_add_u32 s10, s10, 1
    s_waitcnt lgkmcnt(0)
    v_readfirstlane_b32 s9, v15
    s_lshr_b32 s55, s10, 22
    s_lshl_b32 s55, s55, 3
    s_or_b32 s9, s9, s55
    s_cmp_lt_u32 s9, 4
    s_cbranch_scc1 L_aw49
    s_mov_b32 s10, 0
L_aw50:
    ds_read_b32 v15, v14 offset:32
    s_add_u32 s10, s10, 1
    s_waitcnt lgkmcnt(0)
    v_readfirstlane_b32 s9, v15
    s_lshr_b32 s55, s10, 22
    s_lshl_b32 s55, s55, 3
    s_or_b32 s9, s9, s55
    s_cmp_lt_u32 s9, 4
    s_cbranch_scc1 L_aw50
    ds_write_b128 v236, v[164:167] offset:24576
    ds_write_b128 v236, v[168:171] offset:30720
    ds_write_b128 v236, v[124:127] offset:25600
    ds_write_b128 v236, v[128:131] offset:31744
    ds_write_b128 v236, v[132:135] offset:26624
    ds_write_b128 v236, v[136:139] offset:32768
L_skip48:
    v_mov_b32 v14, 163536
    s_mov_b32 s10, 0
L_aw51:
    ds_read_b32 v15, v14 offset:48
    s_add_u32 s10, s10, 1
    s_waitcnt lgkmcnt(0)
    v_readfirstlane_b32 s9, v15
    s_lshr_b32 s55, s10, 22
    s_lshl_b32 s55, s55, 3
    s_or_b32 s9, s9, s55
    s_cmp_lt_u32 s9, 4
    s_cbranch_scc1 L_aw51
    s_cmp_lg_u32 s69, 0
    s_cbranch_scc1 L_skip52
    v_mov_b32 v14, 163536
    s_mov_b32 s10, 0
L_aw53:
    ds_read_b32 v15, v14 offset:44
    s_add_u32 s10, s10, 1
    s_waitcnt lgkmcnt(0)
    v_readfirstlane_b32 s9, v15
    s_lshr_b32 s55, s10, 22
    s_lshl_b32 s55, s55, 3
    s_or_b32 s9, s9, s55
    s_cmp_lt_u32 s9, 4
    s_cbranch_scc1 L_aw53
L_skip52:
    v_pk_fma_f32 v[16:17], v[36:37], v[36:37], s[34:35]
    v_pk_fma_f32 v[18:19], v[38:39], v[38:39], s[34:35]
    v_pk_fma_f32 v[20:21], v[40:41], v[40:41], s[34:35]
    v_pk_fma_f32 v[22:23], v[42:43], v[42:43], s[34:35]
    v_pk_mul_f32 v[16:17], v[16:17], v[36:37]
    v_pk_mul_f32 v[18:19], v[18:19], v[38:39]
    v_pk_mul_f32 v[20:21], v[20:21], v[40:41]
    v_pk_mul_f32 v[22:23], v[22:23], v[42:43]
    s_setprio 3
    v_cvt_f64_f32 v[12:13], v11
    ds_read_b128 v[236:239], v2 offset:0
    ds_read_b128 v[240:243], v3 offset:0
    ds_read_b128 v[244:247], v2 offset:400
    ds_read_b128 v[248:251], v4 offset:0
    ds_read_b128 v[116:119], v2 offset:800
    ds_read_b128 v[120:123], v5 offset:0
    v_mfma_f32_32x32x16_bf16 v[52:67], v[68:71], v[32:35], 0
    v_exp_f32 v16, v16
    v_exp_f32 v17, v17
    v_exp_f32_e64 v18, v18
    v_mfma_f32_32x32x16_bf16 v[52:67], v[72:75], v[252:255], v[52:67]
    v_exp_f32 v19, v19
    v_exp_f32 v20, v20
    v_exp_f32 v21, v21
    v_exp_f32 v22, v22
    v_exp_f32_e64 v23, v23
    v_pk_add_f32 v[16:17], v[16:17], 1.0 op_sel_hi:[1,0]
    v_pk_add_f32 v[18:19], v[18:19], 1.0 op_sel_hi:[1,0]
    v_pk_add_f32 v[20:21], v[20:21], 1.0 op_sel_hi:[1,0]
    v_pk_add_f32 v[22:23], v[22:23], 1.0 op_sel_hi:[1,0]
    ds_read_b128 v[32:35], v6 offset:22528
    ds_read_b128 v[252:255], v6 offset:23552
    ds_add_f64 v8, v[12:13] offset:1792
    ds_read_b128 v[156:159], v2 offset:1200
    ds_read_b128 v[160:163], v3 offset:16
    ds_read_b128 v[164:167], v2 offset:1600
    ds_read_b128 v[168:171], v4 offset:16
    ds_read_b128 v[124:127], v2 offset:2000
    ds_read_b128 v[128:131], v5 offset:16
    v_mfma_f32_32x32x16_bf16 v[52:67], v[76:79], v[24:27], v[52:67]
    v_rcp_f32 v16, v16
    v_rcp_f32 v17, v17
    v_rcp_f32_e64 v18, v18
    v_mfma_f32_32x32x16_bf16 v[52:67], v[80:83], v[28:31], v[52:67]
    v_rcp_f32 v19, v19
    v_rcp_f32 v20, v20
    v_rcp_f32 v21, v21
    v_rcp_f32 v22, v22
    v_rcp_f32_e64 v23, v23
    v_pk_mul_f32 v[16:17], v[16:17], v[36:37]
    v_pk_mul_f32 v[18:19], v[18:19], v[38:39]
    v_pk_mul_f32 v[20:21], v[20:21], v[40:41]
    v_pk_mul_f32 v[22:23], v[22:23], v[42:43]
    v_cvt_pk_bf16_f32 v108, v16, v17
    v_cvt_pk_bf16_f32 v109, v18, v19
    v_cvt_pk_bf16_f32 v110, v20, v21
    v_cvt_pk_bf16_f32 v111, v22, v23
    v_dot2_f32_bf16 v11, v108, v108, 0
    v_dot2_f32_bf16 v11, v109, v109, v11
    v_dot2_f32_bf16 v11, v110, v110, v11
    v_dot2_f32_bf16 v11, v111, v111, v11
    v_pk_fma_f32 v[16:17], v[44:45], v[44:45], s[34:35]
    v_pk_fma_f32 v[18:19], v[46:47], v[46:47], s[34:35]
    v_pk_fma_f32 v[20:21], v[48:49], v[48:49], s[34:35]
    v_pk_fma_f32 v[22:23], v[50:51], v[50:51], s[34:35]
    v_pk_mul_f32 v[16:17], v[16:17], v[44:45]
    v_pk_mul_f32 v[18:19], v[18:19], v[46:47]
    v_pk_mul_f32 v[20:21], v[20:21], v[48:49]
    v_pk_mul_f32 v[22:23], v[22:23], v[50:51]
    s_waitcnt lgkmcnt(7)
    s_waitcnt lgkmcnt(0)
    ds_read_b128 v[24:27], v7 offset:12288
    ds_read_b128 v[28:31], v7 offset:13312
    v_mfma_f32_32x32x16_bf16 v[52:67], v[84:87], v[32:35], v[52:67]
    v_exp_f32 v16, v16
    v_exp_f32 v17, v17
    v_exp_f32_e64 v18, v18
    v_mfma_f32_32x32x16_bf16 v[52:67], v[88:91], v[252:255], v[52:67]
    v_exp_f32 v19, v19
    v_exp_f32 v20, v20
    v_exp_f32 v21, v21
    v_exp_f32 v22, v22
    v_exp_f32_e64 v23, v23
    v_pk_add_f32 v[16:17], v[16:17], 1.0 op_sel_hi:[1,0]
    v_pk_add_f32 v[18:19], v[18:19], 1.0 op_sel_hi:[1,0]
    v_pk_add_f32 v[20:21], v[20:21], 1.0 op_sel_hi:[1,0]
    v_pk_add_f32 v[22:23], v[22:23], 1.0 op_sel_hi:[1,0]
    ds_read_b128 v[32:35], v7 offset:14336
    ds_read_b128 v[252:255], v7 offset:15360
    v_mfma_f32_16x16x32_bf16 v[188:191], v[236:239], v[240:243], 0
    v_rcp_f32_e64 v16, v16
    v_mfma_f32_16x16x32_bf16 v[188:191], v[244:247], v[248:251], v[188:191]
    v_rcp_f32_e64 v17, v17
    v_mfma_f32_16x16x32_bf16 v[188:191], v[116:119], v[120:123], v[188:191]
    v_rcp_f32_e64 v18, v18
    v_mfma_f32_16x16x32_bf16 v[192:195], v[156:159], v[160:163], 0
    v_rcp_f32_e64 v19, v19
    v_mfma_f32_16x16x32_bf16 v[192:195], v[164:167], v[168:171], v[192:195]
    v_rcp_f32_e64 v20, v20
    v_mfma_f32_16x16x32_bf16 v[192:195], v[124:127], v[128:131], v[192:195]
    v_rcp_f32 v21, v21
    v_rcp_f32 v22, v22
    v_rcp_f32_e64 v23, v23
    v_pk_mul_f32 v[16:17], v[16:17], v[44:45]
    v_pk_mul_f32 v[18:19], v[18:19], v[46:47]
    v_pk_mul_f32 v[20:21], v[20:21], v[48:49]
    v_pk_mul_f32 v[22:23], v[22:23], v[50:51]
    v_cvt_pk_bf16_f32 v112, v16, v17
    v_cvt_pk_bf16_f32 v113, v18, v19
    v_cvt_pk_bf16_f32 v114, v20, v21
    v_cvt_pk_bf16_f32 v115, v22, v23
    v_dot2_f32_bf16 v11, v112, v112, v11
    v_dot2_f32_bf16 v11, v113, v113, v11
    v_dot2_f32_bf16 v11, v114, v114, v11
    v_dot2_f32_bf16 v11, v115, v115, v11
    s_cmp_lg_u32 s69, 1
    s_cbranch_scc1 L_skip54
    s_waitcnt lgkmcnt(0)
    v_mov_b32 v14, 163536
    v_mov_b32_e64 v15, 1
    s_mov_b64 exec, 1
    ds_add_u32 v14, v15 offset:40
    s_mov_b64 exec, -1
L_skip54:
    s_nop 0
    v_pk_fma_f32 v[16:17], v[52:53], v[52:53], s[34:35]
    v_pk_fma_f32 v[18:19], v[54:55], v[54:55], s[34:35]
    v_pk_fma_f32 v[20:21], v[56:57], v[56:57], s[34:35]
    v_pk_fma_f32 v[22:23], v[58:59], v[58:59], s[34:35]
    v_pk_mul_f32 v[16:17], v[16:17], v[52:53]
    v_pk_mul_f32 v[18:19], v[18:19], v[54:55]
    v_pk_mul_f32 v[20:21], v[20:21], v[56:57]
    v_pk_mul_f32 v[22:23], v[22:23], v[58:59]
    v_cvt_f64_f32 v[12:13], v11
    s_waitcnt lgkmcnt(0)
    ds_read_b128 v[236:239], v2 offset:2400
    ds_read_b128 v[240:243], v3 offset:32
    ds_read_b128 v[244:247], v2 offset:2800
    ds_read_b128 v[248:251], v4 offset:32
    ds_read_b128 v[156:159], v2 offset:3200
    ds_read_b128 v[160:163], v5 offset:32
    v_mfma_f32_32x32x16_bf16 v[36:51], v[68:71], v[24:27], 0
    v_exp_f32 v16, v16
    v_exp_f32 v17, v17
    v_exp_f32_e64 v18, v18
    v_mfma_f32_32x32x16_bf16 v[36:51], v[72:75], v[28:31], v[36:51]
    v_exp_f32 v19, v19
    v_exp_f32 v20, v20
    v_exp_f32 v21, v21
    v_exp_f32 v22, v22
    v_exp_f32_e64 v23, v23
    v_pk_add_f32 v[16:17], v[16:17], 1.0 op_sel_hi:[1,0]
    v_pk_add_f32 v[18:19], v[18:19], 1.0 op_sel_hi:[1,0]
    v_pk_add_f32 v[20:21], v[20:21], 1.0 op_sel_hi:[1,0]
    v_pk_add_f32 v[22:23], v[22:23], 1.0 op_sel_hi:[1,0]
    ds_read_b128 v[24:27], v7 offset:16384
    ds_read_b128 v[28:31], v7 offset:17408
    ds_add_f64 v8, v[12:13] offset:512
    ds_read_b128 v[164:167], v2 offset:3600
    ds_read_b128 v[168:171], v3 offset:48
    ds_read_b128 v[124:127], v2 offset:4000
    ds_read_b128 v[128:131], v4 offset:48
    ds_read_b128 v[132:135], v2 offset:4400
    ds_read_b128 v[136:139], v5 offset:48
    v_mfma_f32_32x32x16_bf16 v[36:51], v[76:79], v[32:35], v[36:51]
    v_rcp_f32 v16, v16
    v_rcp_f32 v17, v17
    v_rcp_f32_e64 v18, v18
    v_mfma_f32_32x32x16_bf16 v[36:51], v[80:83], v[252:255], v[36:51]
    v_rcp_f32 v19, v19
    v_rcp_f32 v20, v20
    v_rcp_f32 v21, v21
    v_rcp_f32 v22, v22
    v_rcp_f32_e64 v23, v23
    v_pk_mul_f32 v[16:17], v[16:17], v[52:53]
    v_pk_mul_f32 v[18:19], v[18:19], v[54:55]
    v_pk_mul_f32 v[20:21], v[20:21], v[56:57]
    v_pk_mul_f32 v[22:23], v[22:23], v[58:59]
    v_cvt_pk_bf16_f32 v116, v16, v17
    v_cvt_pk_bf16_f32 v117, v18, v19
    v_cvt_pk_bf16_f32 v118, v20, v21
    v_cvt_pk_bf16_f32 v119, v22, v23
    v_dot2_f32_bf16 v11, v116, v116, 0
    v_dot2_f32_bf16 v11, v117, v117, v11
    v_dot2_f32_bf16 v11, v118, v118, v11
    v_dot2_f32_bf16 v11, v119, v119, v11
    v_pk_fma_f32 v[16:17], v[60:61], v[60:61], s[34:35]
    v_pk_fma_f32 v[18:19], v[62:63], v[62:63], s[34:35]
    v_pk_fma_f32 v[20:21], v[64:65], v[64:65], s[34:35]
    v_pk_fma_f32 v[22:23], v[66:67], v[66:67], s[34:35]
    v_pk_mul_f32 v[16:17], v[16:17], v[60:61]
    v_pk_mul_f32 v[18:19], v[18:19], v[62:63]
    v_pk_mul_f32 v[20:21], v[20:21], v[64:65]
    v_pk_mul_f32 v[22:23], v[22:23], v[66:67]
    s_waitcnt lgkmcnt(7)
    s_waitcnt lgkmcnt(0)
    ds_read_b128 v[32:35], v7 offset:18432
    ds_read_b128 v[252:255], v7 offset:19456
    v_mfma_f32_32x32x16_bf16 v[36:51], v[84:87], v[24:27], v[36:51]
    v_exp_f32 v16, v16
    v_exp_f32 v17, v17
    v_exp_f32_e64 v18, v18
    v_mfma_f32_32x32x16_bf16 v[36:51], v[88:91], v[28:31], v[36:51]
    v_exp_f32 v19, v19
    v_exp_f32 v20, v20
    v_exp_f32 v21, v21
    v_exp_f32 v22, v22
    v_exp_f32_e64 v23, v23
    v_pk_add_f32 v[16:17], v[16:17], 1.0 op_sel_hi:[1,0]
    v_pk_add_f32 v[18:19], v[18:19], 1.0 op_sel_hi:[1,0]
    v_pk_add_f32 v[20:21], v[20:21], 1.0 op_sel_hi:[1,0]
    v_pk_add_f32 v[22:23], v[22:23], 1.0 op_sel_hi:[1,0]
    ds_read_b128 v[24:27], v7 offset:20480
    ds_read_b128 v[28:31], v7 offset:21504
    v_mfma_f32_16x16x32_bf16 v[196:199], v[236:239], v[240:243], 0
    v_rcp_f32_e64 v16, v16
    v_mfma_f32_16x16x32_bf16 v[196:199], v[244:247], v[248:251], v[196:199]
    v_rcp_f32_e64 v17, v17
    v_mfma_f32_16x16x32_bf16 v[196:199], v[156:159], v[160:163], v[196:199]
    v_rcp_f32_e64 v18, v18
    v_mfma_f32_16x16x32_bf16 v[200:203], v[164:167], v[168:171], 0
    v_rcp_f32_e64 v19, v19
    v_mfma_f32_16x16x32_bf16 v[200:203], v[124:127], v[128:131], v[200:203]
    v_rcp_f32_e64 v20, v20
    v_mfma_f32_16x16x32_bf16 v[200:203], v[132:135], v[136:139], v[200:203]
    v_rcp_f32 v21, v21
    v_rcp_f32 v22, v22
    v_rcp_f32_e64 v23, v23
    v_pk_mul_f32 v[16:17], v[16:17], v[60:61]
    v_pk_mul_f32 v[18:19], v[18:19], v[62:63]
    v_pk_mul_f32 v[20:21], v[20:21], v[64:65]
    v_pk_mul_f32 v[22:23], v[22:23], v[66:67]
    v_cvt_pk_bf16_f32 v120, v16, v17
    v_cvt_pk_bf16_f32 v121, v18, v19
    v_cvt_pk_bf16_f32 v122, v20, v21
    v_cvt_pk_bf16_f32 v123, v22, v23
    v_dot2_f32_bf16 v11, v120, v120, v11
    v_dot2_f32_bf16 v11, v121, v121, v11
    v_dot2_f32_bf16 v11, v122, v122, v11
    v_dot2_f32_bf16 v11, v123, v123, v11
    v_mov_b32 v14, 163536
    s_mov_b32 s10, 0
L_aw55:
    ds_read_b32 v15, v14 offset:40
    s_add_u32 s10, s10, 1
    s_waitcnt lgkmcnt(0)
    v_readfirstlane_b32 s9, v15
    s_lshr_b32 s55, s10, 22
    s_lshl_b32 s55, s55, 3
    s_or_b32 s9, s9, s55
    s_cmp_lt_u32 s9, 4
    s_cbranch_scc1 L_aw55
    s_nop 0
    v_pk_fma_f32 v[16:17], v[36:37], v[36:37], s[34:35]
    v_pk_fma_f32 v[18:19], v[38:39], v[38:39], s[34:35]
    v_pk_fma_f32 v[20:21], v[40:41], v[40:41], s[34:35]
    v_pk_fma_f32 v[22:23], v[42:43], v[42:43], s[34:35]
    v_pk_mul_f32 v[16:17], v[16:17], v[36:37]
    v_pk_mul_f32 v[18:19], v[18:19], v[38:39]
    v_pk_mul_f32 v[20:21], v[20:21], v[40:41]
    v_pk_mul_f32 v[22:23], v[22:23], v[42:43]
    v_cvt_f64_f32_e64 v[12:13], v11
    ds_read_b128 v[236:239], v2 offset:4800
    ds_read_b128 v[240:243], v3 offset:64
    ds_read_b128 v[244:247], v2 offset:5200
    ds_read_b128 v[248:251], v4 offset:64
    ds_read_b128 v[164:167], v2 offset:5600
    ds_read_b128 v[168:171], v5 offset:64
    v_mfma_f32_32x32x16_bf16 v[52:67], v[68:71], v[32:35], 0
    v_exp_f32 v16, v16
    v_exp_f32 v17, v17
    v_exp_f32_e64 v18, v18
    v_mfma_f32_32x32x16_bf16 v[52:67], v[72:75], v[252:255], v[52:67]
    v_exp_f32 v19, v19
    v_exp_f32 v20, v20
    v_exp_f32 v21, v21
    v_exp_f32 v22, v22
    v_exp_f32_e64 v23, v23
    v_pk_add_f32 v[16:17], v[16:17], 1.0 op_sel_hi:[1,0]
    v_pk_add_f32 v[18:19], v[18:19], 1.0 op_sel_hi:[1,0]
    v_pk_add_f32 v[20:21], v[20:21], 1.0 op_sel_hi:[1,0]
    v_pk_add_f32 v[22:23], v[22:23], 1.0 op_sel_hi:[1,0]
    ds_read_b128 v[32:35], v7 offset:22528
    ds_read_b128 v[252:255], v7 offset:23552
    ds_add_f64 v8, v[12:13] offset:768
    ds_read_b128 v[124:127], v2 offset:6000
    ds_read_b128 v[128:131], v3 offset:80
    ds_read_b128 v[132:135], v2 offset:6400
    ds_read_b128 v[136:139], v4 offset:80
    ds_read_b128 v[172:175], v2 offset:6800
    ds_read_b128 v[176:179], v5 offset:80
    v_mfma_f32_32x32x16_bf16 v[52:67], v[76:79], v[24:27], v[52:67]
    v_rcp_f32 v16, v16
    v_rcp_f32 v17, v17
    v_rcp_f32_e64 v18, v18
    v_mfma_f32_32x32x16_bf16 v[52:67], v[80:83], v[28:31], v[52:67]
    v_rcp_f32 v19, v19
    v_rcp_f32 v20, v20
    v_rcp_f32 v21, v21
    v_rcp_f32 v22, v22
    v_rcp_f32_e64 v23, v23
    v_pk_mul_f32 v[16:17], v[16:17], v[36:37]
    v_pk_mul_f32 v[18:19], v[18:19], v[38:39]
    v_pk_mul_f32 v[20:21], v[20:21], v[40:41]
    v_pk_mul_f32 v[22:23], v[22:23], v[42:43]
    v_cvt_pk_bf16_f32 v156, v16, v17
    v_cvt_pk_bf16_f32 v157, v18, v19
    v_cvt_pk_bf16_f32 v158, v20, v21
    v_cvt_pk_bf16_f32 v159, v22, v23
    v_dot2_f32_bf16 v11, v156, v156, 0
    v_dot2_f32_bf16 v11, v157, v157, v11
    v_dot2_f32_bf16 v11, v158, v158, v11
    v_dot2_f32_bf16 v11, v159, v159, v11
    v_pk_fma_f32 v[16:17], v[44:45], v[44:45], s[34:35]
    v_pk_fma_f32 v[18:19], v[46:47], v[46:47], s[34:35]
    v_pk_fma_f32 v[20:21], v[48:49], v[48:49], s[34:35]
    v_pk_fma_f32 v[22:23], v[50:51], v[50:51], s[34:35]
    v_pk_mul_f32 v[16:17], v[16:17], v[44:45]
    v_pk_mul_f32 v[18:19], v[18:19], v[46:47]
    v_pk_mul_f32 v[20:21], v[20:21], v[48:49]
    v_pk_mul_f32 v[22:23], v[22:23], v[50:51]
    s_waitcnt lgkmcnt(7)
    s_waitcnt lgkmcnt(0)
    ds_read_b128 v[24:27], v6 offset:24576
    ds_read_b128 v[28:31], v6 offset:25600
    v_mfma_f32_32x32x16_bf16 v[52:67], v[84:87], v[32:35], v[52:67]
    v_exp_f32 v16, v16
    v_exp_f32 v17, v17
    v_exp_f32_e64 v18, v18
    v_mfma_f32_32x32x16_bf16 v[52:67], v[88:91], v[252:255], v[52:67]
    v_exp_f32 v19, v19
    v_exp_f32 v20, v20
    v_exp_f32 v21, v21
    v_exp_f32 v22, v22
    v_exp_f32_e64 v23, v23
    v_pk_add_f32 v[16:17], v[16:17], 1.0 op_sel_hi:[1,0]
    v_pk_add_f32 v[18:19], v[18:19], 1.0 op_sel_hi:[1,0]
    v_pk_add_f32 v[20:21], v[20:21], 1.0 op_sel_hi:[1,0]
    v_pk_add_f32 v[22:23], v[22:23], 1.0 op_sel_hi:[1,0]
    ds_read_b128 v[32:35], v6 offset:26624
    ds_read_b128 v[252:255], v6 offset:27648
    v_mfma_f32_16x16x32_bf16 v[204:207], v[236:239], v[240:243], 0
    v_rcp_f32_e64 v16, v16
    v_mfma_f32_16x16x32_bf16 v[204:207], v[244:247], v[248:251], v[204:207]
    v_rcp_f32_e64 v17, v17
    v_mfma_f32_16x16x32_bf16 v[204:207], v[164:167], v[168:171], v[204:207]
    v_rcp_f32_e64 v18, v18
    v_mfma_f32_16x16x32_bf16 v[208:211], v[124:127], v[128:131], 0
    v_rcp_f32_e64 v19, v19
    v_mfma_f32_16x16x32_bf16 v[208:211], v[132:135], v[136:139], v[208:211]
    v_rcp_f32_e64 v20, v20
    v_mfma_f32_16x16x32_bf16 v[208:211], v[172:175], v[176:179], v[208:211]
    v_rcp_f32 v21, v21
    v_rcp_f32 v22, v22
    v_rcp_f32_e64 v23, v23
    v_pk_mul_f32 v[16:17], v[16:17], v[44:45]
    v_pk_mul_f32 v[18:19], v[18:19], v[46:47]
    v_pk_mul_f32 v[20:21], v[20:21], v[48:49]
    v_pk_mul_f32 v[22:23], v[22:23], v[50:51]
    v_cvt_pk_bf16_f32 v160, v16, v17
    v_cvt_pk_bf16_f32 v161, v18, v19
    v_cvt_pk_bf16_f32 v162, v20, v21
    v_cvt_pk_bf16_f32 v163, v22, v23
    v_dot2_f32_bf16 v11, v160, v160, v11
    v_dot2_f32_bf16 v11, v161, v161, v11
    v_dot2_f32_bf16 v11, v162, v162, v11
    v_dot2_f32_bf16 v11, v163, v163, v11
    v_pk_fma_f32 v[16:17], v[52:53], v[52:53], s[34:35]
    v_pk_fma_f32 v[18:19], v[54:55], v[54:55], s[34:35]
    v_pk_fma_f32 v[20:21], v[56:57], v[56:57], s[34:35]
    v_pk_fma_f32 v[22:23], v[58:59], v[58:59], s[34:35]
    v_pk_mul_f32 v[16:17], v[16:17], v[52:53]
    v_pk_mul_f32 v[18:19], v[18:19], v[54:55]
    v_pk_mul_f32 v[20:21], v[20:21], v[56:57]
    v_pk_mul_f32 v[22:23], v[22:23], v[58:59]
    v_cvt_f64_f32 v[12:13], v11
    s_waitcnt lgkmcnt(0)
    ds_read_b128 v[236:239], v2 offset:7200
    ds_read_b128 v[240:243], v3 offset:96
    ds_read_b128 v[244:247], v2 offset:7600
    ds_read_b128 v[248:251], v4 offset:96
    ds_read_b128 v[124:127], v2 offset:8000
    ds_read_b128 v[128:131], v5 offset:96
    v_mfma_f32_32x32x16_bf16 v[36:51], v[68:71], v[24:27], 0
    v_exp_f32 v16, v16
    v_exp_f32 v17, v17
    v_exp_f32_e64 v18, v18
    v_mfma_f32_32x32x16_bf16 v[36:51], v[72:75], v[28:31], v[36:51]
    v_exp_f32 v19, v19
    v_exp_f32 v20, v20
    v_exp_f32 v21, v21
    v_exp_f32 v22, v22
    v_exp_f32_e64 v23, v23
    v_pk_add_f32 v[16:17], v[16:17], 1.0 op_sel_hi:[1,0]
    v_pk_add_f32 v[18:19], v[18:19], 1.0 op_sel_hi:[1,0]
    v_pk_add_f32 v[20:21], v[20:21], 1.0 op_sel_hi:[1,0]
    v_pk_add_f32 v[22:23], v[22:23], 1.0 op_sel_hi:[1,0]
    ds_read_b128 v[24:27], v6 offset:28672
    ds_read_b128 v[28:31], v6 offset:29696
    ds_add_f64 v8, v[12:13] offset:2048
    ds_read_b128 v[132:135], v2 offset:8400
    ds_read_b128 v[136:139], v3 offset:112
    ds_read_b128 v[172:175], v2 offset:8800
    ds_read_b128 v[176:179], v4 offset:112
    ds_read_b128 v[180:183], v2 offset:9200
    ds_read_b128 v[184:187], v5 offset:112
    v_mfma_f32_32x32x16_bf16 v[36:51], v[76:79], v[32:35], v[36:51]
    v_rcp_f32 v16, v16
    v_rcp_f32 v17, v17
    v_rcp_f32_e64 v18, v18
    v_mfma_f32_32x32x16_bf16 v[36:51], v[80:83], v[252:255], v[36:51]
    v_rcp_f32 v19, v19
    v_rcp_f32 v20, v20
    v_rcp_f32 v21, v21
    v_rcp_f32 v22, v22
    v_rcp_f32_e64 v23, v23
    v_pk_mul_f32 v[16:17], v[16:17], v[52:53]
    v_pk_mul_f32 v[18:19], v[18:19], v[54:55]
    v_pk_mul_f32 v[20:21], v[20:21], v[56:57]
    v_pk_mul_f32 v[22:23], v[22:23], v[58:59]
    v_cvt_pk_bf16_f32 v164, v16, v17
    v_cvt_pk_bf16_f32 v165, v18, v19
    v_cvt_pk_bf16_f32 v166, v20, v21
    v_cvt_pk_bf16_f32 v167, v22, v23
    v_dot2_f32_bf16 v11, v164, v164, 0
    v_dot2_f32_bf16 v11, v165, v165, v11
    v_dot2_f32_bf16 v11, v166, v166, v11
    v_dot2_f32_bf16 v11, v167, v167, v11
    v_pk_fma_f32 v[16:17], v[60:61], v[60:61], s[34:35]
    v_pk_fma_f32 v[18:19], v[62:63], v[62:63], s[34:35]
    v_pk_fma_f32 v[20:21], v[64:65], v[64:65], s[34:35]
    v_pk_fma_f32 v[22:23], v[66:67], v[66:67], s[34:35]
    v_pk_mul_f32 v[16:17], v[16:17], v[60:61]
    v_pk_mul_f32 v[18:19], v[18:19], v[62:63]
    v_pk_mul_f32 v[20:21], v[20:21], v[64:65]
    v_pk_mul_f32 v[22:23], v[22:23], v[66:67]
    s_waitcnt lgkmcnt(7)
    s_waitcnt lgkmcnt(0)
    ds_read_b128 v[32:35], v6 offset:30720
    ds_read_b128 v[252:255], v6 offset:31744
    v_mfma_f32_32x32x16_bf16 v[36:51], v[84:87], v[24:27], v[36:51]
    v_exp_f32 v16, v16
    v_exp_f32 v17, v17
    v_exp_f32_e64 v18, v18
    v_mfma_f32_32x32x16_bf16 v[36:51], v[88:91], v[28:31], v[36:51]
    v_exp_f32 v19, v19
    v_exp_f32 v20, v20
    v_exp_f32 v21, v21
    v_exp_f32 v22, v22
    v_exp_f32_e64 v23, v23
    v_pk_add_f32 v[16:17], v[16:17], 1.0 op_sel_hi:[1,0]
    v_pk_add_f32 v[18:19], v[18:19], 1.0 op_sel_hi:[1,0]
    v_pk_add_f32 v[20:21], v[20:21], 1.0 op_sel_hi:[1,0]
    v_pk_add_f32 v[22:23], v[22:23], 1.0 op_sel_hi:[1,0]
    ds_read_b128 v[24:27], v6 offset:32768
    ds_read_b128 v[28:31], v6 offset:33792
    v_mfma_f32_16x16x32_bf16 v[212:215], v[236:239], v[240:243], 0
    v_rcp_f32_e64 v16, v16
    v_mfma_f32_16x16x32_bf16 v[212:215], v[244:247], v[248:251], v[212:215]
    v_rcp_f32_e64 v17, v17
    v_mfma_f32_16x16x32_bf16 v[212:215], v[124:127], v[128:131], v[212:215]
    v_rcp_f32_e64 v18, v18
    v_mfma_f32_16x16x32_bf16 v[216:219], v[132:135], v[136:139], 0
    v_rcp_f32_e64 v19, v19
    v_mfma_f32_16x16x32_bf16 v[216:219], v[172:175], v[176:179], v[216:219]
    v_rcp_f32_e64 v20, v20
    v_mfma_f32_16x16x32_bf16 v[216:219], v[180:183], v[184:187], v[216:219]
    v_rcp_f32 v21, v21
    v_rcp_f32 v22, v22
    v_rcp_f32_e64 v23, v23
    v_pk_mul_f32 v[16:17], v[16:17], v[60:61]
    v_pk_mul_f32 v[18:19], v[18:19], v[62:63]
    v_pk_mul_f32 v[20:21], v[20:21], v[64:65]
    v_pk_mul_f32 v[22:23], v[22:23], v[66:67]
    v_cvt_pk_bf16_f32 v168, v16, v17
    v_cvt_pk_bf16_f32 v169, v18, v19
    v_cvt_pk_bf16_f32 v170, v20, v21
    v_cvt_pk_bf16_f32 v171, v22, v23
    v_dot2_f32_bf16 v11, v168, v168, v11
    v_dot2_f32_bf16 v11, v169, v169, v11
    v_dot2_f32_bf16 v11, v170, v170, v11
    v_dot2_f32_bf16 v11, v171, v171, v11
    v_pk_fma_f32 v[16:17], v[36:37], v[36:37], s[34:35]
    v_pk_fma_f32 v[18:19], v[38:39], v[38:39], s[34:35]
    v_pk_fma_f32 v[20:21], v[40:41], v[40:41], s[34:35]
    v_pk_fma_f32 v[22:23], v[42:43], v[42:43], s[34:35]
    v_pk_mul_f32 v[16:17], v[16:17], v[36:37]
    v_pk_mul_f32 v[18:19], v[18:19], v[38:39]
    v_pk_mul_f32 v[20:21], v[20:21], v[40:41]
    v_pk_mul_f32 v[22:23], v[22:23], v[42:43]
    v_cvt_f64_f32 v[12:13], v11
    s_waitcnt lgkmcnt(0)
    ds_read_b128 v[236:239], v2 offset:9600
    ds_read_b128 v[240:243], v3 offset:128
    ds_read_b128 v[244:247], v2 offset:10000
    ds_read_b128 v[248:251], v4 offset:128
    ds_read_b128 v[132:135], v2 offset:10400
    ds_read_b128 v[136:139], v5 offset:128
    v_mfma_f32_32x32x16_bf16 v[52:67], v[68:71], v[32:35], 0
    v_exp_f32 v16, v16
    v_exp_f32 v17, v17
    v_exp_f32_e64 v18, v18
    v_mfma_f32_32x32x16_bf16 v[52:67], v[72:75], v[252:255], v[52:67]
    v_exp_f32 v19, v19
    v_exp_f32 v20, v20
    v_exp_f32 v21, v21
    v_exp_f32 v22, v22
    v_exp_f32_e64 v23, v23
    v_pk_add_f32 v[16:17], v[16:17], 1.0 op_sel_hi:[1,0]
    v_pk_add_f32 v[18:19], v[18:19], 1.0 op_sel_hi:[1,0]
    v_pk_add_f32 v[20:21], v[20:21], 1.0 op_sel_hi:[1,0]
    v_pk_add_f32 v[22:23], v[22:23], 1.0 op_sel_hi:[1,0]
    ds_read_b128 v[32:35], v6 offset:34816
    ds_read_b128 v[252:255], v6 offset:35840
    ds_add_f64 v8, v[12:13] offset:2304
    ds_read_b128 v[172:175], v2 offset:10800
    ds_read_b128 v[176:179], v3 offset:144
    ds_read_b128 v[180:183], v2 offset:11200
    ds_read_b128 v[184:187], v4 offset:144
    v_mfma_f32_32x32x16_bf16 v[52:67], v[76:79], v[24:27], v[52:67]
    v_rcp_f32 v16, v16
    v_rcp_f32 v17, v17
    v_rcp_f32_e64 v18, v18
    v_mfma_f32_32x32x16_bf16 v[52:67], v[80:83], v[28:31], v[52:67]
    v_rcp_f32 v19, v19
    v_rcp_f32 v20, v20
    v_rcp_f32 v21, v21
    v_rcp_f32 v22, v22
    v_rcp_f32_e64 v23, v23
    v_pk_mul_f32 v[16:17], v[16:17], v[36:37]
    v_pk_mul_f32 v[18:19], v[18:19], v[38:39]
    v_pk_mul_f32 v[20:21], v[20:21], v[40:41]
    v_pk_mul_f32 v[22:23], v[22:23], v[42:43]
    v_cvt_pk_bf16_f32 v124, v16, v17
    v_cvt_pk_bf16_f32 v125, v18, v19
    v_cvt_pk_bf16_f32 v126, v20, v21
    v_cvt_pk_bf16_f32 v127, v22, v23
    v_dot2_f32_bf16 v11, v124, v124, 0
    v_dot2_f32_bf16 v11, v125, v125, v11
    v_dot2_f32_bf16 v11, v126, v126, v11
    v_dot2_f32_bf16 v11, v127, v127, v11
    v_pk_fma_f32 v[16:17], v[44:45], v[44:45], s[34:35]
    v_pk_fma_f32 v[18:19], v[46:47], v[46:47], s[34:35]
    v_pk_fma_f32 v[20:21], v[48:49], v[48:49], s[34:35]
    v_pk_fma_f32 v[22:23], v[50:51], v[50:51], s[34:35]
    v_pk_mul_f32 v[16:17], v[16:17], v[44:45]
    v_pk_mul_f32 v[18:19], v[18:19], v[46:47]
    v_pk_mul_f32 v[20:21], v[20:21], v[48:49]
    v_pk_mul_f32 v[22:23], v[22:23], v[50:51]
    s_waitcnt lgkmcnt(5)
    s_waitcnt lgkmcnt(0)
    ds_read_b128 v[24:27], v7 offset:24576
    ds_read_b128 v[28:31], v7 offset:25600
    v_mfma_f32_32x32x16_bf16 v[52:67], v[84:87], v[32:35], v[52:67]
    v_exp_f32 v16, v16
    v_exp_f32 v17, v17
    v_exp_f32_e64 v18, v18
    v_mfma_f32_32x32x16_bf16 v[52:67], v[88:91], v[252:255], v[52:67]
    v_exp_f32 v19, v19
    v_exp_f32 v20, v20
    v_exp_f32 v21, v21
    v_exp_f32 v22, v22
    v_exp_f32_e64 v23, v23
    v_pk_add_f32 v[16:17], v[16:17], 1.0 op_sel_hi:[1,0]
    v_pk_add_f32 v[18:19], v[18:19], 1.0 op_sel_hi:[1,0]
    v_pk_add_f32 v[20:21], v[20:21], 1.0 op_sel_hi:[1,0]
    v_pk_add_f32 v[22:23], v[22:23], 1.0 op_sel_hi:[1,0]
    ds_read_b128 v[32:35], v7 offset:26624
    ds_read_b128 v[252:255], v7 offset:27648
    v_mfma_f32_16x16x32_bf16 v[220:223], v[236:239], v[240:243], 0
    v_rcp_f32_e64 v16, v16
    v_mfma_f32_16x16x32_bf16 v[220:223], v[244:247], v[248:251], v[220:223]
    v_rcp_f32_e64 v17, v17
    v_mfma_f32_16x16x32_bf16 v[220:223], v[132:135], v[136:139], v[220:223]
    v_rcp_f32_e64 v18, v18
    v_mfma_f32_16x16x32_bf16 v[224:227], v[172:175], v[176:179], 0
    v_rcp_f32_e64 v19, v19
    v_mfma_f32_16x16x32_bf16 v[224:227], v[180:183], v[184:187], v[224:227]
    v_rcp_f32 v20, v20
    v_rcp_f32 v21, v21
    v_rcp_f32 v22, v22
    v_rcp_f32 v23, v23
    v_pk_mul_f32 v[16:17], v[16:17], v[44:45]
    v_pk_mul_f32 v[18:19], v[18:19], v[46:47]
    v_pk_mul_f32 v[20:21], v[20:21], v[48:49]
    v_pk_mul_f32 v[22:23], v[22:23], v[50:51]
    v_cvt_pk_bf16_f32 v128, v16, v17
    v_cvt_pk_bf16_f32 v129, v18, v19
    v_cvt_pk_bf16_f32 v130, v20, v21
    v_cvt_pk_bf16_f32 v131, v22, v23
    v_dot2_f32_bf16 v11, v128, v128, v11
    v_dot2_f32_bf16 v11, v129, v129, v11
    v_dot2_f32_bf16 v11, v130, v130, v11
    v_dot2_f32_bf16 v11, v131, v131, v11
    v_pk_fma_f32 v[16:17], v[52:53], v[52:53], s[34:35]
    v_pk_fma_f32 v[18:19], v[54:55], v[54:55], s[34:35]
    v_pk_fma_f32 v[20:21], v[56:57], v[56:57], s[34:35]
    v_pk_fma_f32 v[22:23], v[58:59], v[58:59], s[34:35]
    v_pk_mul_f32 v[16:17], v[16:17], v[52:53]
    v_pk_mul_f32 v[18:19], v[18:19], v[54:55]
    v_pk_mul_f32 v[20:21], v[20:21], v[56:57]
    v_pk_mul_f32 v[22:23], v[22:23], v[58:59]
    v_cvt_f64_f32 v[12:13], v11
    s_waitcnt lgkmcnt(0)
    ds_read_b128 v[236:239], v2 offset:11600
    ds_read_b128 v[240:243], v5 offset:144
    ds_read_b128 v[244:247], v2 offset:12000
    ds_read_b128 v[248:251], v3 offset:160
    v_mfma_f32_32x32x16_bf16 v[36:51], v[68:71], v[24:27], 0
    v_exp_f32 v16, v16
    v_exp_f32 v17, v17
    v_exp_f32_e64 v18, v18
    v_mfma_f32_32x32x16_bf16 v[36:51], v[72:75], v[28:31], v[36:51]
    v_exp_f32 v19, v19
    v_exp_f32 v20, v20
    v_exp_f32 v21, v21
    v_exp_f32 v22, v22
    v_exp_f32_e64 v23, v23
    v_pk_add_f32 v[16:17], v[16:17], 1.0 op_sel_hi:[1,0]
    v_pk_add_f32 v[18:19], v[18:19], 1.0 op_sel_hi:[1,0]
    v_pk_add_f32 v[20:21], v[20:21], 1.0 op_sel_hi:[1,0]
    v_pk_add_f32 v[22:23], v[22:23], 1.0 op_sel_hi:[1,0]
    ds_read_b128 v[24:27], v7 offset:28672
    ds_read_b128 v[28:31], v7 offset:29696
    ds_add_f64 v8, v[12:13] offset:1024
    ds_read_b128 v[172:175], v2 offset:12400
    ds_read_b128 v[176:179], v4 offset:160
    ds_read_b128 v[180:183], v2 offset:12800
    ds_read_b128 v[184:187], v5 offset:160
    v_mfma_f32_32x32x16_bf16 v[36:51], v[76:79], v[32:35], v[36:51]
    v_rcp_f32 v16, v16
    v_rcp_f32 v17, v17
    v_rcp_f32_e64 v18, v18
    v_mfma_f32_32x32x16_bf16 v[36:51], v[80:83], v[252:255], v[36:51]
    v_rcp_f32 v19, v19
    v_rcp_f32 v20, v20
    v_rcp_f32 v21, v21
    v_rcp_f32 v22, v22
    v_rcp_f32_e64 v23, v23
    v_pk_mul_f32 v[16:17], v[16:17], v[52:53]
    v_pk_mul_f32 v[18:19], v[18:19], v[54:55]
    v_pk_mul_f32 v[20:21], v[20:21], v[56:57]
    v_pk_mul_f32 v[22:23], v[22:23], v[58:59]
    v_cvt_pk_bf16_f32 v132, v16, v17
    v_cvt_pk_bf16_f32 v133, v18, v19
    v_cvt_pk_bf16_f32 v134, v20, v21
    v_cvt_pk_bf16_f32 v135, v22, v23
    v_dot2_f32_bf16 v11, v132, v132, 0
    v_dot2_f32_bf16 v11, v133, v133, v11
    v_dot2_f32_bf16 v11, v134, v134, v11
    v_dot2_f32_bf16 v11, v135, v135, v11
    v_pk_fma_f32 v[16:17], v[60:61], v[60:61], s[34:35]
    v_pk_fma_f32 v[18:19], v[62:63], v[62:63], s[34:35]
    v_pk_fma_f32 v[20:21], v[64:65], v[64:65], s[34:35]
    v_pk_fma_f32 v[22:23], v[66:67], v[66:67], s[34:35]
    v_pk_mul_f32 v[16:17], v[16:17], v[60:61]
    v_pk_mul_f32 v[18:19], v[18:19], v[62:63]
    v_pk_mul_f32 v[20:21], v[20:21], v[64:65]
    v_pk_mul_f32 v[22:23], v[22:23], v[66:67]
    s_waitcnt lgkmcnt(5)
    s_waitcnt lgkmcnt(0)
    ds_read_b128 v[32:35], v7 offset:30720
    ds_read_b128 v[252:255], v7 offset:31744
    v_mfma_f32_32x32x16_bf16 v[36:51], v[84:87], v[24:27], v[36:51]
    v_exp_f32 v16, v16
    v_exp_f32 v17, v17
    v_exp_f32_e64 v18, v18
    v_mfma_f32_32x32x16_bf16 v[36:51], v[88:91], v[28:31], v[36:51]
    v_exp_f32 v19, v19
    v_exp_f32 v20, v20
    v_exp_f32 v21, v21
    v_exp_f32 v22, v22
    v_exp_f32_e64 v23, v23
    v_pk_add_f32 v[16:17], v[16:17], 1.0 op_sel_hi:[1,0]
    v_pk_add_f32 v[18:19], v[18:19], 1.0 op_sel_hi:[1,0]
    v_pk_add_f32 v[20:21], v[20:21], 1.0 op_sel_hi:[1,0]
    v_pk_add_f32 v[22:23], v[22:23], 1.0 op_sel_hi:[1,0]
    ds_read_b128 v[24:27], v7 offset:32768
    ds_read_b128 v[28:31], v7 offset:33792
    v_mfma_f32_16x16x32_bf16 v[224:227], v[236:239], v[240:243], v[224:227]
    v_rcp_f32_e64 v16, v16
    v_mfma_f32_16x16x32_bf16 v[228:231], v[244:247], v[248:251], 0
    v_rcp_f32_e64 v17, v17
    v_mfma_f32_16x16x32_bf16 v[228:231], v[172:175], v[176:179], v[228:231]
    v_rcp_f32_e64 v18, v18
    v_mfma_f32_16x16x32_bf16 v[228:231], v[180:183], v[184:187], v[228:231]
    v_rcp_f32 v19, v19
    v_rcp_f32 v20, v20
    v_rcp_f32 v21, v21
    v_rcp_f32 v22, v22
    v_rcp_f32_e64 v23, v23
    v_pk_mul_f32 v[16:17], v[16:17], v[60:61]
    v_pk_mul_f32 v[18:19], v[18:19], v[62:63]
    v_pk_mul_f32 v[20:21], v[20:21], v[64:65]
    v_pk_mul_f32 v[22:23], v[22:23], v[66:67]
    v_cvt_pk_bf16_f32 v136, v16, v17
    v_cvt_pk_bf16_f32 v137, v18, v19
    v_cvt_pk_bf16_f32 v138, v20, v21
    v_cvt_pk_bf16_f32 v139, v22, v23
    v_dot2_f32_bf16 v11, v136, v136, v11
    v_dot2_f32_bf16 v11, v137, v137, v11
    v_dot2_f32_bf16 v11, v138, v138, v11
    v_dot2_f32_bf16 v11, v139, v139, v11
    v_pk_fma_f32 v[16:17], v[36:37], v[36:37], s[34:35]
    v_pk_fma_f32 v[18:19], v[38:39], v[38:39], s[34:35]
    v_pk_fma_f32 v[20:21], v[40:41], v[40:41], s[34:35]
    v_pk_fma_f32 v[22:23], v[42:43], v[42:43], s[34:35]
    v_pk_mul_f32 v[16:17], v[16:17], v[36:37]
    v_pk_mul_f32 v[18:19], v[18:19], v[38:39]
    v_pk_mul_f32 v[20:21], v[20:21], v[40:41]
    v_pk_mul_f32 v[22:23], v[22:23], v[42:43]
    v_cvt_f64_f32 v[12:13], v11
    s_waitcnt lgkmcnt(0)
    ds_read_b128 v[236:239], v2 offset:13200
    ds_read_b128 v[240:243], v3 offset:176
    ds_read_b128 v[244:247], v2 offset:13600
    ds_read_b128 v[248:251], v4 offset:176
    v_mfma_f32_32x32x16_bf16 v[52:67], v[68:71], v[32:35], 0
    v_exp_f32 v16, v16
    v_exp_f32 v17, v17
    v_exp_f32_e64 v18, v18
    v_mfma_f32_32x32x16_bf16 v[52:67], v[72:75], v[252:255], v[52:67]
    v_exp_f32 v19, v19
    v_exp_f32 v20, v20
    v_exp_f32 v21, v21
    v_exp_f32 v22, v22
    v_exp_f32_e64 v23, v23
    v_pk_add_f32 v[16:17], v[16:17], 1.0 op_sel_hi:[1,0]
    v_pk_add_f32 v[18:19], v[18:19], 1.0 op_sel_hi:[1,0]
    v_pk_add_f32 v[20:21], v[20:21], 1.0 op_sel_hi:[1,0]
    v_pk_add_f32 v[22:23], v[22:23], 1.0 op_sel_hi:[1,0]
    ds_read_b128 v[32:35], v7 offset:34816
    ds_read_b128 v[252:255], v7 offset:35840
    ds_add_f64 v8, v[12:13] offset:1280
    ds_read_b128 v[180:183], v2 offset:14000
    ds_read_b128 v[184:187], v5 offset:176
    v_mfma_f32_32x32x16_bf16 v[52:67], v[76:79], v[24:27], v[52:67]
    v_rcp_f32 v16, v16
    v_rcp_f32 v17, v17
    v_rcp_f32_e64 v18, v18
    v_mfma_f32_32x32x16_bf16 v[52:67], v[80:83], v[28:31], v[52:67]
    v_rcp_f32 v19, v19
    v_rcp_f32 v20, v20
    v_rcp_f32 v21, v21
    v_rcp_f32 v22, v22
    v_rcp_f32_e64 v23, v23
    v_pk_mul_f32 v[16:17], v[16:17], v[36:37]
    v_pk_mul_f32 v[18:19], v[18:19], v[38:39]
    v_pk_mul_f32 v[20:21], v[20:21], v[40:41]
    v_pk_mul_f32 v[22:23], v[22:23], v[42:43]
    v_cvt_pk_bf16_f32 v172, v16, v17
    v_cvt_pk_bf16_f32 v173, v18, v19
    v_cvt_pk_bf16_f32 v174, v20, v21
    v_cvt_pk_bf16_f32 v175, v22, v23
    v_dot2_f32_bf16 v11, v172, v172, 0
    v_dot2_f32_bf16 v11, v173, v173, v11
    v_dot2_f32_bf16 v11, v174, v174, v11
    v_dot2_f32_bf16 v11, v175, v175, v11
    v_pk_fma_f32 v[16:17], v[44:45], v[44:45], s[34:35]
    v_pk_fma_f32 v[18:19], v[46:47], v[46:47], s[34:35]
    v_pk_fma_f32 v[20:21], v[48:49], v[48:49], s[34:35]
    v_pk_fma_f32 v[22:23], v[50:51], v[50:51], s[34:35]
    v_pk_mul_f32 v[16:17], v[16:17], v[44:45]
    v_pk_mul_f32 v[18:19], v[18:19], v[46:47]
    v_pk_mul_f32 v[20:21], v[20:21], v[48:49]
    v_pk_mul_f32 v[22:23], v[22:23], v[50:51]
    s_waitcnt lgkmcnt(3)
    s_waitcnt lgkmcnt(0)
    ds_read_b128 v[24:27], v6 offset:0
    ds_read_b128 v[28:31], v6 offset:1024
    v_mfma_f32_32x32x16_bf16 v[52:67], v[84:87], v[32:35], v[52:67]
    v_exp_f32 v16, v16
    v_exp_f32 v17, v17
    v_exp_f32_e64 v18, v18
    v_mfma_f32_32x32x16_bf16 v[52:67], v[88:91], v[252:255], v[52:67]
    v_exp_f32 v19, v19
    v_exp_f32 v20, v20
    v_exp_f32 v21, v21
    v_exp_f32 v22, v22
    v_exp_f32_e64 v23, v23
    v_pk_add_f32 v[16:17], v[16:17], 1.0 op_sel_hi:[1,0]
    v_pk_add_f32 v[18:19], v[18:19], 1.0 op_sel_hi:[1,0]
    v_pk_add_f32 v[20:21], v[20:21], 1.0 op_sel_hi:[1,0]
    v_pk_add_f32 v[22:23], v[22:23], 1.0 op_sel_hi:[1,0]
    ds_read_b128 v[32:35], v6 offset:2048
    ds_read_b128 v[252:255], v6 offset:3072
    v_mfma_f32_16x16x32_bf16 v[232:235], v[236:239], v[240:243], 0
    v_rcp_f32_e64 v16, v16
    v_mfma_f32_16x16x32_bf16 v[232:235], v[244:247], v[248:251], v[232:235]
    v_rcp_f32_e64 v17, v17
    v_mfma_f32_16x16x32_bf16 v[232:235], v[180:183], v[184:187], v[232:235]
    v_rcp_f32 v18, v18
    v_rcp_f32 v19, v19
    v_rcp_f32 v20, v20
    v_rcp_f32 v21, v21
    v_rcp_f32 v22, v22
    v_rcp_f32 v23, v23
    v_pk_mul_f32 v[16:17], v[16:17], v[44:45]
    v_pk_mul_f32 v[18:19], v[18:19], v[46:47]
    v_pk_mul_f32 v[20:21], v[20:21], v[48:49]
    v_pk_mul_f32 v[22:23], v[22:23], v[50:51]
    v_cvt_pk_bf16_f32 v176, v16, v17
    v_cvt_pk_bf16_f32 v177, v18, v19
    v_cvt_pk_bf16_f32 v178, v20, v21
    v_cvt_pk_bf16_f32 v179, v22, v23
    v_dot2_f32_bf16 v11, v176, v176, v11
    v_dot2_f32_bf16 v11, v177, v177, v11
    v_dot2_f32_bf16 v11, v178, v178, v11
    v_dot2_f32_bf16 v11, v179, v179, v11
    v_mov_b32 v14, 163536
    v_mov_b32 v15, 1
    s_mov_b64 exec, 1
    ds_add_u32 v14, v15 offset:52
    s_mov_b64 exec, -1
    s_nop 0
    v_pk_add_f32 v[16:17], v[188:189], v[190:191]
    v_pk_mul_f32 v[20:21], v[188:189], v[188:189]
    v_pk_add_f32 v[18:19], v[192:193], v[194:195]
    v_pk_mul_f32 v[22:23], v[190:191], v[190:191]
    v_pk_fma_f32 v[20:21], v[192:193], v[192:193], v[20:21]
    v_pk_fma_f32 v[22:23], v[194:195], v[194:195], v[22:23]
    v_pk_add_f32 v[16:17], v[16:17], v[196:197]
    v_pk_fma_f32 v[20:21], v[196:197], v[196:197], v[20:21]
    v_pk_add_f32 v[18:19], v[18:19], v[198:199]
    v_pk_fma_f32 v[22:23], v[198:199], v[198:199], v[22:23]
    v_pk_add_f32 v[16:17], v[16:17], v[200:201]
    v_pk_fma_f32 v[20:21], v[200:201], v[200:201], v[20:21]
    v_pk_add_f32 v[18:19], v[18:19], v[202:203]
    v_pk_fma_f32 v[22:23], v[202:203], v[202:203], v[22:23]
    v_pk_add_f32 v[16:17], v[16:17], v[204:205]
    v_pk_fma_f32 v[20:21], v[204:205], v[204:205], v[20:21]
    v_pk_add_f32 v[18:19], v[18:19], v[206:207]
    v_pk_fma_f32 v[22:23], v[206:207], v[206:207], v[22:23]
    v_pk_add_f32 v[16:17], v[16:17], v[208:209]
    v_pk_fma_f32 v[20:21], v[208:209], v[208:209], v[20:21]
    v_pk_add_f32 v[18:19], v[18:19], v[210:211]
    v_pk_fma_f32 v[22:23], v[210:211], v[210:211], v[22:23]
    v_pk_add_f32 v[16:17], v[16:17], v[212:213]
    v_pk_fma_f32 v[20:21], v[212:213], v[212:213], v[20:21]
    v_pk_add_f32 v[18:19], v[18:19], v[214:215]
    v_pk_fma_f32 v[22:23], v[214:215], v[214:215], v[22:23]
    v_pk_add_f32 v[16:17], v[16:17], v[216:217]
    v_pk_fma_f32 v[20:21], v[216:217], v[216:217], v[20:21]
    v_pk_add_f32 v[18:19], v[18:19], v[218:219]
    v_pk_fma_f32 v[22:23], v[218:219], v[218:219], v[22:23]
    v_pk_add_f32 v[16:17], v[16:17], v[220:221]
    v_pk_fma_f32 v[20:21], v[220:221], v[220:221], v[20:21]
    v_pk_add_f32 v[18:19], v[18:19], v[222:223]
    v_pk_fma_f32 v[22:23], v[222:223], v[222:223], v[22:23]
    v_pk_add_f32 v[16:17], v[16:17], v[224:225]
    v_pk_fma_f32 v[20:21], v[224:225], v[224:225], v[20:21]
    v_pk_add_f32 v[18:19], v[18:19], v[226:227]
    v_pk_fma_f32 v[22:23], v[226:227], v[226:227], v[22:23]
    v_pk_add_f32 v[16:17], v[16:17], v[228:229]
    v_pk_fma_f32 v[20:21], v[228:229], v[228:229], v[20:21]
    v_pk_add_f32 v[18:19], v[18:19], v[230:231]
    v_pk_fma_f32 v[22:23], v[230:231], v[230:231], v[22:23]
    v_pk_add_f32 v[16:17], v[16:17], v[232:233]
    v_pk_fma_f32 v[20:21], v[232:233], v[232:233], v[20:21]
    v_pk_add_f32 v[18:19], v[18:19], v[234:235]
    v_pk_fma_f32 v[22:23], v[234:235], v[234:235], v[22:23]
    v_pk_add_f32 v[16:17], v[16:17], v[18:19]
    v_pk_add_f32 v[20:21], v[20:21], v[22:23]
    v_add_f32 v16, v16, v17
    v_add_f32 v20, v20, v21
    v_mov_b32 v17, v16
    v_mov_b32 v21, v20
    s_nop 0
    v_permlane32_swap_b32 v16, v17
    v_permlane32_swap_b32 v20, v21
    v_add_f32 v16, v16, v17
    v_add_f32_e64 v20, v20, v21
    v_mul_f32 v16, 0x3c2aaaab, v16
    v_mul_f32 v20, 0x3c2aaaab, v20
    v_fma_f32 v20, -v16, v16, v20
    v_max_f32_e64 v20, 0, v20
    v_add_f32 v20, 0x3727c5ac, v20
    v_rsq_f32 v20, v20
    s_nop 0
    v_mul_f32 v18, 0xbeeff558, v20
    v_mul_f32 v19, -v16, v18
    v_pk_fma_f32 v[188:189], v[188:189], v[18:19], v[18:19] op_sel:[0,0,1] op_sel_hi:[1,0,1]
    v_pk_fma_f32 v[190:191], v[190:191], v[18:19], v[18:19] op_sel:[0,0,1] op_sel_hi:[1,0,1]
    v_pk_fma_f32 v[192:193], v[192:193], v[18:19], v[18:19] op_sel:[0,0,1] op_sel_hi:[1,0,1]
    v_pk_fma_f32 v[194:195], v[194:195], v[18:19], v[18:19] op_sel:[0,0,1] op_sel_hi:[1,0,1]
    v_pk_fma_f32 v[196:197], v[196:197], v[18:19], v[18:19] op_sel:[0,0,1] op_sel_hi:[1,0,1]
    v_pk_fma_f32 v[198:199], v[198:199], v[18:19], v[18:19] op_sel:[0,0,1] op_sel_hi:[1,0,1]
    v_pk_fma_f32 v[200:201], v[200:201], v[18:19], v[18:19] op_sel:[0,0,1] op_sel_hi:[1,0,1]
    v_pk_fma_f32 v[202:203], v[202:203], v[18:19], v[18:19] op_sel:[0,0,1] op_sel_hi:[1,0,1]
    v_pk_fma_f32 v[204:205], v[204:205], v[18:19], v[18:19] op_sel:[0,0,1] op_sel_hi:[1,0,1]
    v_pk_fma_f32 v[206:207], v[206:207], v[18:19], v[18:19] op_sel:[0,0,1] op_sel_hi:[1,0,1]
    v_pk_fma_f32 v[208:209], v[208:209], v[18:19], v[18:19] op_sel:[0,0,1] op_sel_hi:[1,0,1]
    v_pk_fma_f32 v[210:211], v[210:211], v[18:19], v[18:19] op_sel:[0,0,1] op_sel_hi:[1,0,1]
    v_pk_fma_f32 v[212:213], v[212:213], v[18:19], v[18:19] op_sel:[0,0,1] op_sel_hi:[1,0,1]
    v_pk_fma_f32 v[214:215], v[214:215], v[18:19], v[18:19] op_sel:[0,0,1] op_sel_hi:[1,0,1]
    v_pk_fma_f32 v[216:217], v[216:217], v[18:19], v[18:19] op_sel:[0,0,1] op_sel_hi:[1,0,1]
    v_pk_fma_f32 v[218:219], v[218:219], v[18:19], v[18:19] op_sel:[0,0,1] op_sel_hi:[1,0,1]
    v_pk_fma_f32 v[220:221], v[220:221], v[18:19], v[18:19] op_sel:[0,0,1] op_sel_hi:[1,0,1]
    v_pk_fma_f32 v[222:223], v[222:223], v[18:19], v[18:19] op_sel:[0,0,1] op_sel_hi:[1,0,1]
    v_pk_fma_f32 v[224:225], v[224:225], v[18:19], v[18:19] op_sel:[0,0,1] op_sel_hi:[1,0,1]
    v_pk_fma_f32 v[226:227], v[226:227], v[18:19], v[18:19] op_sel:[0,0,1] op_sel_hi:[1,0,1]
    v_pk_fma_f32 v[228:229], v[228:229], v[18:19], v[18:19] op_sel:[0,0,1] op_sel_hi:[1,0,1]
    v_pk_fma_f32 v[230:231], v[230:231], v[18:19], v[18:19] op_sel:[0,0,1] op_sel_hi:[1,0,1]
    v_pk_fma_f32 v[232:233], v[232:233], v[18:19], v[18:19] op_sel:[0,0,1] op_sel_hi:[1,0,1]
    v_pk_fma_f32 v[234:235], v[234:235], v[18:19], v[18:19] op_sel:[0,0,1] op_sel_hi:[1,0,1]
    v_cvt_pk_bf16_f32 v68, v188, v189
    v_cvt_pk_bf16_f32 v69, v190, v191
    v_cvt_pk_bf16_f32 v70, v192, v193
    v_cvt_pk_bf16_f32 v71, v194, v195
    v_cvt_pk_bf16_f32 v72, v196, v197
    v_cvt_pk_bf16_f32 v73, v198, v199
    v_cvt_pk_bf16_f32 v74, v200, v201
    v_cvt_pk_bf16_f32 v75, v202, v203
    v_cvt_pk_bf16_f32 v76, v204, v205
    v_cvt_pk_bf16_f32 v77, v206, v207
    v_cvt_pk_bf16_f32 v78, v208, v209
    v_cvt_pk_bf16_f32 v79, v210, v211
    v_cvt_pk_bf16_f32 v80, v212, v213
    v_cvt_pk_bf16_f32 v81, v214, v215
    v_cvt_pk_bf16_f32 v82, v216, v217
    v_cvt_pk_bf16_f32 v83, v218, v219
    v_cvt_pk_bf16_f32 v84, v220, v221
    v_cvt_pk_bf16_f32 v85, v222, v223
    v_cvt_pk_bf16_f32 v86, v224, v225
    v_cvt_pk_bf16_f32 v87, v226, v227
    v_cvt_pk_bf16_f32 v88, v228, v229
    v_cvt_pk_bf16_f32 v89, v230, v231
    v_cvt_pk_bf16_f32 v90, v232, v233
    v_cvt_pk_bf16_f32 v91, v234, v235
    s_lshl_b32 s9, s3, 12
    s_add_u32 s9, s9, 122880
    v_add_u32 v3, s9, v0
    v_xor_b32_e64 v4, 16, v3
    s_mul_i32 s14, s3, 9216
    v_lshlrev_b32_e64 v14, 7, v1
    buffer_load_dword v5, v14, s[44:47], s14 offen
    v_add_u32 v15, 8192, v14
    s_mov_b64 exec, 0xff
    buffer_load_dword v5, v15, s[44:47], s14 offen
    s_mov_b64 exec, 0x3f
    global_load_dword v5, v14, s[24:25]
    global_load_dword v5, v14, s[26:27]
    s_mov_b64 exec, -1
    v_pk_fma_f32 v[16:17], v[52:53], v[52:53], s[34:35]
    v_pk_fma_f32 v[18:19], v[54:55], v[54:55], s[34:35]
    v_pk_fma_f32 v[20:21], v[56:57], v[56:57], s[34:35]
    v_pk_fma_f32 v[22:23], v[58:59], v[58:59], s[34:35]
    v_pk_mul_f32 v[16:17], v[16:17], v[52:53]
    v_pk_mul_f32 v[18:19], v[18:19], v[54:55]
    v_pk_mul_f32 v[20:21], v[20:21], v[56:57]
    v_pk_mul_f32 v[22:23], v[22:23], v[58:59]
    v_cvt_f64_f32 v[12:13], v11
    s_waitcnt lgkmcnt(1)
    v_mfma_f32_32x32x16_bf16 v[36:51], v[68:71], v[24:27], 0
    v_exp_f32 v16, v16
    v_exp_f32 v17, v17
    v_exp_f32_e64 v18, v18
    v_mfma_f32_32x32x16_bf16 v[36:51], v[72:75], v[28:31], v[36:51]
    v_exp_f32 v19, v19
    v_exp_f32 v20, v20
    v_exp_f32 v21, v21
    v_exp_f32 v22, v22
    v_exp_f32_e64 v23, v23
    v_pk_add_f32 v[16:17], v[16:17], 1.0 op_sel_hi:[1,0]
    v_pk_add_f32 v[18:19], v[18:19], 1.0 op_sel_hi:[1,0]
    v_pk_add_f32 v[20:21], v[20:21], 1.0 op_sel_hi:[1,0]
    v_pk_add_f32 v[22:23], v[22:23], 1.0 op_sel_hi:[1,0]
    ds_read_b128 v[24:27], v6 offset:4096
    ds_read_b128 v[28:31], v6 offset:5120
    ds_add_f64 v8, v[12:13] offset:2560
    v_mfma_f32_32x32x16_bf16 v[36:51], v[76:79], v[32:35], v[36:51]
    v_rcp_f32 v16, v16
    v_rcp_f32 v17, v17
    v_rcp_f32_e64 v18, v18
    v_mfma_f32_32x32x16_bf16 v[36:51], v[80:83], v[252:255], v[36:51]
    v_rcp_f32 v19, v19
    v_rcp_f32 v20, v20
    v_rcp_f32 v21, v21
    v_rcp_f32 v22, v22
    v_rcp_f32_e64 v23, v23
    v_pk_mul_f32 v[16:17], v[16:17], v[52:53]
    v_pk_mul_f32 v[18:19], v[18:19], v[54:55]
    v_pk_mul_f32 v[20:21], v[20:21], v[56:57]
    v_pk_mul_f32 v[22:23], v[22:23], v[58:59]
    v_cvt_pk_bf16_f32 v180, v16, v17
    v_cvt_pk_bf16_f32 v181, v18, v19
    v_cvt_pk_bf16_f32 v182, v20, v21
    v_cvt_pk_bf16_f32 v183, v22, v23
    v_dot2_f32_bf16 v11, v180, v180, 0
    v_dot2_f32_bf16 v11, v181, v181, v11
    v_dot2_f32_bf16 v11, v182, v182, v11
    v_dot2_f32_bf16 v11, v183, v183, v11
    v_pk_fma_f32 v[16:17], v[60:61], v[60:61], s[34:35]
    v_pk_fma_f32 v[18:19], v[62:63], v[62:63], s[34:35]
    v_pk_fma_f32 v[20:21], v[64:65], v[64:65], s[34:35]
    v_pk_fma_f32 v[22:23], v[66:67], v[66:67], s[34:35]
    v_pk_mul_f32 v[16:17], v[16:17], v[60:61]
    v_pk_mul_f32 v[18:19], v[18:19], v[62:63]
    v_pk_mul_f32 v[20:21], v[20:21], v[64:65]
    v_pk_mul_f32 v[22:23], v[22:23], v[66:67]
    s_waitcnt lgkmcnt(1)
    ds_read_b128 v[32:35], v6 offset:6144
    ds_read_b128 v[252:255], v6 offset:7168
    v_mfma_f32_32x32x16_bf16 v[36:51], v[84:87], v[24:27], v[36:51]
    v_exp_f32 v16, v16
    v_exp_f32 v17, v17
    v_exp_f32 v18, v18
    v_mfma_f32_32x32x16_bf16 v[36:51], v[88:91], v[28:31], v[36:51]
    v_exp_f32 v19, v19
    v_exp_f32 v20, v20
    v_exp_f32 v21, v21
    v_exp_f32 v22, v22
    v_exp_f32_e64 v23, v23
    v_pk_add_f32 v[16:17], v[16:17], 1.0 op_sel_hi:[1,0]
    v_pk_add_f32 v[18:19], v[18:19], 1.0 op_sel_hi:[1,0]
    v_pk_add_f32 v[20:21], v[20:21], 1.0 op_sel_hi:[1,0]
    v_pk_add_f32 v[22:23], v[22:23], 1.0 op_sel_hi:[1,0]
    ds_read_b128 v[24:27], v6 offset:8192
    ds_read_b128 v[28:31], v6 offset:9216
    v_rcp_f32 v16, v16
    v_rcp_f32 v17, v17
    v_rcp_f32 v18, v18
    v_rcp_f32 v19, v19
    v_rcp_f32 v20, v20
    v_rcp_f32 v21, v21
    v_rcp_f32 v22, v22
    v_rcp_f32 v23, v23
    v_pk_mul_f32 v[16:17], v[16:17], v[60:61]
    v_pk_mul_f32 v[18:19], v[18:19], v[62:63]
    v_pk_mul_f32 v[20:21], v[20:21], v[64:65]
    v_pk_mul_f32 v[22:23], v[22:23], v[66:67]
    v_cvt_pk_bf16_f32 v184, v16, v17
    v_cvt_pk_bf16_f32 v185, v18, v19
    v_cvt_pk_bf16_f32 v186, v20, v21
    v_cvt_pk_bf16_f32 v187, v22, v23
    v_dot2_f32_bf16 v11, v184, v184, v11
    v_dot2_f32_bf16 v11, v185, v185, v11
    v_dot2_f32_bf16 v11, v186, v186, v11
    v_dot2_f32_bf16 v11, v187, v187, v11
    v_pk_fma_f32 v[16:17], v[36:37], v[36:37], s[34:35]
    v_pk_fma_f32 v[18:19], v[38:39], v[38:39], s[34:35]
    v_pk_fma_f32 v[20:21], v[40:41], v[40:41], s[34:35]
    v_pk_fma_f32 v[22:23], v[42:43], v[42:43], s[34:35]
    v_pk_mul_f32 v[16:17], v[16:17], v[36:37]
    v_pk_mul_f32 v[18:19], v[18:19], v[38:39]
    v_pk_mul_f32 v[20:21], v[20:21], v[40:41]
    v_pk_mul_f32 v[22:23], v[22:23], v[42:43]
    s_setprio 2
    v_cvt_f64_f32_e64 v[12:13], v11
    s_waitcnt lgkmcnt(0)
    v_mfma_f32_32x32x16_bf16 v[52:67], v[68:71], v[32:35], 0
    v_exp_f32 v16, v16
    v_exp_f32 v17, v17
    v_exp_f32_e64 v18, v18
    v_mfma_f32_32x32x16_bf16 v[52:67], v[72:75], v[252:255], v[52:67]
    v_exp_f32 v19, v19
    v_exp_f32 v20, v20
    v_exp_f32 v21, v21
    v_exp_f32 v22, v22
    v_exp_f32_e64 v23, v23
    v_pk_add_f32 v[16:17], v[16:17], 1.0 op_sel_hi:[1,0]
    v_pk_add_f32 v[18:19], v[18:19], 1.0 op_sel_hi:[1,0]
    v_pk_add_f32 v[20:21], v[20:21], 1.0 op_sel_hi:[1,0]
    v_pk_add_f32 v[22:23], v[22:23], 1.0 op_sel_hi:[1,0]
    ds_read_b128 v[32:35], v6 offset:10240
    ds_read_b128 v[252:255], v6 offset:11264
    ds_add_f64 v8, v[12:13] offset:2816
    v_mfma_f32_32x32x16_bf16 v[52:67], v[76:79], v[24:27], v[52:67]
    v_rcp_f32 v16, v16
    v_rcp_f32 v17, v17
    v_rcp_f32_e64 v18, v18
    v_mfma_f32_32x32x16_bf16 v[52:67], v[80:83], v[28:31], v[52:67]
    v_rcp_f32 v19, v19
    v_rcp_f32 v20, v20
    v_rcp_f32 v21, v21
    v_rcp_f32 v22, v22
    v_rcp_f32_e64 v23, v23
    v_pk_mul_f32 v[16:17], v[16:17], v[36:37]
    v_pk_mul_f32 v[18:19], v[18:19], v[38:39]
    v_pk_mul_f32 v[20:21], v[20:21], v[40:41]
    v_pk_mul_f32 v[22:23], v[22:23], v[42:43]
    v_cvt_pk_bf16_f32 v188, v16, v17
    v_cvt_pk_bf16_f32 v189, v18, v19
    v_cvt_pk_bf16_f32 v190, v20, v21
    v_cvt_pk_bf16_f32 v191, v22, v23
    v_dot2_f32_bf16 v11, v188, v188, 0
    v_dot2_f32_bf16 v11, v189, v189, v11
    v_dot2_f32_bf16 v11, v190, v190, v11
    v_dot2_f32_bf16 v11, v191, v191, v11
    v_pk_fma_f32 v[16:17], v[44:45], v[44:45], s[34:35]
    v_pk_fma_f32 v[18:19], v[46:47], v[46:47], s[34:35]
    v_pk_fma_f32 v[20:21], v[48:49], v[48:49], s[34:35]
    v_pk_fma_f32 v[22:23], v[50:51], v[50:51], s[34:35]
    v_pk_mul_f32 v[16:17], v[16:17], v[44:45]
    v_pk_mul_f32 v[18:19], v[18:19], v[46:47]
    v_pk_mul_f32 v[20:21], v[20:21], v[48:49]
    v_pk_mul_f32 v[22:23], v[22:23], v[50:51]
    s_waitcnt lgkmcnt(1)
    ds_read_b128 v[24:27], v6 offset:12288
    ds_read_b128 v[28:31], v6 offset:13312
    v_mfma_f32_32x32x16_bf16 v[52:67], v[84:87], v[32:35], v[52:67]
    v_exp_f32 v16, v16
    v_exp_f32 v17, v17
    v_exp_f32 v18, v18
    v_mfma_f32_32x32x16_bf16 v[52:67], v[88:91], v[252:255], v[52:67]
    v_exp_f32 v19, v19
    v_exp_f32 v20, v20
    v_exp_f32 v21, v21
    v_exp_f32 v22, v22
    v_exp_f32_e64 v23, v23
    v_pk_add_f32 v[16:17], v[16:17], 1.0 op_sel_hi:[1,0]
    v_pk_add_f32 v[18:19], v[18:19], 1.0 op_sel_hi:[1,0]
    v_pk_add_f32 v[20:21], v[20:21], 1.0 op_sel_hi:[1,0]
    v_pk_add_f32 v[22:23], v[22:23], 1.0 op_sel_hi:[1,0]
    ds_read_b128 v[32:35], v6 offset:14336
    ds_read_b128 v[252:255], v6 offset:15360
    v_rcp_f32 v16, v16
    v_rcp_f32 v17, v17
    v_rcp_f32 v18, v18
    v_rcp_f32 v19, v19
    v_rcp_f32 v20, v20
    v_rcp_f32 v21, v21
    v_rcp_f32 v22, v22
    v_rcp_f32 v23, v23
    v_pk_mul_f32 v[16:17], v[16:17], v[44:45]
    v_pk_mul_f32 v[18:19], v[18:19], v[46:47]
    v_pk_mul_f32 v[20:21], v[20:21], v[48:49]
    v_pk_mul_f32 v[22:23], v[22:23], v[50:51]
    v_cvt_pk_bf16_f32 v192, v16, v17
    v_cvt_pk_bf16_f32 v193, v18, v19
    v_cvt_pk_bf16_f32 v194, v20, v21
    v_cvt_pk_bf16_f32 v195, v22, v23
    v_dot2_f32_bf16 v11, v192, v192, v11
    v_dot2_f32_bf16 v11, v193, v193, v11
    v_dot2_f32_bf16 v11, v194, v194, v11
    v_dot2_f32_bf16 v11, v195, v195, v11
    v_pk_fma_f32 v[16:17], v[52:53], v[52:53], s[34:35]
    v_pk_fma_f32 v[18:19], v[54:55], v[54:55], s[34:35]
    v_pk_fma_f32 v[20:21], v[56:57], v[56:57], s[34:35]
    v_pk_fma_f32 v[22:23], v[58:59], v[58:59], s[34:35]
    v_pk_mul_f32 v[16:17], v[16:17], v[52:53]
    v_pk_mul_f32 v[18:19], v[18:19], v[54:55]
    v_pk_mul_f32 v[20:21], v[20:21], v[56:57]
    v_pk_mul_f32 v[22:23], v[22:23], v[58:59]
    v_cvt_f64_f32 v[12:13], v11
    s_waitcnt lgkmcnt(0)
    v_mfma_f32_32x32x16_bf16 v[36:51], v[68:71], v[24:27], 0
    v_exp_f32 v16, v16
    v_exp_f32 v17, v17
    v_exp_f32_e64 v18, v18
    v_mfma_f32_32x32x16_bf16 v[36:51], v[72:75], v[28:31], v[36:51]
    v_exp_f32 v19, v19
    v_exp_f32 v20, v20
    v_exp_f32 v21, v21
    v_exp_f32 v22, v22
    v_exp_f32_e64 v23, v23
    v_pk_add_f32 v[16:17], v[16:17], 1.0 op_sel_hi:[1,0]
    v_pk_add_f32 v[18:19], v[18:19], 1.0 op_sel_hi:[1,0]
    v_pk_add_f32 v[20:21], v[20:21], 1.0 op_sel_hi:[1,0]
    v_pk_add_f32 v[22:23], v[22:23], 1.0 op_sel_hi:[1,0]
    ds_read_b128 v[24:27], v6 offset:16384
    ds_read_b128 v[28:31], v6 offset:17408
    ds_add_f64 v8, v[12:13] offset:0
    v_mfma_f32_32x32x16_bf16 v[36:51], v[76:79], v[32:35], v[36:51]
    v_rcp_f32 v16, v16
    v_rcp_f32 v17, v17
    v_rcp_f32_e64 v18, v18
    v_mfma_f32_32x32x16_bf16 v[36:51], v[80:83], v[252:255], v[36:51]
    v_rcp_f32 v19, v19
    v_rcp_f32 v20, v20
    v_rcp_f32 v21, v21
    v_rcp_f32 v22, v22
    v_rcp_f32_e64 v23, v23
    v_pk_mul_f32 v[16:17], v[16:17], v[52:53]
    v_pk_mul_f32 v[18:19], v[18:19], v[54:55]
    v_pk_mul_f32 v[20:21], v[20:21], v[56:57]
    v_pk_mul_f32 v[22:23], v[22:23], v[58:59]
    v_cvt_pk_bf16_f32 v196, v16, v17
    v_cvt_pk_bf16_f32 v197, v18, v19
    v_cvt_pk_bf16_f32 v198, v20, v21
    v_cvt_pk_bf16_f32 v199, v22, v23
    v_dot2_f32_bf16 v11, v196, v196, 0
    v_dot2_f32_bf16 v11, v197, v197, v11
    v_dot2_f32_bf16 v11, v198, v198, v11
    v_dot2_f32_bf16 v11, v199, v199, v11
    v_pk_fma_f32 v[16:17], v[60:61], v[60:61], s[34:35]
    v_pk_fma_f32 v[18:19], v[62:63], v[62:63], s[34:35]
    v_pk_fma_f32 v[20:21], v[64:65], v[64:65], s[34:35]
    v_pk_fma_f32 v[22:23], v[66:67], v[66:67], s[34:35]
    v_pk_mul_f32 v[16:17], v[16:17], v[60:61]
    v_pk_mul_f32 v[18:19], v[18:19], v[62:63]
    v_pk_mul_f32 v[20:21], v[20:21], v[64:65]
    v_pk_mul_f32 v[22:23], v[22:23], v[66:67]
    s_waitcnt lgkmcnt(1)
    ds_read_b128 v[32:35], v6 offset:18432
    ds_read_b128 v[252:255], v6 offset:19456
    v_mfma_f32_32x32x16_bf16 v[36:51], v[84:87], v[24:27], v[36:51]
    v_exp_f32 v16, v16
    v_exp_f32 v17, v17
    v_exp_f32 v18, v18
    v_mfma_f32_32x32x16_bf16 v[36:51], v[88:91], v[28:31], v[36:51]
    v_exp_f32 v19, v19
    v_exp_f32 v20, v20
    v_exp_f32 v21, v21
    v_exp_f32 v22, v22
    v_exp_f32_e64 v23, v23
    v_pk_add_f32 v[16:17], v[16:17], 1.0 op_sel_hi:[1,0]
    v_pk_add_f32 v[18:19], v[18:19], 1.0 op_sel_hi:[1,0]
    v_pk_add_f32 v[20:21], v[20:21], 1.0 op_sel_hi:[1,0]
    v_pk_add_f32 v[22:23], v[22:23], 1.0 op_sel_hi:[1,0]
    ds_read_b128 v[24:27], v6 offset:20480
    ds_read_b128 v[28:31], v6 offset:21504
    v_rcp_f32 v16, v16
    v_rcp_f32 v17, v17
    v_rcp_f32 v18, v18
    v_rcp_f32 v19, v19
    v_rcp_f32 v20, v20
    v_rcp_f32 v21, v21
    v_rcp_f32 v22, v22
    v_rcp_f32 v23, v23
    v_pk_mul_f32 v[16:17], v[16:17], v[60:61]
    v_pk_mul_f32 v[18:19], v[18:19], v[62:63]
    v_pk_mul_f32 v[20:21], v[20:21], v[64:65]
    v_pk_mul_f32 v[22:23], v[22:23], v[66:67]
    v_cvt_pk_bf16_f32 v200, v16, v17
    v_cvt_pk_bf16_f32 v201, v18, v19
    v_cvt_pk_bf16_f32 v202, v20, v21
    v_cvt_pk_bf16_f32 v203, v22, v23
    v_dot2_f32_bf16 v11, v200, v200, v11
    v_dot2_f32_bf16 v11, v201, v201, v11
    v_dot2_f32_bf16 v11, v202, v202, v11
    v_dot2_f32_bf16 v11, v203, v203, v11
    v_pk_fma_f32 v[16:17], v[36:37], v[36:37], s[34:35]
    v_pk_fma_f32 v[18:19], v[38:39], v[38:39], s[34:35]
    v_pk_fma_f32 v[20:21], v[40:41], v[40:41], s[34:35]
    v_pk_fma_f32 v[22:23], v[42:43], v[42:43], s[34:35]
    v_pk_mul_f32 v[16:17], v[16:17], v[36:37]
    v_pk_mul_f32 v[18:19], v[18:19], v[38:39]
    v_pk_mul_f32 v[20:21], v[20:21], v[40:41]
    v_pk_mul_f32 v[22:23], v[22:23], v[42:43]
    v_cvt_f64_f32 v[12:13], v11
    s_waitcnt lgkmcnt(0)
    v_mfma_f32_32x32x16_bf16 v[52:67], v[68:71], v[32:35], 0
    v_exp_f32 v16, v16
    v_exp_f32 v17, v17
    v_exp_f32_e64 v18, v18
    v_mfma_f32_32x32x16_bf16 v[52:67], v[72:75], v[252:255], v[52:67]
    v_exp_f32 v19, v19
    v_exp_f32 v20, v20
    v_exp_f32 v21, v21
    v_exp_f32 v22, v22
    v_exp_f32_e64 v23, v23
    v_pk_add_f32 v[16:17], v[16:17], 1.0 op_sel_hi:[1,0]
    v_pk_add_f32 v[18:19], v[18:19], 1.0 op_sel_hi:[1,0]
    v_pk_add_f32 v[20:21], v[20:21], 1.0 op_sel_hi:[1,0]
    v_pk_add_f32 v[22:23], v[22:23], 1.0 op_sel_hi:[1,0]
    ds_read_b128 v[32:35], v6 offset:22528
    ds_read_b128 v[252:255], v6 offset:23552
    ds_add_f64 v8, v[12:13] offset:256
    v_mfma_f32_32x32x16_bf16 v[52:67], v[76:79], v[24:27], v[52:67]
    v_rcp_f32 v16, v16
    v_rcp_f32 v17, v17
    v_rcp_f32_e64 v18, v18
    v_mfma_f32_32x32x16_bf16 v[52:67], v[80:83], v[28:31], v[52:67]
    v_rcp_f32 v19, v19
    v_rcp_f32 v20, v20
    v_rcp_f32 v21, v21
    v_rcp_f32 v22, v22
    v_rcp_f32_e64 v23, v23
    v_pk_mul_f32 v[16:17], v[16:17], v[36:37]
    v_pk_mul_f32 v[18:19], v[18:19], v[38:39]
    v_pk_mul_f32 v[20:21], v[20:21], v[40:41]
    v_pk_mul_f32 v[22:23], v[22:23], v[42:43]
    v_cvt_pk_bf16_f32 v204, v16, v17
    v_cvt_pk_bf16_f32 v205, v18, v19
    v_cvt_pk_bf16_f32 v206, v20, v21
    v_cvt_pk_bf16_f32 v207, v22, v23
    v_dot2_f32_bf16 v11, v204, v204, 0
    v_dot2_f32_bf16 v11, v205, v205, v11
    v_dot2_f32_bf16 v11, v206, v206, v11
    v_dot2_f32_bf16 v11, v207, v207, v11
    v_pk_fma_f32 v[16:17], v[44:45], v[44:45], s[34:35]
    v_pk_fma_f32 v[18:19], v[46:47], v[46:47], s[34:35]
    v_pk_fma_f32 v[20:21], v[48:49], v[48:49], s[34:35]
    v_pk_fma_f32 v[22:23], v[50:51], v[50:51], s[34:35]
    v_pk_mul_f32 v[16:17], v[16:17], v[44:45]
    v_pk_mul_f32 v[18:19], v[18:19], v[46:47]
    v_pk_mul_f32 v[20:21], v[20:21], v[48:49]
    v_pk_mul_f32 v[22:23], v[22:23], v[50:51]
    s_waitcnt lgkmcnt(1)
    ds_read_b128 v[24:27], v6 offset:24576
    ds_read_b128 v[28:31], v6 offset:25600
    v_mfma_f32_32x32x16_bf16 v[52:67], v[84:87], v[32:35], v[52:67]
    v_exp_f32 v16, v16
    v_exp_f32 v17, v17
    v_exp_f32 v18, v18
    v_mfma_f32_32x32x16_bf16 v[52:67], v[88:91], v[252:255], v[52:67]
    v_exp_f32 v19, v19
    v_exp_f32 v20, v20
    v_exp_f32 v21, v21
    v_exp_f32 v22, v22
    v_exp_f32_e64 v23, v23
    v_pk_add_f32 v[16:17], v[16:17], 1.0 op_sel_hi:[1,0]
    v_pk_add_f32 v[18:19], v[18:19], 1.0 op_sel_hi:[1,0]
    v_pk_add_f32 v[20:21], v[20:21], 1.0 op_sel_hi:[1,0]
    v_pk_add_f32 v[22:23], v[22:23], 1.0 op_sel_hi:[1,0]
    ds_read_b128 v[32:35], v6 offset:26624
    ds_read_b128 v[252:255], v6 offset:27648
    v_rcp_f32 v16, v16
    v_rcp_f32 v17, v17
    v_rcp_f32 v18, v18
    v_rcp_f32 v19, v19
    v_rcp_f32 v20, v20
    v_rcp_f32 v21, v21
    v_rcp_f32 v22, v22
    v_rcp_f32 v23, v23
    v_pk_mul_f32 v[16:17], v[16:17], v[44:45]
    v_pk_mul_f32 v[18:19], v[18:19], v[46:47]
    v_pk_mul_f32 v[20:21], v[20:21], v[48:49]
    v_pk_mul_f32 v[22:23], v[22:23], v[50:51]
    v_cvt_pk_bf16_f32 v208, v16, v17
    v_cvt_pk_bf16_f32 v209, v18, v19
    v_cvt_pk_bf16_f32 v210, v20, v21
    v_cvt_pk_bf16_f32 v211, v22, v23
    v_dot2_f32_bf16 v11, v208, v208, v11
    v_dot2_f32_bf16 v11, v209, v209, v11
    v_dot2_f32_bf16 v11, v210, v210, v11
    v_dot2_f32_bf16 v11, v211, v211, v11
    v_pk_fma_f32 v[16:17], v[52:53], v[52:53], s[34:35]
    v_pk_fma_f32 v[18:19], v[54:55], v[54:55], s[34:35]
    v_pk_fma_f32 v[20:21], v[56:57], v[56:57], s[34:35]
    v_pk_fma_f32 v[22:23], v[58:59], v[58:59], s[34:35]
    v_pk_mul_f32 v[16:17], v[16:17], v[52:53]
    v_pk_mul_f32 v[18:19], v[18:19], v[54:55]
    v_pk_mul_f32 v[20:21], v[20:21], v[56:57]
    v_pk_mul_f32 v[22:23], v[22:23], v[58:59]
    v_cvt_f64_f32 v[12:13], v11
    s_waitcnt lgkmcnt(0)
    v_mfma_f32_32x32x16_bf16 v[36:51], v[68:71], v[24:27], 0
    v_exp_f32 v16, v16
    v_exp_f32 v17, v17
    v_exp_f32_e64 v18, v18
    v_mfma_f32_32x32x16_bf16 v[36:51], v[72:75], v[28:31], v[36:51]
    v_exp_f32 v19, v19
    v_exp_f32 v20, v20
    v_exp_f32 v21, v21
    v_exp_f32 v22, v22
    v_exp_f32_e64 v23, v23
    v_pk_add_f32 v[16:17], v[16:17], 1.0 op_sel_hi:[1,0]
    v_pk_add_f32 v[18:19], v[18:19], 1.0 op_sel_hi:[1,0]
    v_pk_add_f32 v[20:21], v[20:21], 1.0 op_sel_hi:[1,0]
    v_pk_add_f32 v[22:23], v[22:23], 1.0 op_sel_hi:[1,0]
    ds_read_b128 v[24:27], v6 offset:28672
    ds_read_b128 v[28:31], v6 offset:29696
    ds_add_f64 v8, v[12:13] offset:512
    v_mfma_f32_32x32x16_bf16 v[36:51], v[76:79], v[32:35], v[36:51]
    v_rcp_f32 v16, v16
    v_rcp_f32 v17, v17
    v_rcp_f32_e64 v18, v18
    v_mfma_f32_32x32x16_bf16 v[36:51], v[80:83], v[252:255], v[36:51]
    v_rcp_f32 v19, v19
    v_rcp_f32 v20, v20
    v_rcp_f32 v21, v21
    v_rcp_f32 v22, v22
    v_rcp_f32_e64 v23, v23
    v_pk_mul_f32 v[16:17], v[16:17], v[52:53]
    v_pk_mul_f32 v[18:19], v[18:19], v[54:55]
    v_pk_mul_f32 v[20:21], v[20:21], v[56:57]
    v_pk_mul_f32 v[22:23], v[22:23], v[58:59]
    v_cvt_pk_bf16_f32 v212, v16, v17
    v_cvt_pk_bf16_f32 v213, v18, v19
    v_cvt_pk_bf16_f32 v214, v20, v21
    v_cvt_pk_bf16_f32 v215, v22, v23
    v_dot2_f32_bf16 v11, v212, v212, 0
    v_dot2_f32_bf16 v11, v213, v213, v11
    v_dot2_f32_bf16 v11, v214, v214, v11
    v_dot2_f32_bf16 v11, v215, v215, v11
    v_pk_fma_f32 v[16:17], v[60:61], v[60:61], s[34:35]
    v_pk_fma_f32 v[18:19], v[62:63], v[62:63], s[34:35]
    v_pk_fma_f32 v[20:21], v[64:65], v[64:65], s[34:35]
    v_pk_fma_f32 v[22:23], v[66:67], v[66:67], s[34:35]
    v_pk_mul_f32 v[16:17], v[16:17], v[60:61]
    v_pk_mul_f32 v[18:19], v[18:19], v[62:63]
    v_pk_mul_f32 v[20:21], v[20:21], v[64:65]
    v_pk_mul_f32 v[22:23], v[22:23], v[66:67]
    s_waitcnt lgkmcnt(1)
    ds_read_b128 v[32:35], v6 offset:30720
    ds_read_b128 v[252:255], v6 offset:31744
    v_mfma_f32_32x32x16_bf16 v[36:51], v[84:87], v[24:27], v[36:51]
    v_exp_f32 v16, v16
    v_exp_f32 v17, v17
    v_exp_f32 v18, v18
    v_mfma_f32_32x32x16_bf16 v[36:51], v[88:91], v[28:31], v[36:51]
    v_exp_f32 v19, v19
    v_exp_f32 v20, v20
    v_exp_f32 v21, v21
    v_exp_f32 v22, v22
    v_exp_f32_e64 v23, v23
    v_pk_add_f32 v[16:17], v[16:17], 1.0 op_sel_hi:[1,0]
    v_pk_add_f32 v[18:19], v[18:19], 1.0 op_sel_hi:[1,0]
    v_pk_add_f32 v[20:21], v[20:21], 1.0 op_sel_hi:[1,0]
    v_pk_add_f32 v[22:23], v[22:23], 1.0 op_sel_hi:[1,0]
    ds_read_b128 v[24:27], v6 offset:32768
    ds_read_b128 v[28:31], v6 offset:33792
    v_rcp_f32 v16, v16
    v_rcp_f32 v17, v17
    v_rcp_f32 v18, v18
    v_rcp_f32 v19, v19
    v_rcp_f32 v20, v20
    v_rcp_f32 v21, v21
    v_rcp_f32 v22, v22
    v_rcp_f32 v23, v23
    v_pk_mul_f32 v[16:17], v[16:17], v[60:61]
    v_pk_mul_f32 v[18:19], v[18:19], v[62:63]
    v_pk_mul_f32 v[20:21], v[20:21], v[64:65]
    v_pk_mul_f32 v[22:23], v[22:23], v[66:67]
    v_cvt_pk_bf16_f32 v216, v16, v17
    v_cvt_pk_bf16_f32 v217, v18, v19
    v_cvt_pk_bf16_f32 v218, v20, v21
    v_cvt_pk_bf16_f32 v219, v22, v23
    v_dot2_f32_bf16 v11, v216, v216, v11
    v_dot2_f32_bf16 v11, v217, v217, v11
    v_dot2_f32_bf16 v11, v218, v218, v11
    v_dot2_f32_bf16 v11, v219, v219, v11
    v_pk_fma_f32 v[16:17], v[36:37], v[36:37], s[34:35]
    v_pk_fma_f32 v[18:19], v[38:39], v[38:39], s[34:35]
    v_pk_fma_f32 v[20:21], v[40:41], v[40:41], s[34:35]
    v_pk_fma_f32 v[22:23], v[42:43], v[42:43], s[34:35]
    v_pk_mul_f32 v[16:17], v[16:17], v[36:37]
    v_pk_mul_f32 v[18:19], v[18:19], v[38:39]
    v_pk_mul_f32 v[20:21], v[20:21], v[40:41]
    v_pk_mul_f32 v[22:23], v[22:23], v[42:43]
    v_cvt_f64_f32 v[12:13], v11
    s_waitcnt lgkmcnt(0)
    v_mfma_f32_32x32x16_bf16 v[52:67], v[68:71], v[32:35], 0
    v_exp_f32 v16, v16
    v_exp_f32 v17, v17
    v_exp_f32_e64 v18, v18
    v_mfma_f32_32x32x16_bf16 v[52:67], v[72:75], v[252:255], v[52:67]
    v_exp_f32 v19, v19
    v_exp_f32 v20, v20
    v_exp_f32 v21, v21
    v_exp_f32 v22, v22
    v_exp_f32_e64 v23, v23
    v_pk_add_f32 v[16:17], v[16:17], 1.0 op_sel_hi:[1,0]
    v_pk_add_f32 v[18:19], v[18:19], 1.0 op_sel_hi:[1,0]
    v_pk_add_f32 v[20:21], v[20:21], 1.0 op_sel_hi:[1,0]
    v_pk_add_f32 v[22:23], v[22:23], 1.0 op_sel_hi:[1,0]
    ds_read_b128 v[32:35], v6 offset:34816
    ds_read_b128 v[252:255], v6 offset:35840
    ds_add_f64 v8, v[12:13] offset:768
    v_mfma_f32_32x32x16_bf16 v[52:67], v[76:79], v[24:27], v[52:67]
    v_rcp_f32 v16, v16
    v_rcp_f32 v17, v17
    v_rcp_f32_e64 v18, v18
    v_mfma_f32_32x32x16_bf16 v[52:67], v[80:83], v[28:31], v[52:67]
    v_rcp_f32 v19, v19
    v_rcp_f32 v20, v20
    v_rcp_f32 v21, v21
    v_rcp_f32 v22, v22
    v_rcp_f32_e64 v23, v23
    v_pk_mul_f32 v[16:17], v[16:17], v[36:37]
    v_pk_mul_f32 v[18:19], v[18:19], v[38:39]
    v_pk_mul_f32 v[20:21], v[20:21], v[40:41]
    v_pk_mul_f32 v[22:23], v[22:23], v[42:43]
    v_cvt_pk_bf16_f32 v220, v16, v17
    v_cvt_pk_bf16_f32 v221, v18, v19
    v_cvt_pk_bf16_f32 v222, v20, v21
    v_cvt_pk_bf16_f32 v223, v22, v23
    v_dot2_f32_bf16 v11, v220, v220, 0
    v_dot2_f32_bf16 v11, v221, v221, v11
    v_dot2_f32_bf16 v11, v222, v222, v11
    v_dot2_f32_bf16 v11, v223, v223, v11
    v_pk_fma_f32 v[16:17], v[44:45], v[44:45], s[34:35]
    v_pk_fma_f32 v[18:19], v[46:47], v[46:47], s[34:35]
    v_pk_fma_f32 v[20:21], v[48:49], v[48:49], s[34:35]
    v_pk_fma_f32 v[22:23], v[50:51], v[50:51], s[34:35]
    v_pk_mul_f32 v[16:17], v[16:17], v[44:45]
    v_pk_mul_f32 v[18:19], v[18:19], v[46:47]
    v_pk_mul_f32 v[20:21], v[20:21], v[48:49]
    v_pk_mul_f32 v[22:23], v[22:23], v[50:51]
    s_waitcnt lgkmcnt(1)
    ds_read_b128 v[24:27], v7 offset:0
    ds_read_b128 v[28:31], v7 offset:1024
    v_mfma_f32_32x32x16_bf16 v[52:67], v[84:87], v[32:35], v[52:67]
    v_exp_f32 v16, v16
    v_exp_f32 v17, v17
    v_exp_f32 v18, v18
    v_mfma_f32_32x32x16_bf16 v[52:67], v[88:91], v[252:255], v[52:67]
    v_exp_f32 v19, v19
    v_exp_f32 v20, v20
    v_exp_f32 v21, v21
    v_exp_f32 v22, v22
    v_exp_f32_e64 v23, v23
    v_pk_add_f32 v[16:17], v[16:17], 1.0 op_sel_hi:[1,0]
    v_pk_add_f32 v[18:19], v[18:19], 1.0 op_sel_hi:[1,0]
    v_pk_add_f32 v[20:21], v[20:21], 1.0 op_sel_hi:[1,0]
    v_pk_add_f32 v[22:23], v[22:23], 1.0 op_sel_hi:[1,0]
    ds_read_b128 v[32:35], v7 offset:2048
    ds_read_b128 v[252:255], v7 offset:3072
    v_rcp_f32 v16, v16
    v_rcp_f32 v17, v17
    v_rcp_f32 v18, v18
    v_rcp_f32 v19, v19
    v_rcp_f32 v20, v20
    v_rcp_f32 v21, v21
    v_rcp_f32 v22, v22
    v_rcp_f32 v23, v23
    v_pk_mul_f32 v[16:17], v[16:17], v[44:45]
    v_pk_mul_f32 v[18:19], v[18:19], v[46:47]
    v_pk_mul_f32 v[20:21], v[20:21], v[48:49]
    v_pk_mul_f32 v[22:23], v[22:23], v[50:51]
    v_cvt_pk_bf16_f32 v224, v16, v17
    v_cvt_pk_bf16_f32 v225, v18, v19
    v_cvt_pk_bf16_f32 v226, v20, v21
    v_cvt_pk_bf16_f32 v227, v22, v23
    v_dot2_f32_bf16 v11, v224, v224, v11
    v_dot2_f32_bf16 v11, v225, v225, v11
    v_dot2_f32_bf16 v11, v226, v226, v11
    v_dot2_f32_bf16 v11, v227, v227, v11
    v_mov_b32_e64 v10, 0
    global_load_dword v2, v10, s[30:31] sc1
    v_pk_fma_f32 v[16:17], v[52:53], v[52:53], s[34:35]
    v_pk_fma_f32 v[18:19], v[54:55], v[54:55], s[34:35]
    v_pk_fma_f32 v[20:21], v[56:57], v[56:57], s[34:35]
    v_pk_fma_f32 v[22:23], v[58:59], v[58:59], s[34:35]
    v_pk_mul_f32 v[16:17], v[16:17], v[52:53]
    v_pk_mul_f32 v[18:19], v[18:19], v[54:55]
    v_pk_mul_f32 v[20:21], v[20:21], v[56:57]
    v_pk_mul_f32 v[22:23], v[22:23], v[58:59]
    v_cvt_f64_f32 v[12:13], v11
    s_waitcnt lgkmcnt(0)
    v_mfma_f32_32x32x16_bf16 v[36:51], v[68:71], v[24:27], 0
    v_exp_f32 v16, v16
    v_exp_f32 v17, v17
    v_exp_f32_e64 v18, v18
    v_mfma_f32_32x32x16_bf16 v[36:51], v[72:75], v[28:31], v[36:51]
    v_exp_f32 v19, v19
    v_exp_f32 v20, v20
    v_exp_f32 v21, v21
    v_exp_f32 v22, v22
    v_exp_f32_e64 v23, v23
    v_pk_add_f32 v[16:17], v[16:17], 1.0 op_sel_hi:[1,0]
    v_pk_add_f32 v[18:19], v[18:19], 1.0 op_sel_hi:[1,0]
    v_pk_add_f32 v[20:21], v[20:21], 1.0 op_sel_hi:[1,0]
    v_pk_add_f32 v[22:23], v[22:23], 1.0 op_sel_hi:[1,0]
    ds_read_b128 v[24:27], v7 offset:4096
    ds_read_b128 v[28:31], v7 offset:5120
    ds_add_f64 v8, v[12:13] offset:1024
    v_mfma_f32_32x32x16_bf16 v[36:51], v[76:79], v[32:35], v[36:51]
    v_rcp_f32 v16, v16
    v_rcp_f32 v17, v17
    v_rcp_f32_e64 v18, v18
    v_mfma_f32_32x32x16_bf16 v[36:51], v[80:83], v[252:255], v[36:51]
    v_rcp_f32 v19, v19
    v_rcp_f32 v20, v20
    v_rcp_f32 v21, v21
    v_rcp_f32 v22, v22
    v_rcp_f32_e64 v23, v23
    v_pk_mul_f32 v[16:17], v[16:17], v[52:53]
    v_pk_mul_f32 v[18:19], v[18:19], v[54:55]
    v_pk_mul_f32 v[20:21], v[20:21], v[56:57]
    v_pk_mul_f32 v[22:23], v[22:23], v[58:59]
    v_cvt_pk_bf16_f32 v228, v16, v17
    v_cvt_pk_bf16_f32 v229, v18, v19
    v_cvt_pk_bf16_f32 v230, v20, v21
    v_cvt_pk_bf16_f32 v231, v22, v23
    v_dot2_f32_bf16 v11, v228, v228, 0
    v_dot2_f32_bf16 v11, v229, v229, v11
    v_dot2_f32_bf16 v11, v230, v230, v11
    v_dot2_f32_bf16 v11, v231, v231, v11
    v_pk_fma_f32 v[16:17], v[60:61], v[60:61], s[34:35]
    v_pk_fma_f32 v[18:19], v[62:63], v[62:63], s[34:35]
    v_pk_fma_f32 v[20:21], v[64:65], v[64:65], s[34:35]
    v_pk_fma_f32 v[22:23], v[66:67], v[66:67], s[34:35]
    v_pk_mul_f32 v[16:17], v[16:17], v[60:61]
    v_pk_mul_f32 v[18:19], v[18:19], v[62:63]
    v_pk_mul_f32 v[20:21], v[20:21], v[64:65]
    v_pk_mul_f32 v[22:23], v[22:23], v[66:67]
    s_waitcnt lgkmcnt(1)
    ds_read_b128 v[32:35], v7 offset:6144
    ds_read_b128 v[252:255], v7 offset:7168
    v_mfma_f32_32x32x16_bf16 v[36:51], v[84:87], v[24:27], v[36:51]
    v_exp_f32 v16, v16
    v_exp_f32 v17, v17
    v_exp_f32 v18, v18
    v_mfma_f32_32x32x16_bf16 v[36:51], v[88:91], v[28:31], v[36:51]
    v_exp_f32 v19, v19
    v_exp_f32 v20, v20
    v_exp_f32 v21, v21
    v_exp_f32 v22, v22
    v_exp_f32_e64 v23, v23
    v_pk_add_f32 v[16:17], v[16:17], 1.0 op_sel_hi:[1,0]
    v_pk_add_f32 v[18:19], v[18:19], 1.0 op_sel_hi:[1,0]
    v_pk_add_f32 v[20:21], v[20:21], 1.0 op_sel_hi:[1,0]
    v_pk_add_f32 v[22:23], v[22:23], 1.0 op_sel_hi:[1,0]
    ds_read_b128 v[24:27], v7 offset:8192
    ds_read_b128 v[28:31], v7 offset:9216
    v_rcp_f32 v16, v16
    v_rcp_f32 v17, v17
    v_rcp_f32 v18, v18
    v_rcp_f32 v19, v19
    v_rcp_f32 v20, v20
    v_rcp_f32 v21, v21
    v_rcp_f32 v22, v22
    v_rcp_f32 v23, v23
    v_pk_mul_f32 v[16:17], v[16:17], v[60:61]
    v_pk_mul_f32 v[18:19], v[18:19], v[62:63]
    v_pk_mul_f32 v[20:21], v[20:21], v[64:65]
    v_pk_mul_f32 v[22:23], v[22:23], v[66:67]
    v_cvt_pk_bf16_f32 v232, v16, v17
    v_cvt_pk_bf16_f32 v233, v18, v19
    v_cvt_pk_bf16_f32 v234, v20, v21
    v_cvt_pk_bf16_f32 v235, v22, v23
    v_dot2_f32_bf16 v11, v232, v232, v11
    v_dot2_f32_bf16 v11, v233, v233, v11
    v_dot2_f32_bf16 v11, v234, v234, v11
    v_dot2_f32_bf16 v11, v235, v235, v11
    v_pk_fma_f32 v[16:17], v[36:37], v[36:37], s[34:35]
    v_pk_fma_f32 v[18:19], v[38:39], v[38:39], s[34:35]
    v_pk_fma_f32 v[20:21], v[40:41], v[40:41], s[34:35]
    v_pk_fma_f32 v[22:23], v[42:43], v[42:43], s[34:35]
    v_pk_mul_f32 v[16:17], v[16:17], v[36:37]
    v_pk_mul_f32 v[18:19], v[18:19], v[38:39]
    v_pk_mul_f32 v[20:21], v[20:21], v[40:41]
    v_pk_mul_f32 v[22:23], v[22:23], v[42:43]
    v_cvt_f64_f32 v[12:13], v11
    s_waitcnt lgkmcnt(0)
    v_mfma_f32_32x32x16_bf16 v[52:67], v[68:71], v[32:35], 0
    v_exp_f32 v16, v16
    v_exp_f32 v17, v17
    v_exp_f32_e64 v18, v18
    v_mfma_f32_32x32x16_bf16 v[52:67], v[72:75], v[252:255], v[52:67]
    v_exp_f32 v19, v19
    v_exp_f32 v20, v20
    v_exp_f32 v21, v21
    v_exp_f32 v22, v22
    v_exp_f32_e64 v23, v23
    v_pk_add_f32 v[16:17], v[16:17], 1.0 op_sel_hi:[1,0]
    v_pk_add_f32 v[18:19], v[18:19], 1.0 op_sel_hi:[1,0]
    v_pk_add_f32 v[20:21], v[20:21], 1.0 op_sel_hi:[1,0]
    v_pk_add_f32 v[22:23], v[22:23], 1.0 op_sel_hi:[1,0]
    ds_read_b128 v[32:35], v7 offset:10240
    ds_read_b128 v[252:255], v7 offset:11264
    ds_add_f64 v8, v[12:13] offset:1280
    v_mfma_f32_32x32x16_bf16 v[52:67], v[76:79], v[24:27], v[52:67]
    v_rcp_f32 v16, v16
    v_rcp_f32 v17, v17
    v_rcp_f32_e64 v18, v18
    v_mfma_f32_32x32x16_bf16 v[52:67], v[80:83], v[28:31], v[52:67]
    v_rcp_f32 v19, v19
    v_rcp_f32 v20, v20
    v_rcp_f32 v21, v21
    v_rcp_f32 v22, v22
    v_rcp_f32_e64 v23, v23
    v_pk_mul_f32 v[16:17], v[16:17], v[36:37]
    v_pk_mul_f32 v[18:19], v[18:19], v[38:39]
    v_pk_mul_f32 v[20:21], v[20:21], v[40:41]
    v_pk_mul_f32 v[22:23], v[22:23], v[42:43]
    v_cvt_pk_bf16_f32 v236, v16, v17
    v_cvt_pk_bf16_f32 v237, v18, v19
    v_cvt_pk_bf16_f32 v238, v20, v21
    v_cvt_pk_bf16_f32 v239, v22, v23
    v_dot2_f32_bf16 v11, v236, v236, 0
    v_dot2_f32_bf16 v11, v237, v237, v11
    v_dot2_f32_bf16 v11, v238, v238, v11
    v_dot2_f32_bf16 v11, v239, v239, v11
    v_pk_fma_f32 v[16:17], v[44:45], v[44:45], s[34:35]
    v_pk_fma_f32 v[18:19], v[46:47], v[46:47], s[34:35]
    v_pk_fma_f32 v[20:21], v[48:49], v[48:49], s[34:35]
    v_pk_fma_f32 v[22:23], v[50:51], v[50:51], s[34:35]
    v_pk_mul_f32 v[16:17], v[16:17], v[44:45]
    v_pk_mul_f32 v[18:19], v[18:19], v[46:47]
    v_pk_mul_f32 v[20:21], v[20:21], v[48:49]
    v_pk_mul_f32 v[22:23], v[22:23], v[50:51]
    s_waitcnt lgkmcnt(1)
    ds_read_b128 v[24:27], v7 offset:12288
    ds_read_b128 v[28:31], v7 offset:13312
    v_mfma_f32_32x32x16_bf16 v[52:67], v[84:87], v[32:35], v[52:67]
    v_exp_f32 v16, v16
    v_exp_f32 v17, v17
    v_exp_f32 v18, v18
    v_mfma_f32_32x32x16_bf16 v[52:67], v[88:91], v[252:255], v[52:67]
    v_exp_f32 v19, v19
    v_exp_f32 v20, v20
    v_exp_f32 v21, v21
    v_exp_f32 v22, v22
    v_exp_f32_e64 v23, v23
    v_pk_add_f32 v[16:17], v[16:17], 1.0 op_sel_hi:[1,0]
    v_pk_add_f32 v[18:19], v[18:19], 1.0 op_sel_hi:[1,0]
    v_pk_add_f32 v[20:21], v[20:21], 1.0 op_sel_hi:[1,0]
    v_pk_add_f32 v[22:23], v[22:23], 1.0 op_sel_hi:[1,0]
    ds_read_b128 v[32:35], v7 offset:14336
    ds_read_b128 v[252:255], v7 offset:15360
    v_rcp_f32 v16, v16
    v_rcp_f32 v17, v17
    v_rcp_f32 v18, v18
    v_rcp_f32 v19, v19
    v_rcp_f32 v20, v20
    v_rcp_f32 v21, v21
    v_rcp_f32 v22, v22
    v_rcp_f32 v23, v23
    v_pk_mul_f32 v[16:17], v[16:17], v[44:45]
    v_pk_mul_f32 v[18:19], v[18:19], v[46:47]
    v_pk_mul_f32 v[20:21], v[20:21], v[48:49]
    v_pk_mul_f32 v[22:23], v[22:23], v[50:51]
    v_cvt_pk_bf16_f32 v240, v16, v17
    v_cvt_pk_bf16_f32 v241, v18, v19
    v_cvt_pk_bf16_f32 v242, v20, v21
    v_cvt_pk_bf16_f32 v243, v22, v23
    v_dot2_f32_bf16 v11, v240, v240, v11
    v_dot2_f32_bf16 v11, v241, v241, v11
    v_dot2_f32_bf16 v11, v242, v242, v11
    v_dot2_f32_bf16 v11, v243, v243, v11
    v_pk_fma_f32 v[16:17], v[52:53], v[52:53], s[34:35]
    v_pk_fma_f32 v[18:19], v[54:55], v[54:55], s[34:35]
    v_pk_fma_f32 v[20:21], v[56:57], v[56:57], s[34:35]
    v_pk_fma_f32 v[22:23], v[58:59], v[58:59], s[34:35]
    v_pk_mul_f32 v[16:17], v[16:17], v[52:53]
    v_pk_mul_f32 v[18:19], v[18:19], v[54:55]
    v_pk_mul_f32 v[20:21], v[20:21], v[56:57]
    v_pk_mul_f32 v[22:23], v[22:23], v[58:59]
    v_cvt_f64_f32 v[12:13], v11
    s_waitcnt lgkmcnt(0)
    v_mfma_f32_32x32x16_bf16 v[36:51], v[68:71], v[24:27], 0
    v_exp_f32 v16, v16
    v_exp_f32 v17, v17
    v_exp_f32_e64 v18, v18
    v_mfma_f32_32x32x16_bf16 v[36:51], v[72:75], v[28:31], v[36:51]
    v_exp_f32 v19, v19
    v_exp_f32 v20, v20
    v_exp_f32 v21, v21
    v_exp_f32 v22, v22
    v_exp_f32_e64 v23, v23
    v_pk_add_f32 v[16:17], v[16:17], 1.0 op_sel_hi:[1,0]
    v_pk_add_f32 v[18:19], v[18:19], 1.0 op_sel_hi:[1,0]
    v_pk_add_f32 v[20:21], v[20:21], 1.0 op_sel_hi:[1,0]
    v_pk_add_f32 v[22:23], v[22:23], 1.0 op_sel_hi:[1,0]
    ds_read_b128 v[24:27], v7 offset:16384
    ds_read_b128 v[28:31], v7 offset:17408
    ds_add_f64 v8, v[12:13] offset:1536
    v_mfma_f32_32x32x16_bf16 v[36:51], v[76:79], v[32:35], v[36:51]
    v_rcp_f32 v16, v16
    v_rcp_f32 v17, v17
    v_rcp_f32_e64 v18, v18
    v_mfma_f32_32x32x16_bf16 v[36:51], v[80:83], v[252:255], v[36:51]
    v_rcp_f32 v19, v19
    v_rcp_f32 v20, v20
    v_rcp_f32 v21, v21
    v_rcp_f32 v22, v22
    v_rcp_f32_e64 v23, v23
    v_pk_mul_f32 v[16:17], v[16:17], v[52:53]
    v_pk_mul_f32 v[18:19], v[18:19], v[54:55]
    v_pk_mul_f32 v[20:21], v[20:21], v[56:57]
    v_pk_mul_f32 v[22:23], v[22:23], v[58:59]
    v_cvt_pk_bf16_f32 v244, v16, v17
    v_cvt_pk_bf16_f32 v245, v18, v19
    v_cvt_pk_bf16_f32 v246, v20, v21
    v_cvt_pk_bf16_f32 v247, v22, v23
    v_dot2_f32_bf16 v11, v244, v244, 0
    v_dot2_f32_bf16 v11, v245, v245, v11
    v_dot2_f32_bf16 v11, v246, v246, v11
    v_dot2_f32_bf16 v11, v247, v247, v11
    v_pk_fma_f32 v[16:17], v[60:61], v[60:61], s[34:35]
    v_pk_fma_f32 v[18:19], v[62:63], v[62:63], s[34:35]
    v_pk_fma_f32 v[20:21], v[64:65], v[64:65], s[34:35]
    v_pk_fma_f32 v[22:23], v[66:67], v[66:67], s[34:35]
    v_pk_mul_f32 v[16:17], v[16:17], v[60:61]
    v_pk_mul_f32 v[18:19], v[18:19], v[62:63]
    v_pk_mul_f32 v[20:21], v[20:21], v[64:65]
    v_pk_mul_f32 v[22:23], v[22:23], v[66:67]
    s_waitcnt lgkmcnt(1)
    ds_read_b128 v[32:35], v7 offset:18432
    ds_read_b128 v[252:255], v7 offset:19456
    v_mfma_f32_32x32x16_bf16 v[36:51], v[84:87], v[24:27], v[36:51]
    v_exp_f32 v16, v16
    v_exp_f32 v17, v17
    v_exp_f32 v18, v18
    v_mfma_f32_32x32x16_bf16 v[36:51], v[88:91], v[28:31], v[36:51]
    v_exp_f32 v19, v19
    v_exp_f32 v20, v20
    v_exp_f32 v21, v21
    v_exp_f32 v22, v22
    v_exp_f32_e64 v23, v23
    v_pk_add_f32 v[16:17], v[16:17], 1.0 op_sel_hi:[1,0]
    v_pk_add_f32 v[18:19], v[18:19], 1.0 op_sel_hi:[1,0]
    v_pk_add_f32 v[20:21], v[20:21], 1.0 op_sel_hi:[1,0]
    v_pk_add_f32 v[22:23], v[22:23], 1.0 op_sel_hi:[1,0]
    ds_read_b128 v[24:27], v7 offset:20480
    ds_read_b128 v[28:31], v7 offset:21504
    v_rcp_f32 v16, v16
    v_rcp_f32 v17, v17
    v_rcp_f32 v18, v18
    v_rcp_f32 v19, v19
    v_rcp_f32 v20, v20
    v_rcp_f32 v21, v21
    v_rcp_f32 v22, v22
    v_rcp_f32 v23, v23
    v_pk_mul_f32 v[16:17], v[16:17], v[60:61]
    v_pk_mul_f32 v[18:19], v[18:19], v[62:63]
    v_pk_mul_f32 v[20:21], v[20:21], v[64:65]
    v_pk_mul_f32 v[22:23], v[22:23], v[66:67]
    v_cvt_pk_bf16_f32 v248, v16, v17
    v_cvt_pk_bf16_f32 v249, v18, v19
    v_cvt_pk_bf16_f32 v250, v20, v21
    v_cvt_pk_bf16_f32 v251, v22, v23
    v_dot2_f32_bf16 v11, v248, v248, v11
    v_dot2_f32_bf16 v11, v249, v249, v11
    v_dot2_f32_bf16 v11, v250, v250, v11
    v_dot2_f32_bf16 v11, v251, v251, v11
    v_mov_b32_e64 v10, 0
    s_mov_b32 s10, 0
    s_waitcnt vmcnt(0)
    v_readfirstlane_b32 s9, v2
    s_nop 0
    s_cmp_ge_u32 s9, 8
    s_cbranch_scc1 L_init0_done
L_init0_loop:
    global_load_dword v12, v10, s[30:31] offset:0 sc1
    s_waitcnt vmcnt(0)
    v_readfirstlane_b32 s9, v12
    s_nop 0
    s_cmp_ge_u32 s9, 8
    s_cbranch_scc1 L_init0_done
    s_sleep 1
    s_add_u32 s10, s10, 1
    s_cmp_lt_u32 s10, 0x40000
    s_cbranch_scc1 L_init0_loop
L_init0_done:
    s_nop 4
    v_mov_b32 v14, 163536
    s_mov_b32 s10, 0
L_aw56:
    ds_read_b32 v15, v14 offset:52
    s_add_u32 s10, s10, 1
    s_waitcnt lgkmcnt(0)
    v_readfirstlane_b32 s9, v15
    s_lshr_b32 s55, s10, 22
    s_lshl_b32 s55, s55, 3
    s_or_b32 s9, s9, s55
    s_cmp_lt_u32 s9, 8
    s_cbranch_scc1 L_aw56
    s_cmp_lg_u32 s69, 0
    s_cbranch_scc1 L_skip57
    v_mov_b32 v16, 0
    v_mov_b32 v17, 0
    v_mov_b32 v18, 0
    v_mov_b32 v19, 0
    v_min_u32_e64 v12, 59, v1
    s_mul_i32 s9, s62, 960
    s_add_u32 s9, s9, 155648
    v_lshl_add_u32 v12, v12, 4, s9
    ds_write_b128 v12, v[16:19]
    v_bfe_u32 v12, v1, 3, 2
    v_and_b32 v13, 3, v1
    v_xor_b32 v12, v12, v13
    v_and_b32 v13, 1, v12
    v_lshlrev_b32 v9, 10, v13
    v_lshrrev_b32_e64 v12, 1, v12
    v_lshl_add_u32 v9, v12, 9, v9
    v_lshrrev_b32_e64 v12, 2, v1
    v_lshl_add_u32 v9, v12, 4, v9
    s_mul_i32 s15, s62, 12288
    s_add_u32 s15, s15, 73728
L_skip57:
    s_cmp_lg_u32 s69, 0
    s_cbranch_scc1 L_skip58
    s_add_u32 m0, s15, 0
    s_add_u32 s9, s63, 0
    s_nop 0
    s_nop 0
    buffer_load_dwordx4 v9, s[40:43], s9 offen nt lds
    s_add_u32 m0, s15, 1024
    s_add_u32 s9, s63, 256
    buffer_load_dwordx4 v9, s[40:43], s9 offen nt lds
    s_add_u32 m0, s15, 2048
    s_add_u32 s9, s63, 2048
    buffer_load_dwordx4 v9, s[40:43], s9 offen nt lds
L_skip58:
    v_pk_fma_f32 v[16:17], v[36:37], v[36:37], s[34:35]
    v_pk_fma_f32 v[18:19], v[38:39], v[38:39], s[34:35]
    v_pk_fma_f32 v[20:21], v[40:41], v[40:41], s[34:35]
    v_pk_fma_f32 v[22:23], v[42:43], v[42:43], s[34:35]
    v_pk_mul_f32 v[16:17], v[16:17], v[36:37]
    v_pk_mul_f32 v[18:19], v[18:19], v[38:39]
    v_pk_mul_f32 v[20:21], v[20:21], v[40:41]
    v_pk_mul_f32 v[22:23], v[22:23], v[42:43]
    s_setprio 1
    v_cvt_f64_f32 v[12:13], v11
    v_mfma_f32_32x32x16_bf16 v[52:67], v[68:71], v[32:35], 0
    v_exp_f32 v16, v16
    v_exp_f32 v17, v17
    v_exp_f32_e64 v18, v18
    v_mfma_f32_32x32x16_bf16 v[52:67], v[72:75], v[252:255], v[52:67]
    v_exp_f32 v19, v19
    v_exp_f32 v20, v20
    v_exp_f32 v21, v21
    v_exp_f32 v22, v22
    v_exp_f32_e64 v23, v23
    v_pk_add_f32 v[16:17], v[16:17], 1.0 op_sel_hi:[1,0]
    v_pk_add_f32 v[18:19], v[18:19], 1.0 op_sel_hi:[1,0]
    v_pk_add_f32 v[20:21], v[20:21], 1.0 op_sel_hi:[1,0]
    v_pk_add_f32 v[22:23], v[22:23], 1.0 op_sel_hi:[1,0]
    ds_read_b128 v[32:35], v7 offset:22528
    ds_read_b128 v[252:255], v7 offset:23552
    ds_add_f64 v8, v[12:13] offset:1792
    v_mfma_f32_32x32x16_bf16 v[52:67], v[76:79], v[24:27], v[52:67]
    v_rcp_f32 v16, v16
    v_rcp_f32 v17, v17
    v_rcp_f32_e64 v18, v18
    v_mfma_f32_32x32x16_bf16 v[52:67], v[80:83], v[28:31], v[52:67]
    v_rcp_f32 v19, v19
    v_rcp_f32 v20, v20
    v_rcp_f32 v21, v21
    v_rcp_f32 v22, v22
    v_rcp_f32_e64 v23, v23
    v_pk_mul_f32 v[16:17], v[16:17], v[36:37]
    v_pk_mul_f32 v[18:19], v[18:19], v[38:39]
    v_pk_mul_f32 v[20:21], v[20:21], v[40:41]
    v_pk_mul_f32 v[22:23], v[22:23], v[42:43]
    v_cvt_pk_bf16_f32 v36, v16, v17
    v_cvt_pk_bf16_f32 v37, v18, v19
    v_cvt_pk_bf16_f32 v38, v20, v21
    v_cvt_pk_bf16_f32 v39, v22, v23
    v_dot2_f32_bf16 v11, v36, v36, 0
    v_dot2_f32_bf16 v11, v37, v37, v11
    v_dot2_f32_bf16 v11, v38, v38, v11
    v_dot2_f32_bf16 v11, v39, v39, v11
    v_pk_fma_f32 v[16:17], v[44:45], v[44:45], s[34:35]
    v_pk_fma_f32 v[18:19], v[46:47], v[46:47], s[34:35]
    v_pk_fma_f32 v[20:21], v[48:49], v[48:49], s[34:35]
    v_pk_fma_f32 v[22:23], v[50:51], v[50:51], s[34:35]
    v_pk_mul_f32 v[16:17], v[16:17], v[44:45]
    v_pk_mul_f32 v[18:19], v[18:19], v[46:47]
    v_pk_mul_f32 v[20:21], v[20:21], v[48:49]
    v_pk_mul_f32 v[22:23], v[22:23], v[50:51]
    s_waitcnt lgkmcnt(1)
    ds_read_b128 v[24:27], v7 offset:24576
    ds_read_b128 v[28:31], v7 offset:25600
    v_mfma_f32_32x32x16_bf16 v[52:67], v[84:87], v[32:35], v[52:67]
    v_exp_f32 v16, v16
    v_exp_f32 v17, v17
    v_exp_f32 v18, v18
    v_mfma_f32_32x32x16_bf16 v[52:67], v[88:91], v[252:255], v[52:67]
    v_exp_f32 v19, v19
    v_exp_f32 v20, v20
    v_exp_f32 v21, v21
    v_exp_f32 v22, v22
    v_exp_f32_e64 v23, v23
    v_pk_add_f32 v[16:17], v[16:17], 1.0 op_sel_hi:[1,0]
    v_pk_add_f32 v[18:19], v[18:19], 1.0 op_sel_hi:[1,0]
    v_pk_add_f32 v[20:21], v[20:21], 1.0 op_sel_hi:[1,0]
    v_pk_add_f32 v[22:23], v[22:23], 1.0 op_sel_hi:[1,0]
    ds_read_b128 v[32:35], v7 offset:26624
    ds_read_b128 v[252:255], v7 offset:27648
    v_rcp_f32 v16, v16
    v_rcp_f32 v17, v17
    v_rcp_f32 v18, v18
    v_rcp_f32 v19, v19
    v_rcp_f32 v20, v20
    v_rcp_f32 v21, v21
    v_rcp_f32 v22, v22
    v_rcp_f32 v23, v23
    v_pk_mul_f32 v[16:17], v[16:17], v[44:45]
    v_pk_mul_f32 v[18:19], v[18:19], v[46:47]
    v_pk_mul_f32 v[20:21], v[20:21], v[48:49]
    v_pk_mul_f32 v[22:23], v[22:23], v[50:51]
    v_cvt_pk_bf16_f32 v40, v16, v17
    v_cvt_pk_bf16_f32 v41, v18, v19
    v_cvt_pk_bf16_f32 v42, v20, v21
    v_cvt_pk_bf16_f32 v43, v22, v23
    v_dot2_f32_bf16 v11, v40, v40, v11
    v_dot2_f32_bf16 v11, v41, v41, v11
    v_dot2_f32_bf16 v11, v42, v42, v11
    v_dot2_f32_bf16 v11, v43, v43, v11
    s_cmp_lg_u32 s69, 0
    s_cbranch_scc1 L_skip59
    s_add_u32 m0, s15, 3072
    s_add_u32 s9, s63, 2304
    buffer_load_dwordx4 v9, s[40:43], s9 offen nt lds
    s_add_u32 m0, s15, 4096
    s_add_u32 s9, s63, 4096
    buffer_load_dwordx4 v9, s[40:43], s9 offen nt lds
    s_add_u32 m0, s15, 5120
    s_add_u32 s9, s63, 4352
    buffer_load_dwordx4 v9, s[40:43], s9 offen nt lds
L_skip59:
    ds_write_b128 v3, v[36:39] offset:0
    ds_write_b128 v4, v[40:43] offset:0
    v_pk_fma_f32 v[16:17], v[52:53], v[52:53], s[34:35]
    v_pk_fma_f32 v[18:19], v[54:55], v[54:55], s[34:35]
    v_pk_fma_f32 v[20:21], v[56:57], v[56:57], s[34:35]
    v_pk_fma_f32 v[22:23], v[58:59], v[58:59], s[34:35]
    v_pk_mul_f32 v[16:17], v[16:17], v[52:53]
    v_pk_mul_f32 v[18:19], v[18:19], v[54:55]
    v_pk_mul_f32 v[20:21], v[20:21], v[56:57]
    v_pk_mul_f32 v[22:23], v[22:23], v[58:59]
    v_cvt_f64_f32 v[12:13], v11
    s_waitcnt lgkmcnt(2)
    v_mfma_f32_32x32x16_bf16 v[36:51], v[68:71], v[24:27], 0
    v_exp_f32 v16, v16
    v_exp_f32 v17, v17
    v_exp_f32_e64 v18, v18
    v_mfma_f32_32x32x16_bf16 v[36:51], v[72:75], v[28:31], v[36:51]
    v_exp_f32 v19, v19
    v_exp_f32 v20, v20
    v_exp_f32 v21, v21
    v_exp_f32 v22, v22
    v_exp_f32_e64 v23, v23
    v_pk_add_f32 v[16:17], v[16:17], 1.0 op_sel_hi:[1,0]
    v_pk_add_f32 v[18:19], v[18:19], 1.0 op_sel_hi:[1,0]
    v_pk_add_f32 v[20:21], v[20:21], 1.0 op_sel_hi:[1,0]
    v_pk_add_f32 v[22:23], v[22:23], 1.0 op_sel_hi:[1,0]
    ds_read_b128 v[24:27], v7 offset:28672
    ds_read_b128 v[28:31], v7 offset:29696
    ds_add_f64 v8, v[12:13] offset:2048
    v_mfma_f32_32x32x16_bf16 v[36:51], v[76:79], v[32:35], v[36:51]
    v_rcp_f32 v16, v16
    v_rcp_f32 v17, v17
    v_rcp_f32_e64 v18, v18
    v_mfma_f32_32x32x16_bf16 v[36:51], v[80:83], v[252:255], v[36:51]
    v_rcp_f32 v19, v19
    v_rcp_f32 v20, v20
    v_rcp_f32 v21, v21
    v_rcp_f32 v22, v22
    v_rcp_f32_e64 v23, v23
    v_pk_mul_f32 v[16:17], v[16:17], v[52:53]
    v_pk_mul_f32 v[18:19], v[18:19], v[54:55]
    v_pk_mul_f32 v[20:21], v[20:21], v[56:57]
    v_pk_mul_f32 v[22:23], v[22:23], v[58:59]
    v_cvt_pk_bf16_f32 v52, v16, v17
    v_cvt_pk_bf16_f32 v53, v18, v19
    v_cvt_pk_bf16_f32 v54, v20, v21
    v_cvt_pk_bf16_f32 v55, v22, v23
    v_dot2_f32_bf16 v11, v52, v52, 0
    v_dot2_f32_bf16 v11, v53, v53, v11
    v_dot2_f32_bf16 v11, v54, v54, v11
    v_dot2_f32_bf16 v11, v55, v55, v11
    v_pk_fma_f32 v[16:17], v[60:61], v[60:61], s[34:35]
    v_pk_fma_f32 v[18:19], v[62:63], v[62:63], s[34:35]
    v_pk_fma_f32 v[20:21], v[64:65], v[64:65], s[34:35]
    v_pk_fma_f32 v[22:23], v[66:67], v[66:67], s[34:35]
    v_pk_mul_f32 v[16:17], v[16:17], v[60:61]
    v_pk_mul_f32 v[18:19], v[18:19], v[62:63]
    v_pk_mul_f32 v[20:21], v[20:21], v[64:65]
    v_pk_mul_f32 v[22:23], v[22:23], v[66:67]
    s_waitcnt lgkmcnt(1)
    ds_read_b128 v[32:35], v7 offset:30720
    ds_read_b128 v[252:255], v7 offset:31744
    v_mfma_f32_32x32x16_bf16 v[36:51], v[84:87], v[24:27], v[36:51]
    v_exp_f32 v16, v16
    v_exp_f32 v17, v17
    v_exp_f32 v18, v18
    v_mfma_f32_32x32x16_bf16 v[36:51], v[88:91], v[28:31], v[36:51]
    v_exp_f32 v19, v19
    v_exp_f32 v20, v20
    v_exp_f32 v21, v21
    v_exp_f32 v22, v22
    v_exp_f32_e64 v23, v23
    v_pk_add_f32 v[16:17], v[16:17], 1.0 op_sel_hi:[1,0]
    v_pk_add_f32 v[18:19], v[18:19], 1.0 op_sel_hi:[1,0]
    v_pk_add_f32 v[20:21], v[20:21], 1.0 op_sel_hi:[1,0]
    v_pk_add_f32 v[22:23], v[22:23], 1.0 op_sel_hi:[1,0]
    ds_read_b128 v[24:27], v7 offset:32768
    ds_read_b128 v[28:31], v7 offset:33792
    v_rcp_f32 v16, v16
    v_rcp_f32 v17, v17
    v_rcp_f32 v18, v18
    v_rcp_f32 v19, v19
    v_rcp_f32 v20, v20
    v_rcp_f32 v21, v21
    v_rcp_f32 v22, v22
    v_rcp_f32 v23, v23
    v_pk_mul_f32 v[16:17], v[16:17], v[60:61]
    v_pk_mul_f32 v[18:19], v[18:19], v[62:63]
    v_pk_mul_f32 v[20:21], v[20:21], v[64:65]
    v_pk_mul_f32 v[22:23], v[22:23], v[66:67]
    v_cvt_pk_bf16_f32 v56, v16, v17
    v_cvt_pk_bf16_f32 v57, v18, v19
    v_cvt_pk_bf16_f32 v58, v20, v21
    v_cvt_pk_bf16_f32 v59, v22, v23
    v_dot2_f32_bf16 v11, v56, v56, v11
    v_dot2_f32_bf16 v11, v57, v57, v11
    v_dot2_f32_bf16 v11, v58, v58, v11
    v_dot2_f32_bf16 v11, v59, v59, v11
    s_cmp_lg_u32 s69, 0
    s_cbranch_scc1 L_skip60
    s_add_u32 m0, s15, 6144
    s_add_u32 s9, s63, 6144
    buffer_load_dwordx4 v9, s[40:43], s9 offen nt lds
    s_add_u32 m0, s15, 7168
    s_add_u32 s9, s63, 6400
    buffer_load_dwordx4 v9, s[40:43], s9 offen nt lds
    s_add_u32 m0, s15, 8192
    s_add_u32 s9, s63, 8192
    buffer_load_dwordx4 v9, s[40:43], s9 offen nt lds
L_skip60:
    ds_write_b128 v3, v[52:55] offset:2048
    ds_write_b128 v4, v[56:59] offset:2048
    v_pk_fma_f32 v[16:17], v[36:37], v[36:37], s[34:35]
    v_pk_fma_f32 v[18:19], v[38:39], v[38:39], s[34:35]
    v_pk_fma_f32 v[20:21], v[40:41], v[40:41], s[34:35]
    v_pk_fma_f32 v[22:23], v[42:43], v[42:43], s[34:35]
    v_pk_mul_f32 v[16:17], v[16:17], v[36:37]
    v_pk_mul_f32 v[18:19], v[18:19], v[38:39]
    v_pk_mul_f32 v[20:21], v[20:21], v[40:41]
    v_pk_mul_f32 v[22:23], v[22:23], v[42:43]
    v_cvt_f64_f32 v[12:13], v11
    s_waitcnt lgkmcnt(2)
    v_mfma_f32_32x32x16_bf16 v[52:67], v[68:71], v[32:35], 0
    v_exp_f32 v16, v16
    v_exp_f32 v17, v17
    v_exp_f32_e64 v18, v18
    v_mfma_f32_32x32x16_bf16 v[52:67], v[72:75], v[252:255], v[52:67]
    v_exp_f32 v19, v19
    v_exp_f32 v20, v20
    v_exp_f32 v21, v21
    v_exp_f32 v22, v22
    v_exp_f32_e64 v23, v23
    v_pk_add_f32 v[16:17], v[16:17], 1.0 op_sel_hi:[1,0]
    v_pk_add_f32 v[18:19], v[18:19], 1.0 op_sel_hi:[1,0]
    v_pk_add_f32 v[20:21], v[20:21], 1.0 op_sel_hi:[1,0]
    v_pk_add_f32 v[22:23], v[22:23], 1.0 op_sel_hi:[1,0]
    ds_read_b128 v[32:35], v7 offset:34816
    ds_read_b128 v[252:255], v7 offset:35840
    ds_add_f64 v8, v[12:13] offset:2304
    v_mfma_f32_32x32x16_bf16 v[52:67], v[76:79], v[24:27], v[52:67]
    v_rcp_f32 v16, v16
    v_rcp_f32 v17, v17
    v_rcp_f32_e64 v18, v18
    v_mfma_f32_32x32x16_bf16 v[52:67], v[80:83], v[28:31], v[52:67]
    v_rcp_f32 v19, v19
    v_rcp_f32 v20, v20
    v_rcp_f32 v21, v21
    v_rcp_f32 v22, v22
    v_rcp_f32_e64 v23, v23
    v_pk_mul_f32 v[16:17], v[16:17], v[36:37]
    v_pk_mul_f32 v[18:19], v[18:19], v[38:39]
    v_pk_mul_f32 v[20:21], v[20:21], v[40:41]
    v_pk_mul_f32 v[22:23], v[22:23], v[42:43]
    v_cvt_pk_bf16_f32 v36, v16, v17
    v_cvt_pk_bf16_f32 v37, v18, v19
    v_cvt_pk_bf16_f32 v38, v20, v21
    v_cvt_pk_bf16_f32 v39, v22, v23
    v_dot2_f32_bf16 v11, v36, v36, 0
    v_dot2_f32_bf16 v11, v37, v37, v11
    v_dot2_f32_bf16 v11, v38, v38, v11
    v_dot2_f32_bf16 v11, v39, v39, v11
    v_pk_fma_f32 v[16:17], v[44:45], v[44:45], s[34:35]
    v_pk_fma_f32 v[18:19], v[46:47], v[46:47], s[34:35]
    v_pk_fma_f32 v[20:21], v[48:49], v[48:49], s[34:35]
    v_pk_fma_f32 v[22:23], v[50:51], v[50:51], s[34:35]
    v_pk_mul_f32 v[16:17], v[16:17], v[44:45]
    v_pk_mul_f32 v[18:19], v[18:19], v[46:47]
    v_pk_mul_f32 v[20:21], v[20:21], v[48:49]
    v_pk_mul_f32 v[22:23], v[22:23], v[50:51]
    s_waitcnt lgkmcnt(1)
    v_mfma_f32_32x32x16_bf16 v[52:67], v[84:87], v[32:35], v[52:67]
    v_exp_f32 v16, v16
    v_exp_f32 v17, v17
    v_exp_f32 v18, v18
    v_mfma_f32_32x32x16_bf16 v[52:67], v[88:91], v[252:255], v[52:67]
    v_exp_f32 v19, v19
    v_exp_f32 v20, v20
    v_exp_f32 v21, v21
    v_exp_f32 v22, v22
    v_exp_f32_e64 v23, v23
    v_pk_add_f32 v[16:17], v[16:17], 1.0 op_sel_hi:[1,0]
    v_pk_add_f32 v[18:19], v[18:19], 1.0 op_sel_hi:[1,0]
    v_pk_add_f32 v[20:21], v[20:21], 1.0 op_sel_hi:[1,0]
    v_pk_add_f32 v[22:23], v[22:23], 1.0 op_sel_hi:[1,0]
    v_rcp_f32 v16, v16
    v_rcp_f32 v17, v17
    v_rcp_f32 v18, v18
    v_rcp_f32 v19, v19
    v_rcp_f32 v20, v20
    v_rcp_f32 v21, v21
    v_rcp_f32 v22, v22
    v_rcp_f32 v23, v23
    v_pk_mul_f32 v[16:17], v[16:17], v[44:45]
    v_pk_mul_f32 v[18:19], v[18:19], v[46:47]
    v_pk_mul_f32 v[20:21], v[20:21], v[48:49]
    v_pk_mul_f32 v[22:23], v[22:23], v[50:51]
    v_cvt_pk_bf16_f32 v40, v16, v17
    v_cvt_pk_bf16_f32 v41, v18, v19
    v_cvt_pk_bf16_f32 v42, v20, v21
    v_cvt_pk_bf16_f32 v43, v22, v23
    v_dot2_f32_bf16 v11, v40, v40, v11
    v_dot2_f32_bf16 v11, v41, v41, v11
    v_dot2_f32_bf16 v11, v42, v42, v11
    v_dot2_f32_bf16 v11, v43, v43, v11
    s_cmp_lg_u32 s69, 0
    s_cbranch_scc1 L_skip61
    s_add_u32 m0, s15, 9216
    s_add_u32 s9, s63, 8448
    buffer_load_dwordx4 v9, s[40:43], s9 offen nt lds
    s_add_u32 m0, s15, 10240
    s_add_u32 s9, s63, 10240
    buffer_load_dwordx4 v9, s[40:43], s9 offen nt lds
    s_add_u32 m0, s15, 11264
    s_add_u32 s9, s63, 10496
    buffer_load_dwordx4 v9, s[40:43], s9 offen nt lds
L_skip61:
    v_lshrrev_b32 v14, 5, v1
    v_lshlrev_b32 v14, 3, v14
    s_mul_i32 s9, s3, 96
    v_add_u32_e64 v14, s9, v14
    global_load_dwordx2 v[24:25], v14, s[26:27] offset:0
    global_load_dwordx2 v[26:27], v14, s[26:27] offset:16
    global_load_dwordx2 v[28:29], v14, s[26:27] offset:32
    global_load_dwordx2 v[30:31], v14, s[26:27] offset:48
    global_load_dwordx2 v[32:33], v14, s[26:27] offset:64
    global_load_dwordx2 v[34:35], v14, s[26:27] offset:80
    v_lshlrev_b32_e64 v15, 2, v1
    global_load_dword v252, v15, s[24:25] offset:0
    global_load_dword v253, v15, s[24:25] offset:256
    global_load_dword v254, v15, s[24:25] offset:512
    v_pk_fma_f32 v[16:17], v[52:53], v[52:53], s[34:35]
    v_pk_fma_f32 v[18:19], v[54:55], v[54:55], s[34:35]
    v_pk_fma_f32 v[20:21], v[56:57], v[56:57], s[34:35]
    v_pk_fma_f32 v[22:23], v[58:59], v[58:59], s[34:35]
    v_pk_mul_f32 v[16:17], v[16:17], v[52:53]
    v_pk_mul_f32 v[18:19], v[18:19], v[54:55]
    v_pk_mul_f32 v[20:21], v[20:21], v[56:57]
    v_pk_mul_f32 v[22:23], v[22:23], v[58:59]
    s_setprio 0
    v_cvt_f64_f32 v[12:13], v11
    v_exp_f32 v16, v16
    v_exp_f32 v17, v17
    v_exp_f32 v18, v18
    v_exp_f32 v19, v19
    v_exp_f32 v20, v20
    v_exp_f32 v21, v21
    v_exp_f32 v22, v22
    v_exp_f32 v23, v23
    v_pk_add_f32 v[16:17], v[16:17], 1.0 op_sel_hi:[1,0]
    v_pk_add_f32 v[18:19], v[18:19], 1.0 op_sel_hi:[1,0]
    v_pk_add_f32 v[20:21], v[20:21], 1.0 op_sel_hi:[1,0]
    v_pk_add_f32 v[22:23], v[22:23], 1.0 op_sel_hi:[1,0]
    ds_add_f64 v8, v[12:13] offset:2560
    v_rcp_f32 v16, v16
    v_rcp_f32 v17, v17
    v_rcp_f32 v18, v18
    v_rcp_f32 v19, v19
    v_rcp_f32 v20, v20
    v_rcp_f32 v21, v21
    v_rcp_f32 v22, v22
    v_rcp_f32 v23, v23
    v_pk_mul_f32 v[16:17], v[16:17], v[52:53]
    v_pk_mul_f32 v[18:19], v[18:19], v[54:55]
    v_pk_mul_f32 v[20:21], v[20:21], v[56:57]
    v_pk_mul_f32 v[22:23], v[22:23], v[58:59]
    v_cvt_pk_bf16_f32 v44, v16, v17
    v_cvt_pk_bf16_f32 v45, v18, v19
    v_cvt_pk_bf16_f32 v46, v20, v21
    v_cvt_pk_bf16_f32 v47, v22, v23
    v_dot2_f32_bf16 v11, v44, v44, 0
    v_dot2_f32_bf16 v11, v45, v45, v11
    v_dot2_f32_bf16 v11, v46, v46, v11
    v_dot2_f32_bf16 v11, v47, v47, v11
    v_pk_fma_f32 v[16:17], v[60:61], v[60:61], s[34:35]
    v_pk_fma_f32 v[18:19], v[62:63], v[62:63], s[34:35]
    v_pk_fma_f32 v[20:21], v[64:65], v[64:65], s[34:35]
    v_pk_fma_f32 v[22:23], v[66:67], v[66:67], s[34:35]
    v_pk_mul_f32 v[16:17], v[16:17], v[60:61]
    v_pk_mul_f32 v[18:19], v[18:19], v[62:63]
    v_pk_mul_f32 v[20:21], v[20:21], v[64:65]
    v_pk_mul_f32 v[22:23], v[22:23], v[66:67]
    v_exp_f32 v16, v16
    v_exp_f32 v17, v17
    v_exp_f32 v18, v18
    v_exp_f32 v19, v19
    v_exp_f32 v20, v20
    v_exp_f32 v21, v21
    v_exp_f32 v22, v22
    v_exp_f32 v23, v23
    v_pk_add_f32 v[16:17], v[16:17], 1.0 op_sel_hi:[1,0]
    v_pk_add_f32 v[18:19], v[18:19], 1.0 op_sel_hi:[1,0]
    v_pk_add_f32 v[20:21], v[20:21], 1.0 op_sel_hi:[1,0]
    v_pk_add_f32 v[22:23], v[22:23], 1.0 op_sel_hi:[1,0]
    v_rcp_f32 v16, v16
    v_rcp_f32 v17, v17
    v_rcp_f32 v18, v18
    v_rcp_f32 v19, v19
    v_rcp_f32 v20, v20
    v_rcp_f32 v21, v21
    v_rcp_f32 v22, v22
    v_rcp_f32 v23, v23
    v_pk_mul_f32 v[16:17], v[16:17], v[60:61]
    v_pk_mul_f32 v[18:19], v[18:19], v[62:63]
    v_pk_mul_f32 v[20:21], v[20:21], v[64:65]
    v_pk_mul_f32 v[22:23], v[22:23], v[66:67]
    v_cvt_pk_bf16_f32 v48, v16, v17
    v_cvt_pk_bf16_f32 v49, v18, v19
    v_cvt_pk_bf16_f32 v50, v20, v21
    v_cvt_pk_bf16_f32 v51, v22, v23
    v_dot2_f32_bf16 v11, v48, v48, v11
    v_dot2_f32_bf16 v11, v49, v49, v11
    v_dot2_f32_bf16 v11, v50, v50, v11
    v_dot2_f32_bf16 v11, v51, v51, v11
    s_nop 2
    v_cvt_f64_f32 v[12:13], v11
    ds_add_f64 v8, v[12:13] offset:2816
    s_waitcnt lgkmcnt(0)
    s_branch L_streams_done
.section .rodata,"a"
.p2align 6
.amdhsa_kernel standalone__modern_conv_block_slak__vision_kernel
  .amdhsa_next_free_vgpr 256
  .amdhsa_next_free_sgpr 102
  .amdhsa_accum_offset 256
  .amdhsa_group_segment_fixed_size 0
  .amdhsa_kernarg_size 72
  .amdhsa_user_sgpr_count 2
  .amdhsa_user_sgpr_kernarg_segment_ptr 1
  .amdhsa_system_sgpr_workgroup_id_x 1
.end_amdhsa_kernel
```
